```python
import torch

def _softmax(x, axis=-1):
    return torch.softmax(x, dim=axis)
def _gelu(x):
    return torch.nn.functional.gelu(x, approximate="tanh")
def _silu(x):
    return torch.nn.functional.silu(x)
def _sigmoid(x):
    return torch.sigmoid(x)
def _layernorm(x, axis=-1, eps=1e-5):
    m = x.mean(dim=axis, keepdim=True)
    v = x.var(dim=axis, keepdim=True, unbiased=False)
    return (x - m) / torch.sqrt(v + eps)
def _scatter_add(tgt, idx, src, axis=0):
    return tgt.clone().index_add_(axis, idx, src)
def _segment_sum(src, seg, n):
    out = torch.zeros((n,) + src.shape[1:], dtype=src.dtype)
    return out.index_add_(0, seg, src)
def _pad(x, pw):
    flat = tuple(v for pair in reversed(pw) for v in pair)
    return torch.nn.functional.pad(x, flat)

kernel_name = 'gated_mix__sliding_block__swiglu_ffn__prompt'

def setup_inputs():

    _w = (lambda a: (lambda t: t.to(torch.bfloat16) if t.is_floating_point() else t)(torch.as_tensor(a)))
    def _A_setup():
        B, S, D = 1, 2048, 512
        return {
            "x": _w((lambda *s: torch.randn(*s, dtype=torch.bfloat16) * 0.05)(B, S, D)),
            "wqkv": _w((lambda *s: torch.randn(*s, dtype=torch.bfloat16) * 0.8)(D, 3 * D)),
            "wo": _w((lambda *s: torch.randn(*s, dtype=torch.bfloat16) * 0.05)(D, D)),
        }
    _A_in = _A_setup()

    def _B_setup():
        B, S, D, F = 1, 2048, 512, 1792
        return {
            "x": _w((lambda *s: torch.randn(*s, dtype=torch.bfloat16) * 0.05)(B, S, D)),
            "w_gate": _w((lambda *s: torch.randn(*s, dtype=torch.bfloat16) * 0.2)(D, F)),
            "w_up": _w((lambda *s: torch.randn(*s, dtype=torch.bfloat16) * 0.2)(D, F)),
            "w_down": _w((lambda *s: torch.randn(*s, dtype=torch.bfloat16) * 0.2)(F, D)),
        }
    _B_in = _B_setup()

    return {
        "A_x": _A_in["x"],
        "A_wqkv": _A_in["wqkv"],
        "A_wo": _A_in["wo"],
        "B_x": _B_in["x"],
        "B_w_gate": _B_in["w_gate"],
        "B_w_up": _B_in["w_up"],
        "B_w_down": _B_in["w_down"],
        "gate_w": _w((lambda *s: torch.randn(*s, dtype=torch.bfloat16) * 0.05)(512) * 16.0),
    }

def reference(A_x, A_wqkv, A_wo, B_x, B_w_gate, B_w_up, B_w_down, gate_w):
    def _A_ref(x, wqkv, wo):
        B, S, D = x.shape
        H = 32; Dh = D // H; W = 256
        qkv = (lambda x, *d: x.permute(*d))((x @ wqkv).reshape(B, S, 3, H, Dh), 2, 0, 3, 1, 4)
        q, k, v = qkv[0], qkv[1], qkv[2]
        scores = torch.einsum("bhqd,bhkd->bhqk", q, k) * (Dh ** -0.5)
        idx = torch.arange(S)
        mask = (idx[:, None] - idx[None, :] >= 0) & (idx[:, None] - idx[None, :] < W)
        scores = torch.where(mask[None, None], scores, -1e9)
        p = _softmax(scores, axis=-1)
        o = torch.einsum("bhqk,bhkd->bhqd", p, v)
        return (lambda x, *d: x.permute(*d))(o, 0, 2, 1, 3).reshape(B, S, D) @ wo

    def _B_ref(x, w_gate, w_up, w_down):
        g = _silu(x @ w_gate)
        u = x @ w_up
        return (g * u) @ w_down

    x = A_x
    g = _sigmoid((x * gate_w).sum(-1, keepdims=True))
    a = _A_ref(x, A_wqkv, A_wo)
    b = _B_ref(x, B_w_gate, B_w_up, B_w_down)
    return g * a + (1 - g) * b
```

```asm
; @launch grid=(256,1,1) block=(256,1,1) lds=163840
.amdgcn_target "amdgcn-amd-amdhsa--gfx950"
.text
.globl gated_mix__sliding_block__swiglu_ffn__prompt_kernel
.p2align 8
.type gated_mix__sliding_block__swiglu_ffn__prompt_kernel,@function
gated_mix__sliding_block__swiglu_ffn__prompt_kernel:
    s_load_dwordx16 s[64:79], s[0:1], 0
    s_load_dwordx4 s[80:83], s[0:1], 64
    s_load_dwordx2 s[84:85], s[0:1], 80
    s_cmp_ge_u32 s2, 256
    s_cbranch_scc1 L_end
    v_lshrrev_b32 v40, 6, v0
    v_and_b32 v0, 63, v0
    v_readfirstlane_b32 s3, v40
    s_getpc_b64 s[88:89]
    s_and_b32 s4, s2, 7
    s_lshr_b32 s5, s2, 3
    s_lshl_b32 s6, s5, 2
    s_add_u32 s6, s6, s3
    s_lshl_b32 s6, s6, 7
    v_lshl_add_u32 v40, v0, 14, s6
    v_min_u32 v40, 40704, v40
    global_load_dword v95, v40, s[88:89]
    s_and_b32 s48, s4, 1
    s_lshl_b32 s48, s48, 3
    s_and_b32 s6, s5, 7
    s_add_u32 s48, s48, s6
    s_lshr_b32 s50, s4, 1
    s_lshr_b32 s51, s5, 3
    s_lshl_b32 s52, s51, 1
    s_add_u32 s52, s52, s48
    s_add_u32 s52, s52, s50
    s_lshl_b32 s52, s52, 1
    s_and_b32 s52, s52, 6
    s_and_b32 s6, s4, 1
    s_add_u32 s52, s52, s6
    s_lshl_b32 s60, s3, 11
    s_lshl_b32 s61, s3, 12
    v_lshrrev_b32 v60, 3, v0
    v_lshrrev_b32 v42, 4, v0
    v_and_b32 v43, 7, v0
    v_xor_b32 v44, v42, v43
    v_xor_b32 v45, 4, v44
    s_lshl_b32 s6, s48, 7
    s_lshl_b32 s7, s3, 5
    s_add_u32 s6, s6, s7
    v_add_lshl_u32 v46, s6, v60, 10
    v_lshl_add_u32 v2, v44, 4, v46
    v_lshl_add_u32 v3, v45, 4, v46
    v_add_u32 v4, 14336, v2
    v_add_u32 v3, 7168, v3
    v_add_u32 v5, 14336, v3
    s_lshl_b32 s56, s52, 7
    s_mov_b32 m0, s61
    s_waitcnt lgkmcnt(0)
    s_mov_b32 s8, s64
    s_mov_b32 s9, s65
    s_mov_b32 s10, 2097152
    s_mov_b32 s11, 0x20000
    buffer_load_dwordx4 v2, s[8:11], s56 offen sc1 lds
    v_and_b32 v61, 1, v42
    v_lshlrev_b32 v61, 2, v61
    v_xor_b32 v61, v61, v43
    v_lshlrev_b32 v61, 4, v61
    s_lshl_b32 s6, s3, 4
    v_add_u32 v62, s6, v60
    buffer_load_dwordx4 v3, s[8:11], s56 offen offset:1024 sc1 lds
    s_mov_b32 s12, s66
    s_mov_b32 s13, s67
    s_mov_b32 s14, 1572864
    s_mov_b32 s15, 0x20000
    s_mul_i32 s57, s52, 196608
    v_mul_u32_u24 v6, 3072, v62
    buffer_load_dwordx4 v4, s[8:11], s56 offen offset:2048 sc1 lds
    s_lshl_b32 s53, s50, 3
    s_and_b32 s6, s5, 7
    s_add_u32 s53, s53, s6
    s_and_b32 s54, s4, 1
    s_lshl_b32 s54, s54, 2
    s_add_u32 s54, s54, s51
    s_lshl_b32 s49, s50, 2
    s_add_u32 s49, s49, s51
    s_mov_b32 s63, 0
    buffer_load_dwordx4 v5, s[8:11], s56 offen offset:3072 sc1 lds
    s_add_u32 s6, s51, 1
    s_bitcmp1_b32 s6, 1
    s_cbranch_scc0 L_typeP
    s_lshl_b32 s86, s50, 1
    s_mul_i32 s87, s50, 448
    s_add_u32 s86, s86, s51
    s_sub_u32 s86, s86, 1
    s_lshl_b32 s6, s86, 7
    s_add_u32 s6, s6, 1024
    v_add3_u32 v6, v6, v61, s6
    v_xor_b32 v7, 32, v6
    v_add_u32 v7, 23552, v7
    s_add_u32 s58, s57, 1024
    s_add_u32 m0, s60, 16384
    s_nop 0
    buffer_load_dwordx4 v6, s[12:15], s57 offen sc1 lds
    buffer_load_dwordx4 v7, s[12:15], s57 offen offset:1024 sc1 lds
    s_add_u32 m0, s60, 24576
    s_nop 0
    buffer_load_dwordx4 v6, s[12:15], s58 offen sc1 lds
    buffer_load_dwordx4 v7, s[12:15], s58 offen offset:1024 sc1 lds
    s_branch L_typeR
L_typeP:
    s_lshl_b32 s86, s50, 1
    s_mul_i32 s87, s50, 448
    s_lshr_b32 s7, s51, 1
    s_add_u32 s86, s86, s7
    s_mul_i32 s7, s7, 320
    s_add_u32 s87, s87, s7
    s_lshl_b32 s6, s86, 7
    v_add3_u32 v6, v6, v61, s6
    v_xor_b32 v7, 32, v6
    v_add_u32 v7, 23552, v7
    s_add_u32 m0, s60, 16384
    s_nop 0
    buffer_load_dwordx4 v6, s[12:15], s57 offen sc1 lds
    buffer_load_dwordx4 v7, s[12:15], s57 offen offset:1024 sc1 lds
    s_mov_b32 s16, s72
    s_mov_b32 s17, s73
    s_mov_b32 s18, 1835008
    s_mov_b32 s19, 0x20000
    s_lshl_b32 s6, s87, 1
    s_mul_i32 s58, s52, 229376
    v_mul_u32_u24 v8, 3584, v62
    v_add3_u32 v8, v8, v61, s6
    v_xor_b32 v9, 32, v8
    v_add_u32 v9, 27648, v9
    s_add_u32 m0, s60, 24576
    s_nop 0
    buffer_load_dwordx4 v8, s[16:19], s58 offen sc1 lds
    buffer_load_dwordx4 v9, s[16:19], s58 offen offset:1024 sc1 lds
    s_mov_b32 s20, s74
    s_mov_b32 s21, s75
    s_mov_b32 s22, 1835008
    s_mov_b32 s23, 0x20000
    s_add_u32 m0, s60, 32800
    s_nop 0
    buffer_load_dwordx4 v8, s[20:23], s58 offen sc1 lds
    buffer_load_dwordx4 v9, s[20:23], s58 offen offset:1024 sc1 lds
    v_lshlrev_b32 v1, 4, v0
    s_mov_b32 s32, s84
    s_mov_b32 s33, s85
    s_mov_b32 s34, 17039360
    s_mov_b32 s35, 0x20000
    s_mov_b32 s44, s78
    s_mov_b32 s45, s79
    s_mov_b32 s46, 1024
    s_mov_b32 s47, 0x20000
    buffer_load_dwordx4 v[208:211], v1, s[44:47], 0 offen
    v_add_u32 v40, 12, v0
    v_lshrrev_b32 v41, 4, v40
    v_bfe_u32 v42, v40, 1, 3
    v_and_b32 v40, 1, v40
    v_lshlrev_b32 v41, 16, v41
    v_lshl_add_u32 v41, v42, 7, v41
    v_lshl_add_u32 v41, v40, 4, v41
    s_lshl_b32 s6, s48, 10
    s_add_u32 s6, s6, 16842752
    v_add_u32 v41, s6, v41
    s_lshl_b32 s6, s48, 7
    s_add_u32 s6, s6, 16842752
    v_lshl_add_u32 v40, v0, 4, s6
    s_or_b32 s6, s49, s3
    s_cmp_eq_u32 s6, 0
    s_cselect_b32 s6, 36, 0
    v_cmp_gt_u32 vcc, 4, v0
    v_mov_b32 v44, 0
    v_mov_b32 v45, 0
    v_cndmask_b32 v41, v41, v40, vcc
    v_cmp_gt_u32 vcc, s6, v0
    v_mov_b32 v46, 0
    v_mov_b32 v47, 0
    v_mov_b32 v40, 2146435072
    v_cndmask_b32 v41, v40, v41, vcc
    buffer_store_dwordx4 v[44:47], v41, s[32:35], 0 offen sc1
    s_add_u32 s59, s52, 1
    s_and_b32 s59, s59, 7
    s_lshl_b32 s56, s59, 7
    s_mul_i32 s57, s59, 196608
    s_mul_i32 s58, s59, 229376
    s_add_u32 m0, s61, 41024
    s_nop 0
    buffer_load_dwordx4 v2, s[8:11], s56 offen sc1 lds
    buffer_load_dwordx4 v3, s[8:11], s56 offen offset:1024 sc1 lds
    buffer_load_dwordx4 v4, s[8:11], s56 offen offset:2048 sc1 lds
    buffer_load_dwordx4 v5, s[8:11], s56 offen offset:3072 sc1 lds
    s_add_u32 m0, s60, 57408
    s_nop 0
    buffer_load_dwordx4 v6, s[12:15], s57 offen sc1 lds
    v_lshrrev_b32 v40, 4, v0
    v_and_b32 v41, 15, v0
    v_bfe_u32 v42, v0, 2, 2
    v_and_b32 v43, 3, v0
    v_lshlrev_b32 v43, 3, v43
    v_lshrrev_b32 v44, 5, v0
    v_and_b32 v45, 1, v40
    s_lshr_b32 s6, s3, 1
    s_lshl_b32 s6, s6, 6
    v_add_lshl_u32 v46, s6, v41, 7
    v_lshrrev_b32 v47, 1, v41
    v_xor_b32 v47, v47, v40
    v_lshl_add_u32 v11, v47, 4, v46
    v_xor_b32 v12, 64, v11
    v_lshl_add_u32 v46, v40, 3, v42
    s_and_b32 s7, s3, 1
    v_lshrrev_b32 v47, 1, v42
    v_xor_b32 v47, s7, v47
    v_lshl_add_u32 v47, v47, 1, v45
    v_lshl_add_u32 v47, v47, 5, v43
    v_lshl_add_u32 v47, v46, 7, v47
    v_add_u32 v13, 16384, v47
    v_xor_b32 v14, 32, v13
    s_mov_b32 s40, s82
    s_mov_b32 s41, s83
    s_mov_b32 s42, 256
    s_mov_b32 s43, 0x20000
    s_mov_b32 s24, s76
    s_mov_b32 s25, s77
    s_mov_b32 s26, 1835008
    s_mov_b32 s27, 0x20000
    s_mov_b32 s28, s68
    s_mov_b32 s29, s69
    s_mov_b32 s30, 524288
    s_mov_b32 s31, 0x20000
    s_mov_b32 s36, s80
    s_mov_b32 s37, s81
    s_mov_b32 s38, 2097152
    s_mov_b32 s39, 0x20000
    s_lshl_b32 s6, s48, 4
    s_or_b32 s7, s49, s3
    s_cmp_eq_u32 s7, 0
    s_cselect_b32 s6, s6, 2146435072
    v_mov_b32 v23, 2146435072
    v_writelane_b32 v23, s6, 0
    s_lshl_b32 s6, s48, 3
    s_add_u32 s6, s6, s86
    s_lshl_b32 s6, s6, 2
    s_add_u32 s6, s6, s3
    s_lshl_b32 s100, s6, 12
    s_lshl_b32 s101, s6, 5
    s_add_u32 s101, s101, 16777216
    s_lshl_b32 s7, s6, 10
    v_min_u32 v46, 7, v0
    v_lshl_add_u32 v52, v46, 7, s7
    s_mul_i32 s7, s6, 3584
    v_min_u32 v46, 27, v0
    v_lshl_add_u32 v51, v46, 7, s7
    s_and_b32 s7, s3, 1
    s_lshl_b32 s6, s86, 1
    s_add_u32 s6, s6, s7
    s_lshl_b32 s6, s6, 7
    s_lshl_b32 s99, s48, 2
    s_and_b32 s98, s3, 2
    s_add_u32 s99, s99, s98
    s_sub_u32 s46, s99, 8
    s_add_u32 s6, s6, s99
    s_lshl_b32 s96, s6, 10
    s_add_u32 s97, s96, 65536
    s_mul_i32 s99, s99, 144
    s_lshr_b32 s6, s87, 4
    s_add_u32 s99, s99, s6
    s_mul_i32 s7, s7, 2
    s_add_u32 s99, s99, s7
    s_lshl_b32 s98, s99, 10
    s_add_u32 s98, s98, 6291456
    s_add_u32 s99, s98, 147456
    s_lshl_b32 s6, s48, 2
    s_add_u32 s6, s6, s50
    s_lshl_b32 s6, s6, 1
    s_lshr_b32 s7, s3, 1
    s_add_u32 s6, s6, s7
    s_lshl_b32 s6, s6, 5
    s_lshl_b32 s7, s51, 1
    s_add_u32 s6, s6, s7
    s_and_b32 s7, s3, 1
    s_add_u32 s6, s6, s7
    s_lshl_b32 s6, s6, 2
    s_add_u32 s6, s6, 16908288
    s_lshl_b32 s7, s48, 5
    s_add_u32 s7, s7, s49
    s_lshl_b32 s7, s7, 2
    s_add_u32 s7, s7, 16842752
    s_cmp_eq_u32 s3, 0
    s_cselect_b32 s7, s7, 2146435072
    s_cselect_b32 s47, 16, 0
    s_and_b32 s49, s3, 1
    s_lshl_b32 s86, s86, 1
    s_add_u32 s49, s49, s86
    s_lshl_b32 s49, s49, 1
    s_add_u32 s49, s49, 0
    v_mov_b32 v18, 2146435072
    v_mov_b32 v19, 2146435072
    v_writelane_b32 v18, s7, 0
    v_writelane_b32 v19, s6, 0
    v_cmp_gt_u32 vcc, s47, v0
    v_mov_b32 v70, 2146435072
    v_mov_b32 v22, 0
    v_cndmask_b32 v21, v70, v1, vcc
    v_cndmask_b32 v22, 0, 1, vcc
    s_lshl_b32 s6, s54, 7
    v_lshlrev_b32 v24, 10, v60
    v_add3_u32 v24, v24, v61, s6
    v_add_u32 v25, 7168, v24
    v_add_u32 v26, 14336, v24
    v_add_u32 v27, 21504, v24
    s_and_b32 s6, s53, 3
    s_lshl_b32 s55, s6, 1
    v_lshl_add_u32 v65, v44, 2, v42
    v_lshrrev_b32 v64, 1, v42
    s_lshr_b32 s6, s3, 1
    v_xor_b32 v64, s6, v64
    v_lshl_add_u32 v64, v64, 6, v43
    v_lshl_add_u32 v64, v65, 7, v64
    v_lshl_add_u32 v64, v45, 5, v64
    v_add_u32 v64, s61, v64
    v_xor_b32 v65, 64, v64
    v_add_u32 v66, 0x10000, v64
    v_add_u32 v67, 0x10000, v65
    v_add_u32 v68, 0x20000, v64
    v_add_u32 v69, 0x20000, v65
    v_lshl_add_u32 v46, v44, 4, v41
    v_lshl_add_u32 v62, v45, 5, v46
    v_lshlrev_b32 v62, 4, v62
    v_lshl_add_u32 v47, v45, 4, v41
    v_lshlrev_b32 v47, 4, v47
    v_lshl_add_u32 v17, v44, 17, v47
    v_add_u32 v17, 1024, v17
    s_and_b32 s6, s3, 1
    s_mul_i32 s6, s6, 24960
    s_lshr_b32 s7, s3, 1
    s_mul_i32 s7, s7, 4160
    s_add_u32 s6, s6, s7
    s_add_u32 s6, s6, 113856
    v_add_u32 v28, s6, v1
    v_lshl_add_u32 v29, v46, 4, s6
    v_add_u32 v29, 1024, v29
    s_add_u32 s6, s6, 4096
    v_mov_b32 v59, s6
    v_cmp_eq_u32 s[44:45], 1, v45
    v_min_u32 v46, 11, v0
    v_mul_u32_u24 v63, 4160, v46
    v_add_u32 v63, 117952, v63
    v_subrev_u32 v47, 6, v46
    v_min_u32 v46, v46, v47
    s_lshl_b32 s7, s48, 1
    s_sub_u32 s7, 4, s7
    v_mov_b32 v60, 0x3f803f80
    v_cmp_le_i32 vcc, s7, v46
    v_and_b32 v30, 31, v0
    v_lshlrev_b32 v31, 2, v44
    v_cndmask_b32 v60, 0, v60, vcc
    v_mov_b32 v61, v60
    v_sub_u32 v30, v30, v31
    v_cmp_gt_i32 s[64:65], 0, v30
    v_cmp_gt_i32 s[66:67], 1, v30
    v_cmp_gt_i32 s[68:69], 2, v30
    v_cmp_gt_i32 s[70:71], 3, v30
    v_cmp_gt_i32 s[72:73], 8, v30
    v_cmp_gt_i32 s[74:75], 9, v30
    v_cmp_gt_i32 s[76:77], 10, v30
    v_cmp_gt_i32 s[78:79], 11, v30
    v_cmp_gt_i32 s[80:81], 16, v30
    v_cmp_gt_i32 s[82:83], 17, v30
    v_cmp_gt_i32 s[84:85], 18, v30
    v_cmp_gt_i32 s[86:87], 19, v30
    v_cmp_gt_i32 s[88:89], 24, v30
    v_cmp_gt_i32 s[90:91], 25, v30
    v_cmp_gt_i32 s[92:93], 26, v30
    v_cmp_gt_i32 s[94:95], 27, v30
    v_mov_b32 v46, 0xffff
    v_mov_b32 v47, 0xffff0000
    v_cndmask_b32 v32, 0, v46, s[64:65]
    v_cndmask_b32 v48, 0, v47, s[66:67]
    v_or_b32 v32, v32, v48
    v_cndmask_b32 v33, 0, v46, s[68:69]
    v_cndmask_b32 v48, 0, v47, s[70:71]
    v_or_b32 v33, v33, v48
    v_cndmask_b32 v34, 0, v46, s[72:73]
    v_cndmask_b32 v48, 0, v47, s[74:75]
    v_or_b32 v34, v34, v48
    v_cndmask_b32 v35, 0, v46, s[76:77]
    v_cndmask_b32 v48, 0, v47, s[78:79]
    v_or_b32 v35, v35, v48
    v_cndmask_b32 v36, 0, v46, s[80:81]
    v_cndmask_b32 v48, 0, v47, s[82:83]
    v_or_b32 v36, v36, v48
    v_cndmask_b32 v37, 0, v46, s[84:85]
    v_cndmask_b32 v48, 0, v47, s[86:87]
    v_or_b32 v37, v37, v48
    v_cndmask_b32 v38, 0, v46, s[88:89]
    v_cndmask_b32 v48, 0, v47, s[90:91]
    v_or_b32 v38, v38, v48
    v_cndmask_b32 v39, 0, v46, s[92:93]
    v_cndmask_b32 v48, 0, v47, s[94:95]
    v_or_b32 v39, v39, v48
    v_mov_b32 v20, 1
    s_mov_b32 s4, 0xbfb8aa3b
    s_mov_b32 s5, 0xbfb8aa3b
    buffer_load_dwordx4 v7, s[12:15], s57 offen offset:1024 sc1 lds
    s_add_u32 m0, s60, 65600
    s_nop 0
    buffer_load_dwordx4 v8, s[16:19], s58 offen sc1 lds
    buffer_load_dwordx4 v9, s[16:19], s58 offen offset:1024 sc1 lds
    s_add_u32 m0, s60, 73824
    s_nop 0
    buffer_load_dwordx4 v8, s[20:23], s58 offen sc1 lds
    buffer_load_dwordx4 v9, s[20:23], s58 offen offset:1024 sc1 lds
    s_waitcnt vmcnt(12)
    s_barrier
    ds_read_b128 a[0:3], v11 offset:0
    ds_read_b64_tr_b16 v[72:73], v13 offset:0
    ds_read_b64_tr_b16 v[74:75], v13 offset:512
    ds_read_b128 a[4:7], v11 offset:2048
    ds_read_b128 a[8:11], v11 offset:4096
    ds_read_b128 a[12:15], v11 offset:6144
    ds_read_b64_tr_b16 v[76:77], v14 offset:0
    ds_read_b64_tr_b16 v[78:79], v14 offset:512
    s_add_u32 s59, s52, 2
    s_and_b32 s59, s59, 7
    s_waitcnt lgkmcnt(5)
    v_mfma_f32_16x16x32_bf16 v[96:99], v[72:75], a[0:3], 0
    ds_read_b64_tr_b16 v[80:81], v13 offset:8192
    ds_read_b64_tr_b16 v[82:83], v13 offset:8704
    s_waitcnt lgkmcnt(6)
    v_mfma_f32_16x16x32_bf16 v[100:103], v[72:75], a[4:7], 0
    ds_read_b128 a[16:19], v12 offset:0
    s_lshl_b32 s56, s59, 7
    s_waitcnt lgkmcnt(3)
    v_mfma_f32_16x16x32_bf16 v[108:111], v[76:79], a[4:7], 0
    s_mul_i32 s57, s59, 196608
    s_mul_i32 s58, s59, 229376
    s_add_u32 m0, s61, 82048
    v_mfma_f32_16x16x32_bf16 v[104:107], v[76:79], a[0:3], 0
    v_add_u32 v11, 41024, v11
    v_mfma_f32_16x16x32_bf16 v[112:115], v[72:75], a[8:11], 0
    ds_read_b64_tr_b16 v[84:85], v13 offset:16416
    ds_read_b64_tr_b16 v[86:87], v13 offset:16928
    v_mfma_f32_16x16x32_bf16 v[116:119], v[72:75], a[12:15], 0
    ds_read_b128 a[20:23], v12 offset:2048
    v_mfma_f32_16x16x32_bf16 v[124:127], v[76:79], a[12:15], 0
    buffer_load_dwordx4 v2, s[8:11], s56 offen sc1 lds
    v_mfma_f32_16x16x32_bf16 v[120:123], v[76:79], a[8:11], 0
    s_add_u32 s59, s52, 3
    s_and_b32 s59, s59, 7
    s_waitcnt lgkmcnt(1)
    v_mfma_f32_16x16x32_bf16 v[128:131], v[80:83], a[0:3], 0
    ds_read_b64_tr_b16 v[88:89], v14 offset:8192
    ds_read_b64_tr_b16 v[90:91], v14 offset:8704
    v_mfma_f32_16x16x32_bf16 v[132:135], v[80:83], a[4:7], 0
    ds_read_b128 a[24:27], v12 offset:4096
    v_mfma_f32_16x16x32_bf16 v[144:147], v[80:83], a[8:11], 0
    buffer_load_dwordx4 v3, s[8:11], s56 offen offset:1024 sc1 lds
    v_mfma_f32_16x16x32_bf16 v[148:151], v[80:83], a[12:15], 0
    v_mfma_f32_16x16x32_bf16 v[156:159], v[84:87], a[12:15], 0
    ds_read_b64_tr_b16 v[92:93], v14 offset:16416
    ds_read_b64_tr_b16 v[94:95], v14 offset:16928
    v_mfma_f32_16x16x32_bf16 v[152:155], v[84:87], a[8:11], 0
    ds_read_b128 a[28:31], v12 offset:6144
    v_mfma_f32_16x16x32_bf16 v[140:143], v[84:87], a[4:7], 0
    buffer_load_dwordx4 v4, s[8:11], s56 offen offset:2048 sc1 lds
    v_mfma_f32_16x16x32_bf16 v[136:139], v[84:87], a[0:3], 0
    v_add_u32 v12, 41024, v12
    s_waitcnt lgkmcnt(1)
    v_mfma_f32_16x16x32_bf16 v[160:163], v[88:91], a[0:3], 0
    ds_read_b64_tr_b16 v[72:73], v13 offset:4096
    ds_read_b64_tr_b16 v[74:75], v13 offset:4608
    v_mfma_f32_16x16x32_bf16 v[164:167], v[88:91], a[4:7], 0
    ds_read_b64_tr_b16 v[76:77], v14 offset:4096
    ds_read_b64_tr_b16 v[78:79], v14 offset:4608
    v_mfma_f32_16x16x32_bf16 v[176:179], v[88:91], a[8:11], 0
    buffer_load_dwordx4 v5, s[8:11], s56 offen offset:3072 sc1 lds
    v_mfma_f32_16x16x32_bf16 v[180:183], v[88:91], a[12:15], 0
    s_add_u32 m0, s60, 98432
    s_lshl_b32 s56, s59, 7
    v_mfma_f32_16x16x32_bf16 v[188:191], v[92:95], a[12:15], 0
    ds_read_b64_tr_b16 v[80:81], v13 offset:12288
    ds_read_b64_tr_b16 v[82:83], v13 offset:12800
    v_mfma_f32_16x16x32_bf16 v[184:187], v[92:95], a[8:11], 0
    ds_read_b64_tr_b16 v[84:85], v13 offset:20512
    ds_read_b64_tr_b16 v[86:87], v13 offset:21024
    v_mfma_f32_16x16x32_bf16 v[172:175], v[92:95], a[4:7], 0
    buffer_load_dwordx4 v6, s[12:15], s57 offen sc1 lds
    v_mfma_f32_16x16x32_bf16 v[168:171], v[92:95], a[0:3], 0
    s_waitcnt lgkmcnt(2)
    v_mfma_f32_16x16x32_bf16 v[96:99], v[72:75], a[16:19], v[96:99]
    ds_read_b64_tr_b16 v[88:89], v14 offset:12288
    ds_read_b64_tr_b16 v[90:91], v14 offset:12800
    v_mfma_f32_16x16x32_bf16 v[100:103], v[72:75], a[20:23], v[100:103]
    buffer_load_dwordx4 v7, s[12:15], s57 offen offset:1024 sc1 lds
    v_mfma_f32_16x16x32_bf16 v[112:115], v[72:75], a[24:27], v[112:115]
    s_add_u32 m0, s60, 106624
    s_mul_i32 s57, s59, 196608
    v_mfma_f32_16x16x32_bf16 v[116:119], v[72:75], a[28:31], v[116:119]
    v_mfma_f32_16x16x32_bf16 v[124:127], v[76:79], a[28:31], v[124:127]
    ds_read_b64_tr_b16 v[92:93], v14 offset:20512
    ds_read_b64_tr_b16 v[94:95], v14 offset:21024
    v_mfma_f32_16x16x32_bf16 v[120:123], v[76:79], a[24:27], v[120:123]
    v_add_u32 v13, 41024, v13
    v_add_u32 v14, 41024, v14
    v_mfma_f32_16x16x32_bf16 v[108:111], v[76:79], a[20:23], v[108:111]
    buffer_load_dwordx4 v8, s[16:19], s58 offen sc1 lds
    v_mfma_f32_16x16x32_bf16 v[104:107], v[76:79], a[16:19], v[104:107]
    v_mfma_f32_16x16x32_bf16 v[128:131], v[80:83], a[16:19], v[128:131]
    buffer_load_dwordx4 v9, s[16:19], s58 offen offset:1024 sc1 lds
    v_mfma_f32_16x16x32_bf16 v[132:135], v[80:83], a[20:23], v[132:135]
    s_add_u32 m0, s60, 114848
    v_mfma_f32_16x16x32_bf16 v[144:147], v[80:83], a[24:27], v[144:147]
    buffer_load_dwordx4 v8, s[20:23], s58 offen sc1 lds
    v_mfma_f32_16x16x32_bf16 v[148:151], v[80:83], a[28:31], v[148:151]
    s_waitcnt vmcnt(9) lgkmcnt(0)
    s_barrier
    v_mfma_f32_16x16x32_bf16 v[156:159], v[84:87], a[28:31], v[156:159]
    ds_read_b64_tr_b16 v[72:73], v13 offset:0
    ds_read_b64_tr_b16 v[74:75], v13 offset:512
    v_mfma_f32_16x16x32_bf16 v[152:155], v[84:87], a[24:27], v[152:155]
    buffer_load_dwordx4 v9, s[20:23], s58 offen offset:1024 sc1 lds
    v_mfma_f32_16x16x32_bf16 v[140:143], v[84:87], a[20:23], v[140:143]
    s_add_u32 m0, s61, 0
    s_mul_i32 s58, s59, 229376
    v_mfma_f32_16x16x32_bf16 v[136:139], v[84:87], a[16:19], v[136:139]
    v_mov_b32 v236, 0x3f803f80
    v_mfma_f32_16x16x32_bf16 v[160:163], v[88:91], a[16:19], v[160:163]
    ds_read_b64_tr_b16 v[76:77], v14 offset:0
    ds_read_b64_tr_b16 v[78:79], v14 offset:512
    v_mfma_f32_16x16x32_bf16 v[164:167], v[88:91], a[20:23], v[164:167]
    ds_read_b128 a[32:35], v11 offset:0
    v_lshlrev_b32 v212, 16, v208
    v_mfma_f32_16x16x32_bf16 v[176:179], v[88:91], a[24:27], v[176:179]
    buffer_load_dwordx4 v2, s[8:11], s56 offen sc1 lds
    v_mfma_f32_16x16x32_bf16 v[180:183], v[88:91], a[28:31], v[180:183]
    ds_read_b128 a[36:39], v11 offset:2048
    v_mfma_f32_16x16x32_bf16 v[188:191], v[92:95], a[28:31], v[188:191]
    ds_read_b64_tr_b16 v[80:81], v13 offset:8192
    ds_read_b64_tr_b16 v[82:83], v13 offset:8704
    v_mfma_f32_16x16x32_bf16 v[184:187], v[92:95], a[24:27], v[184:187]
    ds_read_b128 a[40:43], v11 offset:4096
    s_add_u32 s59, s52, 4
    v_mfma_f32_16x16x32_bf16 v[172:175], v[92:95], a[20:23], v[172:175]
    s_and_b32 s59, s59, 7
    v_and_b32 v213, 0xffff0000, v208
    v_mfma_f32_16x16x32_bf16 v[168:171], v[92:95], a[16:19], v[168:171]
    ds_read_b128 a[44:47], v11 offset:6144
    s_waitcnt lgkmcnt(2)
    v_mfma_f32_16x16x32_bf16 v[96:99], v[72:75], a[32:35], v[96:99]
    ds_read_b64_tr_b16 v[84:85], v13 offset:16416
    ds_read_b64_tr_b16 v[86:87], v13 offset:16928
    v_mfma_f32_16x16x32_bf16 v[100:103], v[72:75], a[36:39], v[100:103]
    ds_read_b128 a[48:51], v12 offset:0
    v_add_u32 v11, 41024, v11
    v_mfma_f32_16x16x32_bf16 v[108:111], v[76:79], a[36:39], v[108:111]
    buffer_load_dwordx4 v3, s[8:11], s56 offen offset:1024 sc1 lds
    v_mfma_f32_16x16x32_bf16 v[104:107], v[76:79], a[32:35], v[104:107]
    v_lshlrev_b32 v214, 16, v209
    s_waitcnt lgkmcnt(1)
    v_mfma_f32_16x16x32_bf16 v[112:115], v[72:75], a[40:43], v[112:115]
    ds_read_b64_tr_b16 v[88:89], v14 offset:8192
    ds_read_b64_tr_b16 v[90:91], v14 offset:8704
    v_mfma_f32_16x16x32_bf16 v[116:119], v[72:75], a[44:47], v[116:119]
    ds_read_b128 a[52:55], v12 offset:2048
    v_and_b32 v215, 0xffff0000, v209
    v_mfma_f32_16x16x32_bf16 v[124:127], v[76:79], a[44:47], v[124:127]
    buffer_load_dwordx4 v4, s[8:11], s56 offen offset:2048 sc1 lds
    v_mfma_f32_16x16x32_bf16 v[120:123], v[76:79], a[40:43], v[120:123]
    v_lshlrev_b32 v216, 16, v210
    v_mfma_f32_16x16x32_bf16 v[128:131], v[80:83], a[32:35], v[128:131]
    ds_read_b64_tr_b16 v[92:93], v14 offset:16416
    ds_read_b64_tr_b16 v[94:95], v14 offset:16928
    v_mfma_f32_16x16x32_bf16 v[132:135], v[80:83], a[36:39], v[132:135]
    ds_read_b128 a[56:59], v12 offset:4096
    v_and_b32 v217, 0xffff0000, v210
    v_mfma_f32_16x16x32_bf16 v[144:147], v[80:83], a[40:43], v[144:147]
    buffer_load_dwordx4 v5, s[8:11], s56 offen offset:3072 sc1 lds
    v_mfma_f32_16x16x32_bf16 v[148:151], v[80:83], a[44:47], v[148:151]
    s_add_u32 m0, s60, 16384
    s_lshl_b32 s56, s59, 7
    v_mfma_f32_16x16x32_bf16 v[156:159], v[84:87], a[44:47], v[156:159]
    ds_read_b64_tr_b16 v[72:73], v13 offset:4096
    ds_read_b64_tr_b16 v[74:75], v13 offset:4608
    v_mfma_f32_16x16x32_bf16 v[152:155], v[84:87], a[40:43], v[152:155]
    ds_read_b128 a[60:63], v12 offset:6144
    v_lshlrev_b32 v218, 16, v211
    v_mfma_f32_16x16x32_bf16 v[140:143], v[84:87], a[36:39], v[140:143]
    buffer_load_dwordx4 v6, s[12:15], s57 offen sc1 lds
    v_mfma_f32_16x16x32_bf16 v[136:139], v[84:87], a[32:35], v[136:139]
    v_add_u32 v12, 41024, v12
    s_waitcnt lgkmcnt(1)
    v_mfma_f32_16x16x32_bf16 v[160:163], v[88:91], a[32:35], v[160:163]
    ds_read_b64_tr_b16 v[76:77], v14 offset:4096
    ds_read_b64_tr_b16 v[78:79], v14 offset:4608
    v_mfma_f32_16x16x32_bf16 v[164:167], v[88:91], a[36:39], v[164:167]
    ds_read_b64_tr_b16 v[80:81], v13 offset:12288
    ds_read_b64_tr_b16 v[82:83], v13 offset:12800
    v_mfma_f32_16x16x32_bf16 v[176:179], v[88:91], a[40:43], v[176:179]
    buffer_load_dwordx4 v7, s[12:15], s57 offen offset:1024 sc1 lds
    v_mfma_f32_16x16x32_bf16 v[180:183], v[88:91], a[44:47], v[180:183]
    s_add_u32 m0, s60, 24576
    s_mul_i32 s57, s59, 196608
    v_mfma_f32_16x16x32_bf16 v[188:191], v[92:95], a[44:47], v[188:191]
    ds_read_b64_tr_b16 v[84:85], v13 offset:20512
    ds_read_b64_tr_b16 v[86:87], v13 offset:21024
    v_mfma_f32_16x16x32_bf16 v[184:187], v[92:95], a[40:43], v[184:187]
    buffer_load_dwordx4 v8, s[16:19], s58 offen sc1 lds
    v_mfma_f32_16x16x32_bf16 v[172:175], v[92:95], a[36:39], v[172:175]
    buffer_load_dwordx4 v9, s[16:19], s58 offen offset:1024 sc1 lds
    v_mfma_f32_16x16x32_bf16 v[168:171], v[92:95], a[32:35], v[168:171]
    s_add_u32 m0, s60, 32800
    v_mfma_f32_16x16x32_bf16 v[96:99], v[72:75], a[48:51], v[96:99]
    ds_read_b64_tr_b16 v[88:89], v14 offset:12288
    ds_read_b64_tr_b16 v[90:91], v14 offset:12800
    v_mfma_f32_16x16x32_bf16 v[100:103], v[72:75], a[52:55], v[100:103]
    v_and_b32 v219, 0xffff0000, v211
    v_mfma_f32_16x16x32_bf16 v[112:115], v[72:75], a[56:59], v[112:115]
    buffer_load_dwordx4 v8, s[20:23], s58 offen sc1 lds
    s_waitcnt lgkmcnt(2)
    v_mfma_f32_16x16x32_bf16 v[116:119], v[72:75], a[60:63], v[116:119]
    v_mfma_f32_16x16x32_bf16 v[124:127], v[76:79], a[60:63], v[124:127]
    ds_read_b64_tr_b16 v[92:93], v14 offset:20512
    ds_read_b64_tr_b16 v[94:95], v14 offset:21024
    v_mfma_f32_16x16x32_bf16 v[120:123], v[76:79], a[56:59], v[120:123]
    v_add_u32 v13, 41024, v13
    v_add_u32 v14, 41024, v14
    v_mfma_f32_16x16x32_bf16 v[108:111], v[76:79], a[52:55], v[108:111]
    buffer_load_dwordx4 v9, s[20:23], s58 offen offset:1024 sc1 lds
    v_mfma_f32_16x16x32_bf16 v[104:107], v[76:79], a[48:51], v[104:107]
    s_add_u32 m0, s61, 41024
    s_mul_i32 s58, s59, 229376
    v_mfma_f32_16x16x32_bf16 v[128:131], v[80:83], a[48:51], v[128:131]
    v_mfma_f32_16x16x32_bf16 v[132:135], v[80:83], a[52:55], v[132:135]
    v_mfma_f32_16x16x32_bf16 v[144:147], v[80:83], a[56:59], v[144:147]
    buffer_store_dword v20, v23, s[40:43], 0 offen sc1
    v_mfma_f32_16x16x32_bf16 v[148:151], v[80:83], a[60:63], v[148:151]
    s_waitcnt vmcnt(11) lgkmcnt(0)
    s_barrier
    v_mfma_f32_16x16x32_bf16 v[156:159], v[84:87], a[60:63], v[156:159]
    ds_read_b64_tr_b16 v[72:73], v13 offset:0
    ds_read_b64_tr_b16 v[74:75], v13 offset:512
    v_mfma_f32_16x16x32_bf16 v[152:155], v[84:87], a[56:59], v[152:155]
    v_mfma_f32_16x16x32_bf16 v[140:143], v[84:87], a[52:55], v[140:143]
    buffer_load_dwordx4 v[192:195], v1, s[8:11], s100 offen offset:0
    v_mfma_f32_16x16x32_bf16 v[136:139], v[84:87], a[48:51], v[136:139]
    v_mfma_f32_16x16x32_bf16 v[160:163], v[88:91], a[48:51], v[160:163]
    ds_read_b64_tr_b16 v[76:77], v14 offset:0
    ds_read_b64_tr_b16 v[78:79], v14 offset:512
    v_mfma_f32_16x16x32_bf16 v[164:167], v[88:91], a[52:55], v[164:167]
    ds_read_b128 a[64:67], v11 offset:0
    v_mfma_f32_16x16x32_bf16 v[176:179], v[88:91], a[56:59], v[176:179]
    buffer_load_dwordx4 v2, s[8:11], s56 offen sc1 lds
    v_mfma_f32_16x16x32_bf16 v[180:183], v[88:91], a[60:63], v[180:183]
    ds_read_b128 a[68:71], v11 offset:2048
    v_mfma_f32_16x16x32_bf16 v[188:191], v[92:95], a[60:63], v[188:191]
    ds_read_b64_tr_b16 v[80:81], v13 offset:8192
    ds_read_b64_tr_b16 v[82:83], v13 offset:8704
    v_mfma_f32_16x16x32_bf16 v[184:187], v[92:95], a[56:59], v[184:187]
    ds_read_b128 a[72:75], v11 offset:4096
    s_add_u32 s59, s52, 5
    v_mfma_f32_16x16x32_bf16 v[172:175], v[92:95], a[52:55], v[172:175]
    s_and_b32 s59, s59, 7
    v_mfma_f32_16x16x32_bf16 v[168:171], v[92:95], a[48:51], v[168:171]
    ds_read_b128 a[76:79], v11 offset:6144
    s_waitcnt lgkmcnt(2)
    v_mfma_f32_16x16x32_bf16 v[96:99], v[72:75], a[64:67], v[96:99]
    ds_read_b64_tr_b16 v[84:85], v13 offset:16416
    ds_read_b64_tr_b16 v[86:87], v13 offset:16928
    v_mfma_f32_16x16x32_bf16 v[100:103], v[72:75], a[68:71], v[100:103]
    ds_read_b128 a[80:83], v12 offset:0
    v_subrev_u32 v11, 82048, v11
    v_mfma_f32_16x16x32_bf16 v[108:111], v[76:79], a[68:71], v[108:111]
    buffer_load_dwordx4 v3, s[8:11], s56 offen offset:1024 sc1 lds
    v_mfma_f32_16x16x32_bf16 v[104:107], v[76:79], a[64:67], v[104:107]
    s_waitcnt lgkmcnt(1)
    v_mfma_f32_16x16x32_bf16 v[112:115], v[72:75], a[72:75], v[112:115]
    ds_read_b64_tr_b16 v[88:89], v14 offset:8192
    ds_read_b64_tr_b16 v[90:91], v14 offset:8704
    v_mfma_f32_16x16x32_bf16 v[116:119], v[72:75], a[76:79], v[116:119]
    ds_read_b128 a[84:87], v12 offset:2048
    v_mfma_f32_16x16x32_bf16 v[124:127], v[76:79], a[76:79], v[124:127]
    buffer_load_dwordx4 v4, s[8:11], s56 offen offset:2048 sc1 lds
    v_mfma_f32_16x16x32_bf16 v[120:123], v[76:79], a[72:75], v[120:123]
    v_mfma_f32_16x16x32_bf16 v[128:131], v[80:83], a[64:67], v[128:131]
    ds_read_b64_tr_b16 v[92:93], v14 offset:16416
    ds_read_b64_tr_b16 v[94:95], v14 offset:16928
    v_mfma_f32_16x16x32_bf16 v[132:135], v[80:83], a[68:71], v[132:135]
    ds_read_b128 a[88:91], v12 offset:4096
    v_mfma_f32_16x16x32_bf16 v[144:147], v[80:83], a[72:75], v[144:147]
    buffer_load_dwordx4 v5, s[8:11], s56 offen offset:3072 sc1 lds
    v_mfma_f32_16x16x32_bf16 v[148:151], v[80:83], a[76:79], v[148:151]
    s_add_u32 m0, s60, 57408
    s_lshl_b32 s56, s59, 7
    v_mfma_f32_16x16x32_bf16 v[156:159], v[84:87], a[76:79], v[156:159]
    ds_read_b64_tr_b16 v[72:73], v13 offset:4096
    ds_read_b64_tr_b16 v[74:75], v13 offset:4608
    v_mfma_f32_16x16x32_bf16 v[152:155], v[84:87], a[72:75], v[152:155]
    ds_read_b128 a[92:95], v12 offset:6144
    v_mfma_f32_16x16x32_bf16 v[140:143], v[84:87], a[68:71], v[140:143]
    buffer_load_dwordx4 v6, s[12:15], s57 offen sc1 lds
    v_mfma_f32_16x16x32_bf16 v[136:139], v[84:87], a[64:67], v[136:139]
    v_subrev_u32 v12, 82048, v12
    s_waitcnt lgkmcnt(1)
    v_mfma_f32_16x16x32_bf16 v[160:163], v[88:91], a[64:67], v[160:163]
    ds_read_b64_tr_b16 v[76:77], v14 offset:4096
    ds_read_b64_tr_b16 v[78:79], v14 offset:4608
    v_mfma_f32_16x16x32_bf16 v[164:167], v[88:91], a[68:71], v[164:167]
    ds_read_b64_tr_b16 v[80:81], v13 offset:12288
    ds_read_b64_tr_b16 v[82:83], v13 offset:12800
    v_mfma_f32_16x16x32_bf16 v[176:179], v[88:91], a[72:75], v[176:179]
    buffer_load_dwordx4 v7, s[12:15], s57 offen offset:1024 sc1 lds
    v_mfma_f32_16x16x32_bf16 v[180:183], v[88:91], a[76:79], v[180:183]
    s_add_u32 m0, s60, 65600
    s_mul_i32 s57, s59, 196608
    v_mfma_f32_16x16x32_bf16 v[188:191], v[92:95], a[76:79], v[188:191]
    ds_read_b64_tr_b16 v[84:85], v13 offset:20512
    ds_read_b64_tr_b16 v[86:87], v13 offset:21024
    v_mfma_f32_16x16x32_bf16 v[184:187], v[92:95], a[72:75], v[184:187]
    buffer_load_dwordx4 v8, s[16:19], s58 offen sc1 lds
    v_mfma_f32_16x16x32_bf16 v[172:175], v[92:95], a[68:71], v[172:175]
    buffer_load_dwordx4 v9, s[16:19], s58 offen offset:1024 sc1 lds
    v_mfma_f32_16x16x32_bf16 v[168:171], v[92:95], a[64:67], v[168:171]
    s_add_u32 m0, s60, 73824
    v_mfma_f32_16x16x32_bf16 v[96:99], v[72:75], a[80:83], v[96:99]
    ds_read_b64_tr_b16 v[88:89], v14 offset:12288
    ds_read_b64_tr_b16 v[90:91], v14 offset:12800
    v_mfma_f32_16x16x32_bf16 v[100:103], v[72:75], a[84:87], v[100:103]
    v_mfma_f32_16x16x32_bf16 v[112:115], v[72:75], a[88:91], v[112:115]
    buffer_load_dwordx4 v8, s[20:23], s58 offen sc1 lds
    s_waitcnt lgkmcnt(2)
    v_mfma_f32_16x16x32_bf16 v[116:119], v[72:75], a[92:95], v[116:119]
    v_mfma_f32_16x16x32_bf16 v[124:127], v[76:79], a[92:95], v[124:127]
    ds_read_b64_tr_b16 v[92:93], v14 offset:20512
    ds_read_b64_tr_b16 v[94:95], v14 offset:21024
    v_mfma_f32_16x16x32_bf16 v[120:123], v[76:79], a[88:91], v[120:123]
    v_subrev_u32 v13, 82048, v13
    v_subrev_u32 v14, 82048, v14
    v_mfma_f32_16x16x32_bf16 v[108:111], v[76:79], a[84:87], v[108:111]
    buffer_load_dwordx4 v9, s[20:23], s58 offen offset:1024 sc1 lds
    v_mfma_f32_16x16x32_bf16 v[104:107], v[76:79], a[80:83], v[104:107]
    s_add_u32 m0, s61, 82048
    s_mul_i32 s58, s59, 229376
    v_mfma_f32_16x16x32_bf16 v[128:131], v[80:83], a[80:83], v[128:131]
    s_waitcnt vmcnt(10)
    v_lshlrev_b32 v220, 16, v192
    v_and_b32 v221, 0xffff0000, v192
    v_mfma_f32_16x16x32_bf16 v[132:135], v[80:83], a[84:87], v[132:135]
    v_lshlrev_b32 v222, 16, v193
    v_and_b32 v223, 0xffff0000, v193
    v_mfma_f32_16x16x32_bf16 v[144:147], v[80:83], a[88:91], v[144:147]
    buffer_load_dword v54, v51, s[24:27], 0 offen
    v_mfma_f32_16x16x32_bf16 v[148:151], v[80:83], a[92:95], v[148:151]
    s_waitcnt lgkmcnt(0)
    s_barrier
    v_mfma_f32_16x16x32_bf16 v[156:159], v[84:87], a[92:95], v[156:159]
    ds_read_b64_tr_b16 v[72:73], v13 offset:0
    ds_read_b64_tr_b16 v[74:75], v13 offset:512
    v_mfma_f32_16x16x32_bf16 v[152:155], v[84:87], a[88:91], v[152:155]
    v_lshlrev_b32 v224, 16, v194
    v_and_b32 v225, 0xffff0000, v194
    v_mfma_f32_16x16x32_bf16 v[140:143], v[84:87], a[84:87], v[140:143]
    v_lshlrev_b32 v226, 16, v195
    v_and_b32 v227, 0xffff0000, v195
    v_mfma_f32_16x16x32_bf16 v[136:139], v[84:87], a[80:83], v[136:139]
    buffer_load_dword v55, v52, s[28:31], 0 offen
    v_mfma_f32_16x16x32_bf16 v[160:163], v[88:91], a[80:83], v[160:163]
    ds_read_b64_tr_b16 v[76:77], v14 offset:0
    ds_read_b64_tr_b16 v[78:79], v14 offset:512
    v_mfma_f32_16x16x32_bf16 v[164:167], v[88:91], a[84:87], v[164:167]
    ds_read_b128 a[96:99], v11 offset:0
    v_mul_f32 v220, v220, v212
    v_mfma_f32_16x16x32_bf16 v[176:179], v[88:91], a[88:91], v[176:179]
    v_mul_f32 v221, v221, v213
    v_mul_f32 v222, v222, v214
    v_mfma_f32_16x16x32_bf16 v[180:183], v[88:91], a[92:95], v[180:183]
    ds_read_b128 a[100:103], v11 offset:2048
    buffer_load_dwordx4 v[196:199], v1, s[8:11], s100 offen offset:1024
    v_mfma_f32_16x16x32_bf16 v[188:191], v[92:95], a[92:95], v[188:191]
    ds_read_b64_tr_b16 v[80:81], v13 offset:8192
    ds_read_b64_tr_b16 v[82:83], v13 offset:8704
    v_mfma_f32_16x16x32_bf16 v[184:187], v[92:95], a[88:91], v[184:187]
    ds_read_b128 a[104:107], v11 offset:4096
    v_mul_f32 v223, v223, v215
    v_mfma_f32_16x16x32_bf16 v[172:175], v[92:95], a[84:87], v[172:175]
    v_mul_f32 v224, v224, v216
    v_mul_f32 v225, v225, v217
    v_mfma_f32_16x16x32_bf16 v[168:171], v[92:95], a[80:83], v[168:171]
    ds_read_b128 a[108:111], v11 offset:6144
    s_waitcnt lgkmcnt(2)
    v_mfma_f32_16x16x32_bf16 v[96:99], v[72:75], a[96:99], v[96:99]
    ds_read_b64_tr_b16 v[84:85], v13 offset:16416
    ds_read_b64_tr_b16 v[86:87], v13 offset:16928
    v_mfma_f32_16x16x32_bf16 v[100:103], v[72:75], a[100:103], v[100:103]
    ds_read_b128 a[112:115], v12 offset:0
    v_add_u32 v11, 41024, v11
    v_mfma_f32_16x16x32_bf16 v[108:111], v[76:79], a[100:103], v[108:111]
    buffer_load_dwordx4 v2, s[8:11], s56 offen sc1 lds
    v_mfma_f32_16x16x32_bf16 v[104:107], v[76:79], a[96:99], v[104:107]
    s_add_u32 s59, s52, 6
    s_and_b32 s59, s59, 7
    s_waitcnt lgkmcnt(1)
    v_mfma_f32_16x16x32_bf16 v[112:115], v[72:75], a[104:107], v[112:115]
    ds_read_b64_tr_b16 v[88:89], v14 offset:8192
    ds_read_b64_tr_b16 v[90:91], v14 offset:8704
    v_mfma_f32_16x16x32_bf16 v[116:119], v[72:75], a[108:111], v[116:119]
    ds_read_b128 a[116:119], v12 offset:2048
    v_mul_f32 v226, v226, v218
    v_mfma_f32_16x16x32_bf16 v[124:127], v[76:79], a[108:111], v[124:127]
    buffer_load_dwordx4 v3, s[8:11], s56 offen offset:1024 sc1 lds
    v_mfma_f32_16x16x32_bf16 v[120:123], v[76:79], a[104:107], v[120:123]
    v_mul_f32 v227, v227, v219
    v_mfma_f32_16x16x32_bf16 v[128:131], v[80:83], a[96:99], v[128:131]
    ds_read_b64_tr_b16 v[92:93], v14 offset:16416
    ds_read_b64_tr_b16 v[94:95], v14 offset:16928
    v_mfma_f32_16x16x32_bf16 v[132:135], v[80:83], a[100:103], v[132:135]
    ds_read_b128 a[120:123], v12 offset:4096
    v_cvt_pk_bf16_f32 v228, v220, v221
    v_mfma_f32_16x16x32_bf16 v[144:147], v[80:83], a[104:107], v[144:147]
    buffer_load_dwordx4 v4, s[8:11], s56 offen offset:2048 sc1 lds
    v_mfma_f32_16x16x32_bf16 v[148:151], v[80:83], a[108:111], v[148:151]
    v_cvt_pk_bf16_f32 v229, v222, v223
    v_mfma_f32_16x16x32_bf16 v[156:159], v[84:87], a[108:111], v[156:159]
    ds_read_b64_tr_b16 v[72:73], v13 offset:4096
    ds_read_b64_tr_b16 v[74:75], v13 offset:4608
    v_mfma_f32_16x16x32_bf16 v[152:155], v[84:87], a[104:107], v[152:155]
    ds_read_b128 a[124:127], v12 offset:6144
    v_cvt_pk_bf16_f32 v230, v224, v225
    v_mfma_f32_16x16x32_bf16 v[140:143], v[84:87], a[100:103], v[140:143]
    buffer_load_dwordx4 v5, s[8:11], s56 offen offset:3072 sc1 lds
    v_mfma_f32_16x16x32_bf16 v[136:139], v[84:87], a[96:99], v[136:139]
    s_add_u32 m0, s60, 98432
    s_lshl_b32 s56, s59, 7
    s_waitcnt lgkmcnt(1)
    v_mfma_f32_16x16x32_bf16 v[160:163], v[88:91], a[96:99], v[160:163]
    ds_read_b64_tr_b16 v[76:77], v14 offset:4096
    ds_read_b64_tr_b16 v[78:79], v14 offset:4608
    v_mfma_f32_16x16x32_bf16 v[164:167], v[88:91], a[100:103], v[164:167]
    ds_read_b64_tr_b16 v[80:81], v13 offset:12288
    ds_read_b64_tr_b16 v[82:83], v13 offset:12800
    v_mfma_f32_16x16x32_bf16 v[176:179], v[88:91], a[104:107], v[176:179]
    buffer_load_dwordx4 v6, s[12:15], s57 offen sc1 lds
    v_mfma_f32_16x16x32_bf16 v[180:183], v[88:91], a[108:111], v[180:183]
    v_add_u32 v12, 41024, v12
    v_mfma_f32_16x16x32_bf16 v[188:191], v[92:95], a[108:111], v[188:191]
    ds_read_b64_tr_b16 v[84:85], v13 offset:20512
    ds_read_b64_tr_b16 v[86:87], v13 offset:21024
    v_mfma_f32_16x16x32_bf16 v[184:187], v[92:95], a[104:107], v[184:187]
    buffer_load_dwordx4 v7, s[12:15], s57 offen offset:1024 sc1 lds
    v_mfma_f32_16x16x32_bf16 v[172:175], v[92:95], a[100:103], v[172:175]
    s_add_u32 m0, s60, 106624
    s_mul_i32 s57, s59, 196608
    v_mfma_f32_16x16x32_bf16 v[168:171], v[92:95], a[96:99], v[168:171]
    v_cvt_pk_bf16_f32 v231, v226, v227
    v_mfma_f32_16x16x32_bf16 v[96:99], v[72:75], a[112:115], v[96:99]
    ds_read_b64_tr_b16 v[88:89], v14 offset:12288
    ds_read_b64_tr_b16 v[90:91], v14 offset:12800
    v_mfma_f32_16x16x32_bf16 v[100:103], v[72:75], a[116:119], v[100:103]
    buffer_load_dwordx4 v8, s[16:19], s58 offen sc1 lds
    v_mfma_f32_16x16x32_bf16 v[112:115], v[72:75], a[120:123], v[112:115]
    v_dot2_f32_bf16 v232, v228, v236, 0
    v_dot2_f32_bf16 v232, v229, v236, v232
    s_waitcnt lgkmcnt(2)
    v_mfma_f32_16x16x32_bf16 v[116:119], v[72:75], a[124:127], v[116:119]
    v_dot2_f32_bf16 v232, v230, v236, v232
    v_mfma_f32_16x16x32_bf16 v[124:127], v[76:79], a[124:127], v[124:127]
    ds_read_b64_tr_b16 v[92:93], v14 offset:20512
    ds_read_b64_tr_b16 v[94:95], v14 offset:21024
    v_mfma_f32_16x16x32_bf16 v[120:123], v[76:79], a[120:123], v[120:123]
    v_add_u32 v13, 41024, v13
    v_add_u32 v14, 41024, v14
    v_mfma_f32_16x16x32_bf16 v[108:111], v[76:79], a[116:119], v[108:111]
    buffer_load_dwordx4 v9, s[16:19], s58 offen offset:1024 sc1 lds
    v_mfma_f32_16x16x32_bf16 v[104:107], v[76:79], a[112:115], v[104:107]
    s_add_u32 m0, s60, 114848
    v_mfma_f32_16x16x32_bf16 v[128:131], v[80:83], a[112:115], v[128:131]
    buffer_load_dwordx4 v8, s[20:23], s58 offen sc1 lds
    v_mfma_f32_16x16x32_bf16 v[132:135], v[80:83], a[116:119], v[132:135]
    v_dot2_f32_bf16 v232, v231, v236, v232
    v_mfma_f32_16x16x32_bf16 v[144:147], v[80:83], a[120:123], v[144:147]
    v_mfma_f32_16x16x32_bf16 v[148:151], v[80:83], a[124:127], v[148:151]
    s_waitcnt vmcnt(12) lgkmcnt(0)
    s_barrier
    v_mfma_f32_16x16x32_bf16 v[156:159], v[84:87], a[124:127], v[156:159]
    ds_read_b64_tr_b16 v[72:73], v13 offset:0
    ds_read_b64_tr_b16 v[74:75], v13 offset:512
    v_mfma_f32_16x16x32_bf16 v[152:155], v[84:87], a[120:123], v[152:155]
    buffer_load_dwordx4 v9, s[20:23], s58 offen offset:1024 sc1 lds
    v_mfma_f32_16x16x32_bf16 v[140:143], v[84:87], a[116:119], v[140:143]
    s_add_u32 m0, s61, 0
    s_mul_i32 s58, s59, 229376
    v_mfma_f32_16x16x32_bf16 v[136:139], v[84:87], a[112:115], v[136:139]
    s_waitcnt vmcnt(10)
    v_lshlrev_b32 v220, 16, v196
    v_mfma_f32_16x16x32_bf16 v[160:163], v[88:91], a[112:115], v[160:163]
    ds_read_b64_tr_b16 v[76:77], v14 offset:0
    ds_read_b64_tr_b16 v[78:79], v14 offset:512
    v_mfma_f32_16x16x32_bf16 v[164:167], v[88:91], a[116:119], v[164:167]
    ds_read_b128 a[128:131], v11 offset:0
    v_and_b32 v221, 0xffff0000, v196
    v_mfma_f32_16x16x32_bf16 v[176:179], v[88:91], a[120:123], v[176:179]
    buffer_load_dwordx4 v[200:203], v1, s[8:11], s100 offen offset:2048
    v_mfma_f32_16x16x32_bf16 v[180:183], v[88:91], a[124:127], v[180:183]
    ds_read_b128 a[132:135], v11 offset:2048
    v_mfma_f32_16x16x32_bf16 v[188:191], v[92:95], a[124:127], v[188:191]
    ds_read_b64_tr_b16 v[80:81], v13 offset:8192
    ds_read_b64_tr_b16 v[82:83], v13 offset:8704
    v_mfma_f32_16x16x32_bf16 v[184:187], v[92:95], a[120:123], v[184:187]
    ds_read_b128 a[136:139], v11 offset:4096
    v_lshlrev_b32 v222, 16, v197
    v_mfma_f32_16x16x32_bf16 v[172:175], v[92:95], a[116:119], v[172:175]
    buffer_load_dwordx4 v2, s[8:11], s56 offen sc1 lds
    v_mfma_f32_16x16x32_bf16 v[168:171], v[92:95], a[112:115], v[168:171]
    ds_read_b128 a[140:143], v11 offset:6144
    s_waitcnt lgkmcnt(2)
    v_mfma_f32_16x16x32_bf16 v[96:99], v[72:75], a[128:131], v[96:99]
    ds_read_b64_tr_b16 v[84:85], v13 offset:16416
    ds_read_b64_tr_b16 v[86:87], v13 offset:16928
    v_mfma_f32_16x16x32_bf16 v[100:103], v[72:75], a[132:135], v[100:103]
    ds_read_b128 a[144:147], v12 offset:0
    s_add_u32 s59, s52, 7
    v_mfma_f32_16x16x32_bf16 v[108:111], v[76:79], a[132:135], v[108:111]
    s_and_b32 s59, s59, 7
    v_add_u32 v11, 41024, v11
    v_mfma_f32_16x16x32_bf16 v[104:107], v[76:79], a[128:131], v[104:107]
    v_and_b32 v223, 0xffff0000, v197
    s_waitcnt lgkmcnt(1)
    v_mfma_f32_16x16x32_bf16 v[112:115], v[72:75], a[136:139], v[112:115]
    ds_read_b64_tr_b16 v[88:89], v14 offset:8192
    ds_read_b64_tr_b16 v[90:91], v14 offset:8704
    v_mfma_f32_16x16x32_bf16 v[116:119], v[72:75], a[140:143], v[116:119]
    ds_read_b128 a[148:151], v12 offset:2048
    v_lshlrev_b32 v224, 16, v198
    v_mfma_f32_16x16x32_bf16 v[124:127], v[76:79], a[140:143], v[124:127]
    buffer_load_dwordx4 v3, s[8:11], s56 offen offset:1024 sc1 lds
    v_mfma_f32_16x16x32_bf16 v[120:123], v[76:79], a[136:139], v[120:123]
    v_and_b32 v225, 0xffff0000, v198
    v_mfma_f32_16x16x32_bf16 v[128:131], v[80:83], a[128:131], v[128:131]
    ds_read_b64_tr_b16 v[92:93], v14 offset:16416
    ds_read_b64_tr_b16 v[94:95], v14 offset:16928
    v_mfma_f32_16x16x32_bf16 v[132:135], v[80:83], a[132:135], v[132:135]
    ds_read_b128 a[152:155], v12 offset:4096
    v_lshlrev_b32 v226, 16, v199
    v_mfma_f32_16x16x32_bf16 v[144:147], v[80:83], a[136:139], v[144:147]
    buffer_load_dwordx4 v4, s[8:11], s56 offen offset:2048 sc1 lds
    v_mfma_f32_16x16x32_bf16 v[148:151], v[80:83], a[140:143], v[148:151]
    v_and_b32 v227, 0xffff0000, v199
    v_mfma_f32_16x16x32_bf16 v[156:159], v[84:87], a[140:143], v[156:159]
    ds_read_b64_tr_b16 v[72:73], v13 offset:4096
    ds_read_b64_tr_b16 v[74:75], v13 offset:4608
    v_mfma_f32_16x16x32_bf16 v[152:155], v[84:87], a[136:139], v[152:155]
    ds_read_b128 a[156:159], v12 offset:6144
    v_mul_f32 v220, v220, v212
    v_mfma_f32_16x16x32_bf16 v[140:143], v[84:87], a[132:135], v[140:143]
    buffer_load_dwordx4 v5, s[8:11], s56 offen offset:3072 sc1 lds
    v_mfma_f32_16x16x32_bf16 v[136:139], v[84:87], a[128:131], v[136:139]
    s_add_u32 m0, s60, 16384
    s_lshl_b32 s56, s59, 7
    s_waitcnt lgkmcnt(1)
    v_mfma_f32_16x16x32_bf16 v[160:163], v[88:91], a[128:131], v[160:163]
    ds_read_b64_tr_b16 v[76:77], v14 offset:4096
    ds_read_b64_tr_b16 v[78:79], v14 offset:4608
    v_mfma_f32_16x16x32_bf16 v[164:167], v[88:91], a[132:135], v[164:167]
    ds_read_b64_tr_b16 v[80:81], v13 offset:12288
    ds_read_b64_tr_b16 v[82:83], v13 offset:12800
    v_mfma_f32_16x16x32_bf16 v[176:179], v[88:91], a[136:139], v[176:179]
    buffer_load_dwordx4 v6, s[12:15], s57 offen sc1 lds
    v_mfma_f32_16x16x32_bf16 v[180:183], v[88:91], a[140:143], v[180:183]
    v_add_u32 v12, 41024, v12
    v_mfma_f32_16x16x32_bf16 v[188:191], v[92:95], a[140:143], v[188:191]
    ds_read_b64_tr_b16 v[84:85], v13 offset:20512
    ds_read_b64_tr_b16 v[86:87], v13 offset:21024
    v_mfma_f32_16x16x32_bf16 v[184:187], v[92:95], a[136:139], v[184:187]
    buffer_load_dwordx4 v7, s[12:15], s57 offen offset:1024 sc1 lds
    v_mfma_f32_16x16x32_bf16 v[172:175], v[92:95], a[132:135], v[172:175]
    s_add_u32 m0, s60, 24576
    s_mul_i32 s57, s59, 196608
    v_mfma_f32_16x16x32_bf16 v[168:171], v[92:95], a[128:131], v[168:171]
    v_mul_f32 v221, v221, v213
    v_mfma_f32_16x16x32_bf16 v[96:99], v[72:75], a[144:147], v[96:99]
    ds_read_b64_tr_b16 v[88:89], v14 offset:12288
    ds_read_b64_tr_b16 v[90:91], v14 offset:12800
    v_mfma_f32_16x16x32_bf16 v[100:103], v[72:75], a[148:151], v[100:103]
    buffer_load_dwordx4 v8, s[16:19], s58 offen sc1 lds
    v_mfma_f32_16x16x32_bf16 v[112:115], v[72:75], a[152:155], v[112:115]
    buffer_load_dwordx4 v9, s[16:19], s58 offen offset:1024 sc1 lds
    s_waitcnt lgkmcnt(2)
    v_mfma_f32_16x16x32_bf16 v[116:119], v[72:75], a[156:159], v[116:119]
    s_add_u32 m0, s60, 32800
    v_mfma_f32_16x16x32_bf16 v[124:127], v[76:79], a[156:159], v[124:127]
    ds_read_b64_tr_b16 v[92:93], v14 offset:20512
    ds_read_b64_tr_b16 v[94:95], v14 offset:21024
    v_mfma_f32_16x16x32_bf16 v[120:123], v[76:79], a[152:155], v[120:123]
    v_add_u32 v13, 41024, v13
    v_add_u32 v14, 41024, v14
    v_mfma_f32_16x16x32_bf16 v[108:111], v[76:79], a[148:151], v[108:111]
    buffer_load_dwordx4 v8, s[20:23], s58 offen sc1 lds
    v_mfma_f32_16x16x32_bf16 v[104:107], v[76:79], a[144:147], v[104:107]
    v_mul_f32 v222, v222, v214
    v_mfma_f32_16x16x32_bf16 v[128:131], v[80:83], a[144:147], v[128:131]
    v_mul_f32 v223, v223, v215
    v_mul_f32 v224, v224, v216
    v_mfma_f32_16x16x32_bf16 v[132:135], v[80:83], a[148:151], v[132:135]
    v_mul_f32 v225, v225, v217
    v_mul_f32 v226, v226, v218
    v_mfma_f32_16x16x32_bf16 v[144:147], v[80:83], a[152:155], v[144:147]
    buffer_load_dwordx4 v9, s[20:23], s58 offen offset:1024 sc1 lds
    v_mfma_f32_16x16x32_bf16 v[148:151], v[80:83], a[156:159], v[148:151]
    s_waitcnt vmcnt(11) lgkmcnt(0)
    s_barrier
    v_mfma_f32_16x16x32_bf16 v[156:159], v[84:87], a[156:159], v[156:159]
    ds_read_b64_tr_b16 v[72:73], v13 offset:0
    ds_read_b64_tr_b16 v[74:75], v13 offset:512
    v_mfma_f32_16x16x32_bf16 v[152:155], v[84:87], a[152:155], v[152:155]
    s_add_u32 m0, s61, 41024
    s_mul_i32 s58, s59, 229376
    v_mfma_f32_16x16x32_bf16 v[140:143], v[84:87], a[148:151], v[140:143]
    buffer_load_dwordx4 v[204:207], v1, s[8:11], s100 offen offset:3072
    v_mfma_f32_16x16x32_bf16 v[136:139], v[84:87], a[144:147], v[136:139]
    v_mul_f32 v227, v227, v219
    v_mfma_f32_16x16x32_bf16 v[160:163], v[88:91], a[144:147], v[160:163]
    ds_read_b64_tr_b16 v[76:77], v14 offset:0
    ds_read_b64_tr_b16 v[78:79], v14 offset:512
    v_mfma_f32_16x16x32_bf16 v[164:167], v[88:91], a[148:151], v[164:167]
    ds_read_b128 a[160:163], v11 offset:0
    v_cvt_pk_bf16_f32 v228, v220, v221
    v_mfma_f32_16x16x32_bf16 v[176:179], v[88:91], a[152:155], v[176:179]
    buffer_load_dwordx4 v2, s[8:11], s56 offen sc1 lds
    v_mfma_f32_16x16x32_bf16 v[180:183], v[88:91], a[156:159], v[180:183]
    ds_read_b128 a[164:167], v11 offset:2048
    v_mfma_f32_16x16x32_bf16 v[188:191], v[92:95], a[156:159], v[188:191]
    ds_read_b64_tr_b16 v[80:81], v13 offset:8192
    ds_read_b64_tr_b16 v[82:83], v13 offset:8704
    v_mfma_f32_16x16x32_bf16 v[184:187], v[92:95], a[152:155], v[184:187]
    ds_read_b128 a[168:171], v11 offset:4096
    s_add_u32 s59, s52, 0
    v_mfma_f32_16x16x32_bf16 v[172:175], v[92:95], a[148:151], v[172:175]
    s_and_b32 s59, s59, 7
    v_cvt_pk_bf16_f32 v229, v222, v223
    v_mfma_f32_16x16x32_bf16 v[168:171], v[92:95], a[144:147], v[168:171]
    ds_read_b128 a[172:175], v11 offset:6144
    s_waitcnt lgkmcnt(2)
    v_mfma_f32_16x16x32_bf16 v[96:99], v[72:75], a[160:163], v[96:99]
    ds_read_b64_tr_b16 v[84:85], v13 offset:16416
    ds_read_b64_tr_b16 v[86:87], v13 offset:16928
    v_mfma_f32_16x16x32_bf16 v[100:103], v[72:75], a[164:167], v[100:103]
    ds_read_b128 a[176:179], v12 offset:0
    v_subrev_u32 v11, 82048, v11
    v_mfma_f32_16x16x32_bf16 v[108:111], v[76:79], a[164:167], v[108:111]
    buffer_load_dwordx4 v3, s[8:11], s56 offen offset:1024 sc1 lds
    v_mfma_f32_16x16x32_bf16 v[104:107], v[76:79], a[160:163], v[104:107]
    v_cvt_pk_bf16_f32 v230, v224, v225
    s_waitcnt lgkmcnt(1)
    v_mfma_f32_16x16x32_bf16 v[112:115], v[72:75], a[168:171], v[112:115]
    ds_read_b64_tr_b16 v[88:89], v14 offset:8192
    ds_read_b64_tr_b16 v[90:91], v14 offset:8704
    v_mfma_f32_16x16x32_bf16 v[116:119], v[72:75], a[172:175], v[116:119]
    ds_read_b128 a[180:183], v12 offset:2048
    v_cvt_pk_bf16_f32 v231, v226, v227
    v_mfma_f32_16x16x32_bf16 v[124:127], v[76:79], a[172:175], v[124:127]
    buffer_load_dwordx4 v4, s[8:11], s56 offen offset:2048 sc1 lds
    v_mfma_f32_16x16x32_bf16 v[120:123], v[76:79], a[168:171], v[120:123]
    v_dot2_f32_bf16 v233, v228, v236, 0
    v_mfma_f32_16x16x32_bf16 v[128:131], v[80:83], a[160:163], v[128:131]
    ds_read_b64_tr_b16 v[92:93], v14 offset:16416
    ds_read_b64_tr_b16 v[94:95], v14 offset:16928
    v_mfma_f32_16x16x32_bf16 v[132:135], v[80:83], a[164:167], v[132:135]
    ds_read_b128 a[184:187], v12 offset:4096
    v_dot2_f32_bf16 v233, v229, v236, v233
    v_mfma_f32_16x16x32_bf16 v[144:147], v[80:83], a[168:171], v[144:147]
    buffer_load_dwordx4 v5, s[8:11], s56 offen offset:3072 sc1 lds
    v_mfma_f32_16x16x32_bf16 v[148:151], v[80:83], a[172:175], v[148:151]
    s_add_u32 m0, s60, 57408
    v_mfma_f32_16x16x32_bf16 v[156:159], v[84:87], a[172:175], v[156:159]
    ds_read_b64_tr_b16 v[72:73], v13 offset:4096
    ds_read_b64_tr_b16 v[74:75], v13 offset:4608
    v_mfma_f32_16x16x32_bf16 v[152:155], v[84:87], a[168:171], v[152:155]
    ds_read_b128 a[188:191], v12 offset:6144
    v_dot2_f32_bf16 v233, v230, v236, v233
    v_mfma_f32_16x16x32_bf16 v[140:143], v[84:87], a[164:167], v[140:143]
    buffer_load_dwordx4 v6, s[12:15], s57 offen sc1 lds
    v_mfma_f32_16x16x32_bf16 v[136:139], v[84:87], a[160:163], v[136:139]
    v_subrev_u32 v12, 82048, v12
    s_waitcnt lgkmcnt(1)
    v_mfma_f32_16x16x32_bf16 v[160:163], v[88:91], a[160:163], v[160:163]
    ds_read_b64_tr_b16 v[76:77], v14 offset:4096
    ds_read_b64_tr_b16 v[78:79], v14 offset:4608
    v_mfma_f32_16x16x32_bf16 v[164:167], v[88:91], a[164:167], v[164:167]
    ds_read_b64_tr_b16 v[80:81], v13 offset:12288
    ds_read_b64_tr_b16 v[82:83], v13 offset:12800
    v_mfma_f32_16x16x32_bf16 v[176:179], v[88:91], a[168:171], v[176:179]
    buffer_load_dwordx4 v7, s[12:15], s57 offen offset:1024 sc1 lds
    v_mfma_f32_16x16x32_bf16 v[180:183], v[88:91], a[172:175], v[180:183]
    s_add_u32 m0, s60, 65600
    v_mfma_f32_16x16x32_bf16 v[188:191], v[92:95], a[172:175], v[188:191]
    ds_read_b64_tr_b16 v[84:85], v13 offset:20512
    ds_read_b64_tr_b16 v[86:87], v13 offset:21024
    v_mfma_f32_16x16x32_bf16 v[184:187], v[92:95], a[168:171], v[184:187]
    buffer_load_dwordx4 v8, s[16:19], s58 offen sc1 lds
    v_mfma_f32_16x16x32_bf16 v[172:175], v[92:95], a[164:167], v[172:175]
    buffer_load_dwordx4 v9, s[16:19], s58 offen offset:1024 sc1 lds
    v_mfma_f32_16x16x32_bf16 v[168:171], v[92:95], a[160:163], v[168:171]
    s_add_u32 m0, s60, 73824
    v_mfma_f32_16x16x32_bf16 v[96:99], v[72:75], a[176:179], v[96:99]
    ds_read_b64_tr_b16 v[88:89], v14 offset:12288
    ds_read_b64_tr_b16 v[90:91], v14 offset:12800
    v_mfma_f32_16x16x32_bf16 v[100:103], v[72:75], a[180:183], v[100:103]
    v_dot2_f32_bf16 v233, v231, v236, v233
    s_waitcnt vmcnt(19)
    v_lshlrev_b32 v220, 16, v200
    v_mfma_f32_16x16x32_bf16 v[112:115], v[72:75], a[184:187], v[112:115]
    buffer_load_dwordx4 v8, s[20:23], s58 offen sc1 lds
    s_waitcnt lgkmcnt(2)
    v_mfma_f32_16x16x32_bf16 v[116:119], v[72:75], a[188:191], v[116:119]
    v_and_b32 v221, 0xffff0000, v200
    v_mfma_f32_16x16x32_bf16 v[124:127], v[76:79], a[188:191], v[124:127]
    ds_read_b64_tr_b16 v[92:93], v14 offset:20512
    ds_read_b64_tr_b16 v[94:95], v14 offset:21024
    v_mfma_f32_16x16x32_bf16 v[120:123], v[76:79], a[184:187], v[120:123]
    v_subrev_u32 v13, 82048, v13
    v_subrev_u32 v14, 82048, v14
    v_mfma_f32_16x16x32_bf16 v[108:111], v[76:79], a[180:183], v[108:111]
    buffer_load_dwordx4 v9, s[20:23], s58 offen offset:1024 sc1 lds
    v_mfma_f32_16x16x32_bf16 v[104:107], v[76:79], a[176:179], v[104:107]
    s_add_u32 m0, s60, 138464
    s_mul_i32 s58, s59, 229376
    v_mfma_f32_16x16x32_bf16 v[128:131], v[80:83], a[176:179], v[128:131]
    s_add_u32 s58, s58, 128
    v_lshlrev_b32 v222, 16, v201
    v_mfma_f32_16x16x32_bf16 v[132:135], v[80:83], a[180:183], v[132:135]
    v_and_b32 v223, 0xffff0000, v201
    v_lshlrev_b32 v224, 16, v202
    v_mfma_f32_16x16x32_bf16 v[144:147], v[80:83], a[184:187], v[144:147]
    buffer_load_dwordx4 v8, s[16:19], s58 offen sc1 lds
    v_mfma_f32_16x16x32_bf16 v[148:151], v[80:83], a[188:191], v[148:151]
    s_waitcnt vmcnt(12) lgkmcnt(0)
    s_barrier
    v_mfma_f32_16x16x32_bf16 v[156:159], v[84:87], a[188:191], v[156:159]
    ds_read_b64_tr_b16 v[72:73], v13 offset:0
    ds_read_b64_tr_b16 v[74:75], v13 offset:512
    v_mfma_f32_16x16x32_bf16 v[152:155], v[84:87], a[184:187], v[152:155]
    s_add_u32 s59, s52, 1
    s_and_b32 s59, s59, 7
    s_lshr_b32 s8, s51, 1
    v_mfma_f32_16x16x32_bf16 v[140:143], v[84:87], a[180:183], v[140:143]
    buffer_load_dwordx4 v9, s[16:19], s58 offen offset:1024 sc1 lds
    v_mfma_f32_16x16x32_bf16 v[136:139], v[84:87], a[176:179], v[136:139]
    s_add_u32 m0, s60, 146688
    s_lshl_b32 s9, s50, 2
    v_mfma_f32_16x16x32_bf16 v[160:163], v[88:91], a[176:179], v[160:163]
    ds_read_b64_tr_b16 v[76:77], v14 offset:0
    ds_read_b64_tr_b16 v[78:79], v14 offset:512
    v_mfma_f32_16x16x32_bf16 v[164:167], v[88:91], a[180:183], v[164:167]
    ds_read_b128 a[192:195], v11 offset:0
    v_and_b32 v225, 0xffff0000, v202
    v_mfma_f32_16x16x32_bf16 v[176:179], v[88:91], a[184:187], v[176:179]
    buffer_load_dwordx4 v8, s[20:23], s58 offen sc1 lds
    v_mfma_f32_16x16x32_bf16 v[180:183], v[88:91], a[188:191], v[180:183]
    ds_read_b128 a[196:199], v11 offset:2048
    v_mfma_f32_16x16x32_bf16 v[188:191], v[92:95], a[188:191], v[188:191]
    ds_read_b64_tr_b16 v[80:81], v13 offset:8192
    ds_read_b64_tr_b16 v[82:83], v13 offset:8704
    v_mfma_f32_16x16x32_bf16 v[184:187], v[92:95], a[184:187], v[184:187]
    ds_read_b128 a[200:203], v11 offset:4096
    v_lshlrev_b32 v226, 16, v203
    v_mfma_f32_16x16x32_bf16 v[172:175], v[92:95], a[180:183], v[172:175]
    buffer_load_dwordx4 v9, s[20:23], s58 offen offset:1024 sc1 lds
    v_mfma_f32_16x16x32_bf16 v[168:171], v[92:95], a[176:179], v[168:171]
    ds_read_b128 a[204:207], v11 offset:6144
    s_waitcnt lgkmcnt(2)
    v_mfma_f32_16x16x32_bf16 v[96:99], v[72:75], a[192:195], v[96:99]
    ds_read_b64_tr_b16 v[84:85], v13 offset:16416
    ds_read_b64_tr_b16 v[86:87], v13 offset:16928
    v_mfma_f32_16x16x32_bf16 v[100:103], v[72:75], a[196:199], v[100:103]
    ds_read_b128 a[208:211], v12 offset:0
    s_add_u32 m0, s60, 113856
    v_mfma_f32_16x16x32_bf16 v[108:111], v[76:79], a[196:199], v[108:111]
    s_mul_i32 s58, s59, 229376
    s_add_u32 s58, s58, 128
    s_add_u32 s8, s8, s9
    v_mfma_f32_16x16x32_bf16 v[104:107], v[76:79], a[192:195], v[104:107]
    v_add_u32 v11, 41024, v11
    s_waitcnt lgkmcnt(1)
    v_mfma_f32_16x16x32_bf16 v[112:115], v[72:75], a[200:203], v[112:115]
    ds_read_b64_tr_b16 v[88:89], v14 offset:8192
    ds_read_b64_tr_b16 v[90:91], v14 offset:8704
    v_mfma_f32_16x16x32_bf16 v[116:119], v[72:75], a[204:207], v[116:119]
    ds_read_b128 a[212:215], v12 offset:2048
    v_and_b32 v227, 0xffff0000, v203
    v_mfma_f32_16x16x32_bf16 v[124:127], v[76:79], a[204:207], v[124:127]
    v_mul_f32 v220, v220, v212
    v_mul_f32 v221, v221, v213
    v_mfma_f32_16x16x32_bf16 v[120:123], v[76:79], a[200:203], v[120:123]
    v_mul_f32 v222, v222, v214
    v_mfma_f32_16x16x32_bf16 v[128:131], v[80:83], a[192:195], v[128:131]
    ds_read_b64_tr_b16 v[92:93], v14 offset:16416
    ds_read_b64_tr_b16 v[94:95], v14 offset:16928
    v_mfma_f32_16x16x32_bf16 v[132:135], v[80:83], a[196:199], v[132:135]
    ds_read_b128 a[216:219], v12 offset:4096
    v_mul_f32 v223, v223, v215
    v_mfma_f32_16x16x32_bf16 v[144:147], v[80:83], a[200:203], v[144:147]
    v_mul_f32 v224, v224, v216
    v_mul_f32 v225, v225, v217
    v_mfma_f32_16x16x32_bf16 v[148:151], v[80:83], a[204:207], v[148:151]
    v_mul_f32 v226, v226, v218
    v_mfma_f32_16x16x32_bf16 v[156:159], v[84:87], a[204:207], v[156:159]
    ds_read_b64_tr_b16 v[72:73], v13 offset:4096
    ds_read_b64_tr_b16 v[74:75], v13 offset:4608
    v_mfma_f32_16x16x32_bf16 v[152:155], v[84:87], a[200:203], v[152:155]
    ds_read_b128 a[220:223], v12 offset:6144
    v_mul_f32 v227, v227, v219
    v_mfma_f32_16x16x32_bf16 v[140:143], v[84:87], a[196:199], v[140:143]
    v_add_u32 v12, 41024, v12
    v_cvt_pk_bf16_f32 v228, v220, v221
    v_mfma_f32_16x16x32_bf16 v[136:139], v[84:87], a[192:195], v[136:139]
    v_cvt_pk_bf16_f32 v229, v222, v223
    s_waitcnt lgkmcnt(1)
    v_mfma_f32_16x16x32_bf16 v[160:163], v[88:91], a[192:195], v[160:163]
    ds_read_b64_tr_b16 v[76:77], v14 offset:4096
    ds_read_b64_tr_b16 v[78:79], v14 offset:4608
    v_mfma_f32_16x16x32_bf16 v[164:167], v[88:91], a[196:199], v[164:167]
    ds_read_b64_tr_b16 v[80:81], v13 offset:12288
    ds_read_b64_tr_b16 v[82:83], v13 offset:12800
    v_mfma_f32_16x16x32_bf16 v[176:179], v[88:91], a[200:203], v[176:179]
    v_cvt_pk_bf16_f32 v230, v224, v225
    v_cvt_pk_bf16_f32 v231, v226, v227
    v_mfma_f32_16x16x32_bf16 v[180:183], v[88:91], a[204:207], v[180:183]
    v_dot2_f32_bf16 v234, v228, v236, 0
    v_mfma_f32_16x16x32_bf16 v[188:191], v[92:95], a[204:207], v[188:191]
    ds_read_b64_tr_b16 v[84:85], v13 offset:20512
    ds_read_b64_tr_b16 v[86:87], v13 offset:21024
    v_mfma_f32_16x16x32_bf16 v[184:187], v[92:95], a[200:203], v[184:187]
    v_dot2_f32_bf16 v234, v229, v236, v234
    v_dot2_f32_bf16 v234, v230, v236, v234
    v_mfma_f32_16x16x32_bf16 v[172:175], v[92:95], a[196:199], v[172:175]
    v_dot2_f32_bf16 v234, v231, v236, v234
    s_waitcnt vmcnt(14)
    v_lshlrev_b32 v220, 16, v204
    v_mfma_f32_16x16x32_bf16 v[168:171], v[92:95], a[192:195], v[168:171]
    v_and_b32 v221, 0xffff0000, v204
    v_mfma_f32_16x16x32_bf16 v[96:99], v[72:75], a[208:211], v[96:99]
    ds_read_b64_tr_b16 v[88:89], v14 offset:12288
    ds_read_b64_tr_b16 v[90:91], v14 offset:12800
    v_mfma_f32_16x16x32_bf16 v[100:103], v[72:75], a[212:215], v[100:103]
    v_lshlrev_b32 v222, 16, v205
    v_and_b32 v223, 0xffff0000, v205
    v_mfma_f32_16x16x32_bf16 v[112:115], v[72:75], a[216:219], v[112:115]
    v_lshlrev_b32 v224, 16, v206
    v_and_b32 v225, 0xffff0000, v206
    s_waitcnt lgkmcnt(2)
    v_mfma_f32_16x16x32_bf16 v[116:119], v[72:75], a[220:223], v[116:119]
    v_lshlrev_b32 v226, 16, v207
    v_mfma_f32_16x16x32_bf16 v[124:127], v[76:79], a[220:223], v[124:127]
    ds_read_b64_tr_b16 v[92:93], v14 offset:20512
    ds_read_b64_tr_b16 v[94:95], v14 offset:21024
    v_mfma_f32_16x16x32_bf16 v[120:123], v[76:79], a[216:219], v[120:123]
    v_add_u32 v13, 41024, v13
    v_add_u32 v14, 41024, v14
    v_mfma_f32_16x16x32_bf16 v[108:111], v[76:79], a[212:215], v[108:111]
    v_and_b32 v227, 0xffff0000, v207
    v_mul_f32 v220, v220, v212
    v_mfma_f32_16x16x32_bf16 v[104:107], v[76:79], a[208:211], v[104:107]
    v_mul_f32 v221, v221, v213
    v_mfma_f32_16x16x32_bf16 v[128:131], v[80:83], a[208:211], v[128:131]
    v_mul_f32 v222, v222, v214
    v_mul_f32 v223, v223, v215
    v_mfma_f32_16x16x32_bf16 v[132:135], v[80:83], a[212:215], v[132:135]
    v_mul_f32 v224, v224, v216
    v_mul_f32 v225, v225, v217
    v_mfma_f32_16x16x32_bf16 v[144:147], v[80:83], a[216:219], v[144:147]
    v_mul_f32 v226, v226, v218
    v_mul_f32 v227, v227, v219
    v_mfma_f32_16x16x32_bf16 v[148:151], v[80:83], a[220:223], v[148:151]
    s_waitcnt vmcnt(4) lgkmcnt(0)
    s_barrier
    v_mfma_f32_16x16x32_bf16 v[156:159], v[84:87], a[220:223], v[156:159]
    ds_read_b64_tr_b16 v[72:73], v13 offset:0
    ds_read_b64_tr_b16 v[74:75], v13 offset:512
    v_mfma_f32_16x16x32_bf16 v[152:155], v[84:87], a[216:219], v[152:155]
    v_cvt_pk_bf16_f32 v228, v220, v221
    v_cvt_pk_bf16_f32 v229, v222, v223
    v_mfma_f32_16x16x32_bf16 v[140:143], v[84:87], a[212:215], v[140:143]
    v_cvt_pk_bf16_f32 v230, v224, v225
    v_cvt_pk_bf16_f32 v231, v226, v227
    v_mfma_f32_16x16x32_bf16 v[136:139], v[84:87], a[208:211], v[136:139]
    v_dot2_f32_bf16 v235, v228, v236, 0
    v_mfma_f32_16x16x32_bf16 v[160:163], v[88:91], a[208:211], v[160:163]
    ds_read_b64_tr_b16 v[76:77], v14 offset:0
    ds_read_b64_tr_b16 v[78:79], v14 offset:512
    v_mfma_f32_16x16x32_bf16 v[164:167], v[88:91], a[212:215], v[164:167]
    ds_read_b128 a[224:227], v11 offset:0
    v_dot2_f32_bf16 v235, v229, v236, v235
    v_mfma_f32_16x16x32_bf16 v[176:179], v[88:91], a[216:219], v[176:179]
    v_dot2_f32_bf16 v235, v230, v236, v235
    v_dot2_f32_bf16 v235, v231, v236, v235
    v_mfma_f32_16x16x32_bf16 v[180:183], v[88:91], a[220:223], v[180:183]
    ds_read_b128 a[228:231], v11 offset:2048
    v_mfma_f32_16x16x32_bf16 v[188:191], v[92:95], a[220:223], v[188:191]
    ds_read_b64_tr_b16 v[80:81], v13 offset:8192
    ds_read_b64_tr_b16 v[82:83], v13 offset:8704
    v_mfma_f32_16x16x32_bf16 v[184:187], v[92:95], a[216:219], v[184:187]
    ds_read_b128 a[232:235], v11 offset:4096
    v_add_f32_dpp v232, v232, v232 row_shr:1 row_mask:0xf bank_mask:0xf bound_ctrl:1
    v_mfma_f32_16x16x32_bf16 v[172:175], v[92:95], a[212:215], v[172:175]
    v_add_f32_dpp v233, v233, v233 row_shr:1 row_mask:0xf bank_mask:0xf bound_ctrl:1
    v_add_f32_dpp v234, v234, v234 row_shr:1 row_mask:0xf bank_mask:0xf bound_ctrl:1
    v_mfma_f32_16x16x32_bf16 v[168:171], v[92:95], a[208:211], v[168:171]
    ds_read_b128 a[236:239], v11 offset:6144
    s_waitcnt lgkmcnt(2)
    v_mfma_f32_16x16x32_bf16 v[96:99], v[72:75], a[224:227], v[96:99]
    ds_read_b64_tr_b16 v[84:85], v13 offset:16416
    ds_read_b64_tr_b16 v[86:87], v13 offset:16928
    v_mfma_f32_16x16x32_bf16 v[100:103], v[72:75], a[228:231], v[100:103]
    ds_read_b128 a[240:243], v12 offset:0
    v_add_f32_dpp v235, v235, v235 row_shr:1 row_mask:0xf bank_mask:0xf bound_ctrl:1
    v_mfma_f32_16x16x32_bf16 v[108:111], v[76:79], a[228:231], v[108:111]
    v_add_f32_dpp v232, v232, v232 row_shr:2 row_mask:0xf bank_mask:0xf bound_ctrl:1
    v_add_f32_dpp v233, v233, v233 row_shr:2 row_mask:0xf bank_mask:0xf bound_ctrl:1
    v_mfma_f32_16x16x32_bf16 v[104:107], v[76:79], a[224:227], v[104:107]
    v_add_f32_dpp v234, v234, v234 row_shr:2 row_mask:0xf bank_mask:0xf bound_ctrl:1
    s_waitcnt lgkmcnt(1)
    v_mfma_f32_16x16x32_bf16 v[112:115], v[72:75], a[232:235], v[112:115]
    ds_read_b64_tr_b16 v[88:89], v14 offset:8192
    ds_read_b64_tr_b16 v[90:91], v14 offset:8704
    v_mfma_f32_16x16x32_bf16 v[116:119], v[72:75], a[236:239], v[116:119]
    ds_read_b128 a[244:247], v12 offset:2048
    v_add_f32_dpp v235, v235, v235 row_shr:2 row_mask:0xf bank_mask:0xf bound_ctrl:1
    v_mfma_f32_16x16x32_bf16 v[124:127], v[76:79], a[236:239], v[124:127]
    v_add_f32_dpp v232, v232, v232 row_shr:4 row_mask:0xf bank_mask:0xf bound_ctrl:1
    v_add_f32_dpp v233, v233, v233 row_shr:4 row_mask:0xf bank_mask:0xf bound_ctrl:1
    v_mfma_f32_16x16x32_bf16 v[120:123], v[76:79], a[232:235], v[120:123]
    v_add_f32_dpp v234, v234, v234 row_shr:4 row_mask:0xf bank_mask:0xf bound_ctrl:1
    v_mfma_f32_16x16x32_bf16 v[128:131], v[80:83], a[224:227], v[128:131]
    ds_read_b64_tr_b16 v[92:93], v14 offset:16416
    ds_read_b64_tr_b16 v[94:95], v14 offset:16928
    v_mfma_f32_16x16x32_bf16 v[132:135], v[80:83], a[228:231], v[132:135]
    ds_read_b128 a[248:251], v12 offset:4096
    v_add_f32_dpp v235, v235, v235 row_shr:4 row_mask:0xf bank_mask:0xf bound_ctrl:1
    v_mfma_f32_16x16x32_bf16 v[144:147], v[80:83], a[232:235], v[144:147]
    v_add_f32_dpp v232, v232, v232 row_shr:8 row_mask:0xf bank_mask:0xf bound_ctrl:1
    v_add_f32_dpp v233, v233, v233 row_shr:8 row_mask:0xf bank_mask:0xf bound_ctrl:1
    v_mfma_f32_16x16x32_bf16 v[148:151], v[80:83], a[236:239], v[148:151]
    v_add_f32_dpp v234, v234, v234 row_shr:8 row_mask:0xf bank_mask:0xf bound_ctrl:1
    v_mfma_f32_16x16x32_bf16 v[156:159], v[84:87], a[236:239], v[156:159]
    ds_read_b64_tr_b16 v[72:73], v13 offset:4096
    ds_read_b64_tr_b16 v[74:75], v13 offset:4608
    v_mfma_f32_16x16x32_bf16 v[152:155], v[84:87], a[232:235], v[152:155]
    ds_read_b128 a[252:255], v12 offset:6144
    v_add_f32_dpp v235, v235, v235 row_shr:8 row_mask:0xf bank_mask:0xf bound_ctrl:1
    v_mfma_f32_16x16x32_bf16 v[140:143], v[84:87], a[228:231], v[140:143]
    v_add_f32_dpp v232, v232, v232 row_bcast:15 row_mask:0xa bank_mask:0xf
    v_add_f32_dpp v233, v233, v233 row_bcast:15 row_mask:0xa bank_mask:0xf
    v_mfma_f32_16x16x32_bf16 v[136:139], v[84:87], a[224:227], v[136:139]
    v_add_f32_dpp v234, v234, v234 row_bcast:15 row_mask:0xa bank_mask:0xf
    s_waitcnt lgkmcnt(1)
    v_mfma_f32_16x16x32_bf16 v[160:163], v[88:91], a[224:227], v[160:163]
    ds_read_b64_tr_b16 v[76:77], v14 offset:4096
    ds_read_b64_tr_b16 v[78:79], v14 offset:4608
    v_mfma_f32_16x16x32_bf16 v[164:167], v[88:91], a[228:231], v[164:167]
    ds_read_b64_tr_b16 v[80:81], v13 offset:12288
    ds_read_b64_tr_b16 v[82:83], v13 offset:12800
    v_mfma_f32_16x16x32_bf16 v[176:179], v[88:91], a[232:235], v[176:179]
    v_add_f32_dpp v235, v235, v235 row_bcast:15 row_mask:0xa bank_mask:0xf
    v_add_f32_dpp v232, v232, v232 row_bcast:31 row_mask:0xc bank_mask:0xf
    v_mfma_f32_16x16x32_bf16 v[180:183], v[88:91], a[236:239], v[180:183]
    v_add_f32_dpp v233, v233, v233 row_bcast:31 row_mask:0xc bank_mask:0xf
    v_mfma_f32_16x16x32_bf16 v[188:191], v[92:95], a[236:239], v[188:191]
    ds_read_b64_tr_b16 v[84:85], v13 offset:20512
    ds_read_b64_tr_b16 v[86:87], v13 offset:21024
    v_mfma_f32_16x16x32_bf16 v[184:187], v[92:95], a[232:235], v[184:187]
    v_add_f32_dpp v234, v234, v234 row_bcast:31 row_mask:0xc bank_mask:0xf
    v_add_f32_dpp v235, v235, v235 row_bcast:31 row_mask:0xc bank_mask:0xf
    v_mfma_f32_16x16x32_bf16 v[172:175], v[92:95], a[228:231], v[172:175]
    v_readlane_b32 s7, v232, 63
    v_readlane_b32 s6, v233, 63
    v_mfma_f32_16x16x32_bf16 v[168:171], v[92:95], a[224:227], v[168:171]
    v_readlane_b32 s62, v234, 63
    v_mfma_f32_16x16x32_bf16 v[96:99], v[72:75], a[240:243], v[96:99]
    ds_read_b64_tr_b16 v[88:89], v14 offset:12288
    ds_read_b64_tr_b16 v[90:91], v14 offset:12800
    v_mfma_f32_16x16x32_bf16 v[100:103], v[72:75], a[244:247], v[100:103]
    v_readlane_b32 s47, v235, 63
    v_lshlrev_b32 v214, 3, v0
    v_mfma_f32_16x16x32_bf16 v[112:115], v[72:75], a[248:251], v[112:115]
    v_mov_b32 v215, 2146435072
    v_writelane_b32 v212, s7, 0
    s_waitcnt lgkmcnt(2)
    v_mfma_f32_16x16x32_bf16 v[116:119], v[72:75], a[252:255], v[116:119]
    v_writelane_b32 v212, s6, 1
    v_mfma_f32_16x16x32_bf16 v[124:127], v[76:79], a[252:255], v[124:127]
    ds_read_b64_tr_b16 v[92:93], v14 offset:20512
    ds_read_b64_tr_b16 v[94:95], v14 offset:21024
    v_mfma_f32_16x16x32_bf16 v[120:123], v[76:79], a[248:251], v[120:123]
    v_writelane_b32 v212, s62, 2
    v_writelane_b32 v212, s47, 3
    v_mfma_f32_16x16x32_bf16 v[108:111], v[76:79], a[244:247], v[108:111]
    v_cvt_pk_bf16_f32 v212, v212, v212
    v_lshlrev_b32 v212, 16, v212
    v_mfma_f32_16x16x32_bf16 v[104:107], v[76:79], a[240:243], v[104:107]
    v_mul_f32 v212, s4, v212
    v_mfma_f32_16x16x32_bf16 v[128:131], v[80:83], a[240:243], v[128:131]
    v_exp_f32 v212, v212
    v_mfma_f32_16x16x32_bf16 v[132:135], v[80:83], a[244:247], v[132:135]
    v_cmp_gt_u32 vcc, 4, v0
    v_add_f32 v212, 1.0, v212
    v_rcp_f32 v212, v212
    v_cndmask_b32 v214, v215, v214, vcc
    v_mfma_f32_16x16x32_bf16 v[144:147], v[80:83], a[248:251], v[144:147]
    v_cvt_pk_bf16_f32 v212, v212, v212
    v_lshlrev_b32 v212, 16, v212
    v_mfma_f32_16x16x32_bf16 v[148:151], v[80:83], a[252:255], v[148:151]
    v_sub_f32 v213, 1.0, v212
    v_mfma_f32_16x16x32_bf16 v[156:159], v[84:87], a[252:255], v[156:159]
    v_cvt_pk_bf16_f32 v213, v213, v213
    v_lshlrev_b32 v213, 16, v213
    v_mfma_f32_16x16x32_bf16 v[152:155], v[84:87], a[248:251], v[152:155]
    buffer_store_dwordx2 v[212:213], v214, s[32:35], s101 offen sc1
    v_mfma_f32_16x16x32_bf16 v[140:143], v[84:87], a[244:247], v[140:143]
    v_add_u32 v13, 81056, v13
    v_add_u32 v14, 81056, v14
    v_mfma_f32_16x16x32_bf16 v[136:139], v[84:87], a[240:243], v[136:139]
    s_lshl_b32 s8, s8, 2
    s_lshl_b32 s9, s48, 7
    s_waitcnt lgkmcnt(0)
    v_mfma_f32_16x16x32_bf16 v[160:163], v[88:91], a[240:243], v[160:163]
    buffer_load_dwordx4 v8, s[16:19], s58 offen sc1 lds
    v_mfma_f32_16x16x32_bf16 v[164:167], v[88:91], a[244:247], v[164:167]
    s_add_u32 s59, s52, 2
    s_and_b32 s59, s59, 7
    s_add_u32 s8, s8, s9
    v_mfma_f32_16x16x32_bf16 v[176:179], v[88:91], a[248:251], v[176:179]
    buffer_load_dwordx4 v9, s[16:19], s58 offen offset:1024 sc1 lds
    v_mfma_f32_16x16x32_bf16 v[180:183], v[88:91], a[252:255], v[180:183]
    s_add_u32 m0, s60, 122080
    s_add_u32 s8, s8, 16842756
    v_mfma_f32_16x16x32_bf16 v[188:191], v[92:95], a[252:255], v[188:191]
    v_lshlrev_b32 v4, 7, v0
    v_sub_u32 v4, s8, v4
    v_mfma_f32_16x16x32_bf16 v[184:187], v[92:95], a[248:251], v[184:187]
    buffer_load_dwordx4 v8, s[20:23], s58 offen sc1 lds
    v_mfma_f32_16x16x32_bf16 v[172:175], v[92:95], a[244:247], v[172:175]
    s_min_u32 s8, s48, 2
    s_cmp_eq_u32 s3, 0
    s_cselect_b32 s8, s8, -1
    v_mfma_f32_16x16x32_bf16 v[168:171], v[92:95], a[240:243], v[168:171]
    v_cmp_ge_i32 vcc, s8, v0
    s_nop 1
    v_cndmask_b32 v4, v70, v4, vcc
    v_cndmask_b32 v5, 0, 1, vcc
    s_add_u32 s14, s98, 4096
    s_add_u32 s15, s99, 4096
    s_and_b32 s12, s3, 1
    s_lshl_b32 s13, s53, 1
    s_add_u32 s12, s12, s13
    s_xor_b32 s13, s12, 1
    s_mul_i32 s12, s12, 147456
    s_mul_i32 s13, s13, 147456
    s_add_u32 s12, s12, 6291456
    s_add_u32 s13, s13, 6291456
    v_add_u32 v2, s12, v1
    v_add_u32 v3, s13, v1
    v_add_u32 v16, 512, v29
    v_add_u32 v6, 2048, v29
    v_add_u32 v7, 2560, v29
    v_cndmask_b32 v29, v29, v59, s[44:45]
    v_cndmask_b32 v16, v16, v59, s[44:45]
    v_cndmask_b32 v6, v6, v59, s[44:45]
    v_cndmask_b32 v7, v7, v59, s[44:45]
    s_mov_b32 s6, 0x3eb8aa3b
    buffer_load_dwordx4 v9, s[20:23], s58 offen offset:1024 sc1 lds
    s_add_u32 m0, s60, 89248
    s_mul_i32 s58, s59, 229376
    s_add_u32 s58, s58, 128
    buffer_load_dword v23, v21, s[40:43], 0 offen sc1
    s_mov_b32 s7, s6
    v_pk_mul_f32 v[96:97], v[96:97], s[6:7]
    v_pk_mul_f32 v[98:99], v[98:99], s[6:7]
    v_pk_mul_f32 v[100:101], v[100:101], s[6:7]
    v_pk_mul_f32 v[102:103], v[102:103], s[6:7]
    v_pk_mul_f32 v[104:105], v[104:105], s[6:7]
    v_pk_mul_f32 v[106:107], v[106:107], s[6:7]
    v_pk_mul_f32 v[108:109], v[108:109], s[6:7]
    v_pk_mul_f32 v[110:111], v[110:111], s[6:7]
    v_cvt_pk_bf16_f32 v96, v96, v97
    v_cvt_pk_bf16_f32 v97, v98, v99
    buffer_load_dwordx4 v8, s[16:19], s58 offen sc1 lds
    s_add_u32 s59, s52, 3
    s_and_b32 s59, s59, 7
    v_cvt_pk_bf16_f32 v98, v100, v101
    v_cvt_pk_bf16_f32 v99, v102, v103
    v_cvt_pk_bf16_f32 v100, v104, v105
    v_cvt_pk_bf16_f32 v101, v106, v107
    v_cvt_pk_bf16_f32 v102, v108, v109
    v_cvt_pk_bf16_f32 v103, v110, v111
    v_permlane16_swap_b32 v96, v98
    v_permlane16_swap_b32 v97, v99
    v_permlane16_swap_b32 v100, v102
    v_permlane16_swap_b32 v101, v103
    buffer_store_dwordx4 v[100:103], v1, s[32:35], s97 offen offset:0 sc1
    v_pk_mul_f32 v[112:113], v[112:113], s[6:7]
    v_pk_mul_f32 v[114:115], v[114:115], s[6:7]
    v_pk_mul_f32 v[116:117], v[116:117], s[6:7]
    v_pk_mul_f32 v[118:119], v[118:119], s[6:7]
    v_pk_mul_f32 v[120:121], v[120:121], s[6:7]
    v_pk_mul_f32 v[122:123], v[122:123], s[6:7]
    v_pk_mul_f32 v[124:125], v[124:125], s[6:7]
    v_pk_mul_f32 v[126:127], v[126:127], s[6:7]
    v_cvt_pk_bf16_f32 v112, v112, v113
    v_cvt_pk_bf16_f32 v113, v114, v115
    v_cvt_pk_bf16_f32 v114, v116, v117
    v_cvt_pk_bf16_f32 v115, v118, v119
    v_cvt_pk_bf16_f32 v116, v120, v121
    v_cvt_pk_bf16_f32 v117, v122, v123
    v_cvt_pk_bf16_f32 v118, v124, v125
    v_cvt_pk_bf16_f32 v119, v126, v127
    v_permlane16_swap_b32 v112, v114
    v_permlane16_swap_b32 v113, v115
    v_permlane16_swap_b32 v116, v118
    v_permlane16_swap_b32 v117, v119
    buffer_store_dwordx4 v[116:119], v1, s[32:35], s97 offen offset:1024 sc1
    v_pk_mul_f32 v[52:53], v[128:129], s[4:5]
    v_pk_mul_f32 v[54:55], v[130:131], s[4:5]
    v_pk_mul_f32 v[56:57], v[132:133], s[4:5]
    v_pk_mul_f32 v[58:59], v[134:135], s[4:5]
    v_exp_f32 v52, v52
    v_exp_f32 v53, v53
    v_exp_f32 v54, v54
    v_exp_f32 v55, v55
    v_exp_f32 v56, v56
    v_exp_f32 v57, v57
    v_exp_f32 v58, v58
    v_exp_f32 v59, v59
    v_pk_mul_f32 v[128:129], v[128:129], v[136:137]
    v_pk_mul_f32 v[130:131], v[130:131], v[138:139]
    v_pk_mul_f32 v[132:133], v[132:133], v[140:141]
    v_pk_mul_f32 v[134:135], v[134:135], v[142:143]
    v_pk_add_f32 v[52:53], v[52:53], 1.0 op_sel_hi:[1,0]
    v_pk_add_f32 v[54:55], v[54:55], 1.0 op_sel_hi:[1,0]
    v_pk_add_f32 v[56:57], v[56:57], 1.0 op_sel_hi:[1,0]
    v_pk_add_f32 v[58:59], v[58:59], 1.0 op_sel_hi:[1,0]
    v_rcp_f32 v52, v52
    v_rcp_f32 v53, v53
    v_rcp_f32 v54, v54
    v_rcp_f32 v55, v55
    v_rcp_f32 v56, v56
    v_rcp_f32 v57, v57
    v_rcp_f32 v58, v58
    v_rcp_f32 v59, v59
    v_pk_mul_f32 v[128:129], v[128:129], v[52:53]
    v_pk_mul_f32 v[130:131], v[130:131], v[54:55]
    v_pk_mul_f32 v[132:133], v[132:133], v[56:57]
    v_pk_mul_f32 v[134:135], v[134:135], v[58:59]
    v_cvt_pk_bf16_f32 v136, v128, v129
    v_cvt_pk_bf16_f32 v137, v130, v131
    v_cvt_pk_bf16_f32 v138, v132, v133
    v_cvt_pk_bf16_f32 v139, v134, v135
    s_nop 0
    v_permlane32_swap_b32 v136, v138
    buffer_load_dwordx4 v9, s[16:19], s58 offen offset:1024 sc1 lds
    s_add_u32 m0, s60, 97472
    v_permlane32_swap_b32 v137, v139
    v_pk_mul_f32 v[52:53], v[144:145], s[4:5]
    v_pk_mul_f32 v[54:55], v[146:147], s[4:5]
    v_pk_mul_f32 v[56:57], v[148:149], s[4:5]
    v_pk_mul_f32 v[58:59], v[150:151], s[4:5]
    v_exp_f32 v52, v52
    v_exp_f32 v53, v53
    v_exp_f32 v54, v54
    v_exp_f32 v55, v55
    v_exp_f32 v56, v56
    buffer_load_dwordx4 v8, s[20:23], s58 offen sc1 lds
    v_exp_f32 v57, v57
    v_exp_f32 v58, v58
    v_exp_f32 v59, v59
    v_pk_mul_f32 v[144:145], v[144:145], v[152:153]
    v_pk_mul_f32 v[146:147], v[146:147], v[154:155]
    v_pk_mul_f32 v[148:149], v[148:149], v[156:157]
    v_pk_mul_f32 v[150:151], v[150:151], v[158:159]
    v_pk_add_f32 v[52:53], v[52:53], 1.0 op_sel_hi:[1,0]
    v_pk_add_f32 v[54:55], v[54:55], 1.0 op_sel_hi:[1,0]
    v_pk_add_f32 v[56:57], v[56:57], 1.0 op_sel_hi:[1,0]
    buffer_load_dwordx4 v9, s[20:23], s58 offen offset:1024 sc1 lds
    s_mul_i32 s58, s59, 229376
    s_add_u32 s58, s58, 128
    v_pk_add_f32 v[58:59], v[58:59], 1.0 op_sel_hi:[1,0]
    v_rcp_f32 v52, v52
    v_rcp_f32 v53, v53
    v_rcp_f32 v54, v54
    v_rcp_f32 v55, v55
    v_rcp_f32 v56, v56
    v_rcp_f32 v57, v57
    buffer_store_dwordx4 v[136:139], v62, s[32:35], s98 offen offset:0 sc1
    v_rcp_f32 v58, v58
    v_rcp_f32 v59, v59
    v_pk_mul_f32 v[144:145], v[144:145], v[52:53]
    v_pk_mul_f32 v[146:147], v[146:147], v[54:55]
    v_pk_mul_f32 v[148:149], v[148:149], v[56:57]
    v_pk_mul_f32 v[150:151], v[150:151], v[58:59]
    v_cvt_pk_bf16_f32 v152, v144, v145
    v_cvt_pk_bf16_f32 v153, v146, v147
    v_cvt_pk_bf16_f32 v154, v148, v149
    v_cvt_pk_bf16_f32 v155, v150, v151
    s_nop 0
    v_permlane32_swap_b32 v152, v154
    v_permlane32_swap_b32 v153, v155
    s_waitcnt vmcnt(13)
    s_barrier
    ds_read_b64_tr_b16 v[72:73], v13 offset:0
    ds_read_b64_tr_b16 v[74:75], v13 offset:512
    ds_read_b64_tr_b16 v[76:77], v13 offset:8224
    ds_read_b64_tr_b16 v[78:79], v13 offset:8736
    ds_read_b64_tr_b16 v[80:81], v14 offset:0
    ds_read_b64_tr_b16 v[82:83], v14 offset:512
    s_add_u32 s101, s55, 0
    s_waitcnt lgkmcnt(4)
    v_mfma_f32_16x16x32_bf16 v[192:195], v[72:75], a[0:3], 0
    ds_read_b64_tr_b16 v[84:85], v14 offset:8224
    ds_read_b64_tr_b16 v[86:87], v14 offset:8736
    v_mfma_f32_16x16x32_bf16 v[196:199], v[72:75], a[4:7], 0
    ds_read_b64_tr_b16 v[88:89], v13 offset:4096
    ds_read_b64_tr_b16 v[90:91], v13 offset:4608
    v_mfma_f32_16x16x32_bf16 v[208:211], v[72:75], a[8:11], 0
    s_cmp_ge_u32 s101, 7
    s_cselect_b32 s100, 7, 0
    s_sub_u32 s101, s101, s100
    v_mfma_f32_16x16x32_bf16 v[212:215], v[72:75], a[12:15], 0
    s_mul_i32 s100, s3, 7
    s_add_u32 s101, s101, s100
    s_waitcnt lgkmcnt(2)
    v_mfma_f32_16x16x32_bf16 v[220:223], v[76:79], a[12:15], 0
    ds_read_b64_tr_b16 v[92:93], v13 offset:12320
    ds_read_b64_tr_b16 v[94:95], v13 offset:12832
    v_mfma_f32_16x16x32_bf16 v[216:219], v[76:79], a[8:11], 0
    s_lshl_b32 s100, s101, 16
    s_add_u32 m0, s61, 0
    v_mfma_f32_16x16x32_bf16 v[204:207], v[76:79], a[4:7], 0
    v_mul_f32 v52, s4, v160
    v_mul_f32 v53, s4, v161
    v_mfma_f32_16x16x32_bf16 v[200:203], v[76:79], a[0:3], 0
    v_mul_f32 v54, s4, v162
    v_mfma_f32_16x16x32_bf16 v[224:227], v[80:83], a[0:3], 0
    ds_read_b64_tr_b16 v[72:73], v14 offset:4096
    ds_read_b64_tr_b16 v[74:75], v14 offset:4608
    v_mfma_f32_16x16x32_bf16 v[228:231], v[80:83], a[4:7], 0
    buffer_load_dwordx4 v24, s[24:27], s100 offen sc1 lds
    v_mfma_f32_16x16x32_bf16 v[240:243], v[80:83], a[8:11], 0
    v_mul_f32 v55, s4, v163
    v_mul_f32 v56, s4, v164
    v_mfma_f32_16x16x32_bf16 v[244:247], v[80:83], a[12:15], 0
    v_mul_f32 v57, s4, v165
    v_mfma_f32_16x16x32_bf16 v[252:255], v[84:87], a[12:15], 0
    ds_read_b64_tr_b16 v[76:77], v14 offset:12320
    ds_read_b64_tr_b16 v[78:79], v14 offset:12832
    v_mfma_f32_16x16x32_bf16 v[248:251], v[84:87], a[8:11], 0
    v_subrev_u32 v13, 24608, v13
    v_subrev_u32 v14, 24608, v14
    v_mfma_f32_16x16x32_bf16 v[236:239], v[84:87], a[4:7], 0
    buffer_load_dwordx4 v25, s[24:27], s100 offen offset:1024 sc1 lds
    v_mfma_f32_16x16x32_bf16 v[232:235], v[84:87], a[0:3], 0
    v_mul_f32 v58, s4, v166
    s_waitcnt lgkmcnt(0)
    v_mfma_f32_16x16x32_bf16 v[192:195], v[88:91], a[16:19], v[192:195]
    s_waitcnt vmcnt(9)
    v_cmp_lt_u32 vcc, v23, v22
    s_nop 4
    s_cbranch_vccnz L_spin_1
L_back_2:
    v_mfma_f32_16x16x32_bf16 v[196:199], v[88:91], a[20:23], v[196:199]
    buffer_load_dwordx4 v26, s[24:27], s100 offen offset:2048 sc1 lds
    v_mfma_f32_16x16x32_bf16 v[208:211], v[88:91], a[24:27], v[208:211]
    buffer_load_dwordx4 v27, s[24:27], s100 offen offset:3072 sc1 lds
    v_mfma_f32_16x16x32_bf16 v[212:215], v[88:91], a[28:31], v[212:215]
    s_waitcnt vmcnt(8)
    s_barrier
    v_mfma_f32_16x16x32_bf16 v[220:223], v[92:95], a[28:31], v[220:223]
    ds_read_b64_tr_b16 v[80:81], v13 offset:0
    ds_read_b64_tr_b16 v[82:83], v13 offset:512
    buffer_store_dword v20, v18, s[32:35], 0 offen sc1
    v_mfma_f32_16x16x32_bf16 v[216:219], v[92:95], a[24:27], v[216:219]
    s_add_u32 m0, s60, 64640
    v_mul_f32 v59, s4, v167
    v_mfma_f32_16x16x32_bf16 v[204:207], v[92:95], a[20:23], v[204:207]
    buffer_store_dwordx4 v[152:155], v62, s[32:35], s99 offen offset:0 sc1
    v_mfma_f32_16x16x32_bf16 v[200:203], v[92:95], a[16:19], v[200:203]
    v_mfma_f32_16x16x32_bf16 v[224:227], v[72:75], a[16:19], v[224:227]
    ds_read_b64_tr_b16 v[84:85], v13 offset:8224
    ds_read_b64_tr_b16 v[86:87], v13 offset:8736
    v_mfma_f32_16x16x32_bf16 v[228:231], v[72:75], a[20:23], v[228:231]
    v_exp_f32 v52, v52
    v_mfma_f32_16x16x32_bf16 v[240:243], v[72:75], a[24:27], v[240:243]
    v_exp_f32 v53, v53
    v_mfma_f32_16x16x32_bf16 v[244:247], v[72:75], a[28:31], v[244:247]
    v_mfma_f32_16x16x32_bf16 v[252:255], v[76:79], a[28:31], v[252:255]
    ds_read_b64_tr_b16 v[88:89], v14 offset:0
    ds_read_b64_tr_b16 v[90:91], v14 offset:512
    v_mfma_f32_16x16x32_bf16 v[248:251], v[76:79], a[24:27], v[248:251]
    ds_read_b64_tr_b16 v[92:93], v14 offset:8224
    ds_read_b64_tr_b16 v[94:95], v14 offset:8736
    v_mfma_f32_16x16x32_bf16 v[236:239], v[76:79], a[20:23], v[236:239]
    v_exp_f32 v54, v54
    v_mfma_f32_16x16x32_bf16 v[232:235], v[76:79], a[16:19], v[232:235]
    s_waitcnt lgkmcnt(2)
    v_mfma_f32_16x16x32_bf16 v[192:195], v[80:83], a[32:35], v[192:195]
    ds_read_b64_tr_b16 v[72:73], v13 offset:4096
    ds_read_b64_tr_b16 v[74:75], v13 offset:4608
    v_mfma_f32_16x16x32_bf16 v[196:199], v[80:83], a[36:39], v[196:199]
    v_exp_f32 v55, v55
    v_mfma_f32_16x16x32_bf16 v[208:211], v[80:83], a[40:43], v[208:211]
    buffer_load_dwordx4 v8, s[16:19], s58 offen sc1 lds
    v_mfma_f32_16x16x32_bf16 v[212:215], v[80:83], a[44:47], v[212:215]
    s_add_u32 s59, s52, 4
    s_and_b32 s59, s59, 7
    v_mfma_f32_16x16x32_bf16 v[220:223], v[84:87], a[44:47], v[220:223]
    ds_read_b64_tr_b16 v[76:77], v13 offset:12320
    ds_read_b64_tr_b16 v[78:79], v13 offset:12832
    v_mfma_f32_16x16x32_bf16 v[216:219], v[84:87], a[40:43], v[216:219]
    v_exp_f32 v56, v56
    v_mfma_f32_16x16x32_bf16 v[204:207], v[84:87], a[36:39], v[204:207]
    buffer_load_dwordx4 v9, s[16:19], s58 offen offset:1024 sc1 lds
    v_mfma_f32_16x16x32_bf16 v[200:203], v[84:87], a[32:35], v[200:203]
    s_add_u32 m0, s60, 72864
    v_mfma_f32_16x16x32_bf16 v[224:227], v[88:91], a[32:35], v[224:227]
    ds_read_b64_tr_b16 v[80:81], v14 offset:4096
    ds_read_b64_tr_b16 v[82:83], v14 offset:4608
    v_mfma_f32_16x16x32_bf16 v[228:231], v[88:91], a[36:39], v[228:231]
    v_exp_f32 v57, v57
    v_mfma_f32_16x16x32_bf16 v[240:243], v[88:91], a[40:43], v[240:243]
    buffer_load_dwordx4 v8, s[20:23], s58 offen sc1 lds
    v_mfma_f32_16x16x32_bf16 v[244:247], v[88:91], a[44:47], v[244:247]
    s_waitcnt lgkmcnt(0)
    v_mfma_f32_16x16x32_bf16 v[252:255], v[92:95], a[44:47], v[252:255]
    ds_read_b64_tr_b16 v[84:85], v14 offset:12320
    ds_read_b64_tr_b16 v[86:87], v14 offset:12832
    v_mfma_f32_16x16x32_bf16 v[248:251], v[92:95], a[40:43], v[248:251]
    v_subrev_u32 v13, 24608, v13
    v_subrev_u32 v14, 24608, v14
    v_mfma_f32_16x16x32_bf16 v[236:239], v[92:95], a[36:39], v[236:239]
    buffer_load_dwordx4 v9, s[20:23], s58 offen offset:1024 sc1 lds
    v_mfma_f32_16x16x32_bf16 v[232:235], v[92:95], a[32:35], v[232:235]
    s_add_u32 s100, s100, 32768
    s_add_u32 m0, s61, 16384
    v_mfma_f32_16x16x32_bf16 v[192:195], v[72:75], a[48:51], v[192:195]
    s_mul_i32 s58, s59, 229376
    s_add_u32 s58, s58, 128
    v_mfma_f32_16x16x32_bf16 v[196:199], v[72:75], a[52:55], v[196:199]
    v_exp_f32 v58, v58
    v_mfma_f32_16x16x32_bf16 v[208:211], v[72:75], a[56:59], v[208:211]
    buffer_load_dwordx4 v24, s[24:27], s100 offen sc1 lds
    v_mfma_f32_16x16x32_bf16 v[212:215], v[72:75], a[60:63], v[212:215]
    s_waitcnt vmcnt(12) lgkmcnt(0)
    s_barrier
    v_mfma_f32_16x16x32_bf16 v[220:223], v[76:79], a[60:63], v[220:223]
    ds_read_b64_tr_b16 v[88:89], v13 offset:0
    ds_read_b64_tr_b16 v[90:91], v13 offset:512
    v_mfma_f32_16x16x32_bf16 v[216:219], v[76:79], a[56:59], v[216:219]
    v_exp_f32 v59, v59
    v_mfma_f32_16x16x32_bf16 v[204:207], v[76:79], a[52:55], v[204:207]
    buffer_load_dwordx4 v25, s[24:27], s100 offen offset:1024 sc1 lds
    v_mfma_f32_16x16x32_bf16 v[200:203], v[76:79], a[48:51], v[200:203]
    v_mul_f32 v160, v160, v168
    v_mfma_f32_16x16x32_bf16 v[224:227], v[80:83], a[48:51], v[224:227]
    ds_read_b64_tr_b16 v[92:93], v13 offset:8224
    ds_read_b64_tr_b16 v[94:95], v13 offset:8736
    v_mfma_f32_16x16x32_bf16 v[228:231], v[80:83], a[52:55], v[228:231]
    v_mul_f32 v161, v161, v169
    v_mul_f32 v162, v162, v170
    v_mfma_f32_16x16x32_bf16 v[240:243], v[80:83], a[56:59], v[240:243]
    buffer_load_dwordx4 v26, s[24:27], s100 offen offset:2048 sc1 lds
    v_mfma_f32_16x16x32_bf16 v[244:247], v[80:83], a[60:63], v[244:247]
    v_mul_f32 v163, v163, v171
    v_mfma_f32_16x16x32_bf16 v[252:255], v[84:87], a[60:63], v[252:255]
    ds_read_b64_tr_b16 v[72:73], v14 offset:0
    ds_read_b64_tr_b16 v[74:75], v14 offset:512
    v_mfma_f32_16x16x32_bf16 v[248:251], v[84:87], a[56:59], v[248:251]
    ds_read_b64_tr_b16 v[76:77], v14 offset:8224
    ds_read_b64_tr_b16 v[78:79], v14 offset:8736
    v_mfma_f32_16x16x32_bf16 v[236:239], v[84:87], a[52:55], v[236:239]
    buffer_load_dwordx4 v27, s[24:27], s100 offen offset:3072 sc1 lds
    v_mfma_f32_16x16x32_bf16 v[232:235], v[84:87], a[48:51], v[232:235]
    s_add_u32 m0, s60, 138464
    s_waitcnt lgkmcnt(2)
    v_mfma_f32_16x16x32_bf16 v[192:195], v[88:91], a[64:67], v[192:195]
    ds_read_b64_tr_b16 v[80:81], v13 offset:4096
    ds_read_b64_tr_b16 v[82:83], v13 offset:4608
    v_mfma_f32_16x16x32_bf16 v[196:199], v[88:91], a[68:71], v[196:199]
    buffer_load_dwordx4 v8, s[16:19], s58 offen sc1 lds
    v_mfma_f32_16x16x32_bf16 v[208:211], v[88:91], a[72:75], v[208:211]
    s_add_u32 s59, s52, 5
    s_and_b32 s59, s59, 7
    v_mfma_f32_16x16x32_bf16 v[212:215], v[88:91], a[76:79], v[212:215]
    v_mul_f32 v164, v164, v172
    v_mfma_f32_16x16x32_bf16 v[220:223], v[92:95], a[76:79], v[220:223]
    ds_read_b64_tr_b16 v[84:85], v13 offset:12320
    ds_read_b64_tr_b16 v[86:87], v13 offset:12832
    v_mfma_f32_16x16x32_bf16 v[216:219], v[92:95], a[72:75], v[216:219]
    buffer_load_dwordx4 v9, s[16:19], s58 offen offset:1024 sc1 lds
    v_mfma_f32_16x16x32_bf16 v[204:207], v[92:95], a[68:71], v[204:207]
    s_add_u32 m0, s60, 146688
    v_mul_f32 v165, v165, v173
    v_mfma_f32_16x16x32_bf16 v[200:203], v[92:95], a[64:67], v[200:203]
    v_mul_f32 v166, v166, v174
    v_mfma_f32_16x16x32_bf16 v[224:227], v[72:75], a[64:67], v[224:227]
    ds_read_b64_tr_b16 v[88:89], v14 offset:4096
    ds_read_b64_tr_b16 v[90:91], v14 offset:4608
    v_mfma_f32_16x16x32_bf16 v[228:231], v[72:75], a[68:71], v[228:231]
    buffer_load_dwordx4 v8, s[20:23], s58 offen sc1 lds
    v_mfma_f32_16x16x32_bf16 v[240:243], v[72:75], a[72:75], v[240:243]
    v_mul_f32 v167, v167, v175
    v_add_f32 v52, 1.0, v52
    v_mfma_f32_16x16x32_bf16 v[244:247], v[72:75], a[76:79], v[244:247]
    v_add_f32 v53, 1.0, v53
    s_waitcnt lgkmcnt(0)
    v_mfma_f32_16x16x32_bf16 v[252:255], v[76:79], a[76:79], v[252:255]
    ds_read_b64_tr_b16 v[92:93], v14 offset:12320
    ds_read_b64_tr_b16 v[94:95], v14 offset:12832
    v_mfma_f32_16x16x32_bf16 v[248:251], v[76:79], a[72:75], v[248:251]
    v_subrev_u32 v13, 24608, v13
    v_subrev_u32 v14, 24608, v14
    v_mfma_f32_16x16x32_bf16 v[236:239], v[76:79], a[68:71], v[236:239]
    buffer_load_dwordx4 v9, s[20:23], s58 offen offset:1024 sc1 lds
    v_mfma_f32_16x16x32_bf16 v[232:235], v[76:79], a[64:67], v[232:235]
    s_add_u32 s101, s55, 1
    s_mul_i32 s58, s59, 229376
    v_mfma_f32_16x16x32_bf16 v[192:195], v[80:83], a[80:83], v[192:195]
    s_cmp_ge_u32 s101, 7
    s_cselect_b32 s100, 7, 0
    s_sub_u32 s101, s101, s100
    v_mfma_f32_16x16x32_bf16 v[196:199], v[80:83], a[84:87], v[196:199]
    s_mul_i32 s100, s3, 7
    s_add_u32 s101, s101, s100
    s_lshl_b32 s100, s101, 16
    v_mfma_f32_16x16x32_bf16 v[208:211], v[80:83], a[88:91], v[208:211]
    s_add_u32 m0, s61, 32768
    s_add_u32 s58, s58, 128
    v_mfma_f32_16x16x32_bf16 v[212:215], v[80:83], a[92:95], v[212:215]
    s_waitcnt vmcnt(8) lgkmcnt(0)
    s_barrier
    v_mfma_f32_16x16x32_bf16 v[220:223], v[84:87], a[92:95], v[220:223]
    ds_read_b64_tr_b16 v[72:73], v13 offset:0
    ds_read_b64_tr_b16 v[74:75], v13 offset:512
    v_mfma_f32_16x16x32_bf16 v[216:219], v[84:87], a[88:91], v[216:219]
    buffer_load_dwordx4 v24, s[24:27], s100 offen sc1 lds
    v_mfma_f32_16x16x32_bf16 v[204:207], v[84:87], a[84:87], v[204:207]
    buffer_load_dwordx4 v25, s[24:27], s100 offen offset:1024 sc1 lds
    v_mfma_f32_16x16x32_bf16 v[200:203], v[84:87], a[80:83], v[200:203]
    v_add_f32 v54, 1.0, v54
    v_mfma_f32_16x16x32_bf16 v[224:227], v[88:91], a[80:83], v[224:227]
    ds_read_b64_tr_b16 v[76:77], v13 offset:8224
    ds_read_b64_tr_b16 v[78:79], v13 offset:8736
    v_mfma_f32_16x16x32_bf16 v[228:231], v[88:91], a[84:87], v[228:231]
    buffer_load_dwordx4 v26, s[24:27], s100 offen offset:2048 sc1 lds
    v_mfma_f32_16x16x32_bf16 v[240:243], v[88:91], a[88:91], v[240:243]
    v_add_f32 v55, 1.0, v55
    v_add_f32 v56, 1.0, v56
    v_mfma_f32_16x16x32_bf16 v[244:247], v[88:91], a[92:95], v[244:247]
    v_add_f32 v57, 1.0, v57
    v_mfma_f32_16x16x32_bf16 v[252:255], v[92:95], a[92:95], v[252:255]
    ds_read_b64_tr_b16 v[80:81], v14 offset:0
    ds_read_b64_tr_b16 v[82:83], v14 offset:512
    v_mfma_f32_16x16x32_bf16 v[248:251], v[92:95], a[88:91], v[248:251]
    ds_read_b64_tr_b16 v[84:85], v14 offset:8224
    ds_read_b64_tr_b16 v[86:87], v14 offset:8736
    v_mfma_f32_16x16x32_bf16 v[236:239], v[92:95], a[84:87], v[236:239]
    buffer_load_dwordx4 v27, s[24:27], s100 offen offset:3072 sc1 lds
    v_mfma_f32_16x16x32_bf16 v[232:235], v[92:95], a[80:83], v[232:235]
    s_add_u32 m0, s60, 113856
    s_waitcnt lgkmcnt(2)
    v_mfma_f32_16x16x32_bf16 v[192:195], v[72:75], a[96:99], v[192:195]
    ds_read_b64_tr_b16 v[88:89], v13 offset:4096
    ds_read_b64_tr_b16 v[90:91], v13 offset:4608
    v_mfma_f32_16x16x32_bf16 v[196:199], v[72:75], a[100:103], v[196:199]
    buffer_load_dwordx4 v8, s[16:19], s58 offen sc1 lds
    v_mfma_f32_16x16x32_bf16 v[208:211], v[72:75], a[104:107], v[208:211]
    s_add_u32 s59, s52, 6
    s_and_b32 s59, s59, 7
    v_mfma_f32_16x16x32_bf16 v[212:215], v[72:75], a[108:111], v[212:215]
    v_add_f32 v58, 1.0, v58
    v_mfma_f32_16x16x32_bf16 v[220:223], v[76:79], a[108:111], v[220:223]
    ds_read_b64_tr_b16 v[92:93], v13 offset:12320
    ds_read_b64_tr_b16 v[94:95], v13 offset:12832
    v_mfma_f32_16x16x32_bf16 v[216:219], v[76:79], a[104:107], v[216:219]
    buffer_load_dwordx4 v9, s[16:19], s58 offen offset:1024 sc1 lds
    v_mfma_f32_16x16x32_bf16 v[204:207], v[76:79], a[100:103], v[204:207]
    s_add_u32 m0, s60, 122080
    v_add_f32 v59, 1.0, v59
    v_mfma_f32_16x16x32_bf16 v[200:203], v[76:79], a[96:99], v[200:203]
    v_mfma_f32_16x16x32_bf16 v[224:227], v[80:83], a[96:99], v[224:227]
    ds_read_b64_tr_b16 v[72:73], v14 offset:4096
    ds_read_b64_tr_b16 v[74:75], v14 offset:4608
    v_mfma_f32_16x16x32_bf16 v[228:231], v[80:83], a[100:103], v[228:231]
    buffer_load_dwordx4 v8, s[20:23], s58 offen sc1 lds
    v_mfma_f32_16x16x32_bf16 v[240:243], v[80:83], a[104:107], v[240:243]
    v_rcp_f32 v52, v52
    v_mfma_f32_16x16x32_bf16 v[244:247], v[80:83], a[108:111], v[244:247]
    s_waitcnt lgkmcnt(0)
    v_mfma_f32_16x16x32_bf16 v[252:255], v[84:87], a[108:111], v[252:255]
    ds_read_b64_tr_b16 v[76:77], v14 offset:12320
    ds_read_b64_tr_b16 v[78:79], v14 offset:12832
    v_mfma_f32_16x16x32_bf16 v[248:251], v[84:87], a[104:107], v[248:251]
    v_add_u32 v13, 73824, v13
    v_add_u32 v14, 73824, v14
    v_mfma_f32_16x16x32_bf16 v[236:239], v[84:87], a[100:103], v[236:239]
    buffer_load_dwordx4 v9, s[20:23], s58 offen offset:1024 sc1 lds
    v_mfma_f32_16x16x32_bf16 v[232:235], v[84:87], a[96:99], v[232:235]
    s_add_u32 m0, s60, 89248
    s_mul_i32 s58, s59, 229376
    v_mfma_f32_16x16x32_bf16 v[192:195], v[88:91], a[112:115], v[192:195]
    s_add_u32 s58, s58, 128
    v_mfma_f32_16x16x32_bf16 v[196:199], v[88:91], a[116:119], v[196:199]
    buffer_load_dword v23, v4, s[32:35], 0 offen sc1
    v_mfma_f32_16x16x32_bf16 v[208:211], v[88:91], a[120:123], v[208:211]
    s_lshl_b32 s10, s48, 2
    s_lshr_b32 s8, s3, 1
    s_mul_i32 s9, s8, 6
    v_mfma_f32_16x16x32_bf16 v[212:215], v[88:91], a[124:127], v[212:215]
    s_waitcnt vmcnt(9) lgkmcnt(0)
    s_barrier
    v_mfma_f32_16x16x32_bf16 v[220:223], v[92:95], a[124:127], v[220:223]
    ds_read_b64_tr_b16 v[80:81], v13 offset:0
    ds_read_b64_tr_b16 v[82:83], v13 offset:512
    v_mfma_f32_16x16x32_bf16 v[216:219], v[92:95], a[120:123], v[216:219]
    buffer_load_dwordx4 v8, s[16:19], s58 offen sc1 lds
    v_mfma_f32_16x16x32_bf16 v[204:207], v[92:95], a[116:119], v[204:207]
    s_add_u32 s59, s52, 7
    s_and_b32 s59, s59, 7
    s_add_u32 s10, s10, s9
    v_mfma_f32_16x16x32_bf16 v[200:203], v[92:95], a[112:115], v[200:203]
    s_sub_u32 s10, s10, 8
    s_mul_i32 s13, s8, 12480
    v_mfma_f32_16x16x32_bf16 v[224:227], v[72:75], a[112:115], v[224:227]
    ds_read_b64_tr_b16 v[84:85], v13 offset:8224
    ds_read_b64_tr_b16 v[86:87], v13 offset:8736
    v_mfma_f32_16x16x32_bf16 v[228:231], v[72:75], a[116:119], v[228:231]
    buffer_load_dwordx4 v9, s[16:19], s58 offen offset:1024 sc1 lds
    v_mfma_f32_16x16x32_bf16 v[240:243], v[72:75], a[120:123], v[240:243]
    s_add_u32 m0, s60, 97472
    s_and_b32 s8, s3, 1
    s_mul_i32 s9, s8, 24960
    v_mfma_f32_16x16x32_bf16 v[244:247], v[72:75], a[124:127], v[244:247]
    s_add_u32 s13, s13, s9
    s_lshl_b32 s12, s49, 6
    v_mfma_f32_16x16x32_bf16 v[252:255], v[76:79], a[124:127], v[252:255]
    ds_read_b64_tr_b16 v[88:89], v14 offset:0
    ds_read_b64_tr_b16 v[90:91], v14 offset:512
    v_mfma_f32_16x16x32_bf16 v[248:251], v[76:79], a[120:123], v[248:251]
    ds_read_b64_tr_b16 v[92:93], v14 offset:8224
    ds_read_b64_tr_b16 v[94:95], v14 offset:8736
    v_mfma_f32_16x16x32_bf16 v[236:239], v[76:79], a[116:119], v[236:239]
    buffer_load_dwordx4 v8, s[20:23], s58 offen sc1 lds
    v_mfma_f32_16x16x32_bf16 v[232:235], v[76:79], a[112:115], v[232:235]
    s_add_u32 s8, s12, s10
    s_lshl_b32 s97, s8, 11
    s_waitcnt lgkmcnt(2)
    v_mfma_f32_16x16x32_bf16 v[192:195], v[80:83], a[128:131], v[192:195]
    ds_read_b64_tr_b16 v[72:73], v13 offset:4096
    ds_read_b64_tr_b16 v[74:75], v13 offset:4608
    v_mfma_f32_16x16x32_bf16 v[196:199], v[80:83], a[132:135], v[196:199]
    buffer_load_dwordx4 v9, s[20:23], s58 offen offset:1024 sc1 lds
    v_mfma_f32_16x16x32_bf16 v[208:211], v[80:83], a[136:139], v[208:211]
    s_add_u32 m0, s60, 64640
    s_mul_i32 s58, s59, 229376
    s_add_u32 s58, s58, 128
    v_mfma_f32_16x16x32_bf16 v[212:215], v[80:83], a[140:143], v[212:215]
    s_add_u32 s97, s97, 2097152
    s_add_u32 s12, s12, s46
    v_mfma_f32_16x16x32_bf16 v[220:223], v[84:87], a[140:143], v[220:223]
    ds_read_b64_tr_b16 v[76:77], v13 offset:12320
    ds_read_b64_tr_b16 v[78:79], v13 offset:12832
    v_mfma_f32_16x16x32_bf16 v[216:219], v[84:87], a[136:139], v[216:219]
    s_add_u32 s12, s12, 8
    s_lshl_b32 s12, s12, 10
    v_mfma_f32_16x16x32_bf16 v[204:207], v[84:87], a[132:135], v[204:207]
    buffer_load_dwordx4 v8, s[16:19], s58 offen sc1 lds
    v_mfma_f32_16x16x32_bf16 v[200:203], v[84:87], a[128:131], v[200:203]
    v_accvgpr_write_b32 a120, v96
    v_mfma_f32_16x16x32_bf16 v[224:227], v[88:91], a[128:131], v[224:227]
    ds_read_b64_tr_b16 v[80:81], v14 offset:4096
    ds_read_b64_tr_b16 v[82:83], v14 offset:4608
    v_mfma_f32_16x16x32_bf16 v[228:231], v[88:91], a[132:135], v[228:231]
    buffer_load_dwordx4 v9, s[16:19], s58 offen offset:1024 sc1 lds
    v_mfma_f32_16x16x32_bf16 v[240:243], v[88:91], a[136:139], v[240:243]
    s_add_u32 m0, s60, 72864
    v_accvgpr_write_b32 a121, v97
    v_mfma_f32_16x16x32_bf16 v[244:247], v[88:91], a[140:143], v[244:247]
    v_accvgpr_write_b32 a122, v98
    s_waitcnt lgkmcnt(0)
    v_mfma_f32_16x16x32_bf16 v[252:255], v[92:95], a[140:143], v[252:255]
    ds_read_b64_tr_b16 v[84:85], v14 offset:12320
    ds_read_b64_tr_b16 v[86:87], v14 offset:12832
    v_mfma_f32_16x16x32_bf16 v[248:251], v[92:95], a[136:139], v[248:251]
    v_subrev_u32 v13, 24608, v13
    v_subrev_u32 v14, 24608, v14
    v_mfma_f32_16x16x32_bf16 v[236:239], v[92:95], a[132:135], v[236:239]
    buffer_load_dwordx4 v8, s[20:23], s58 offen sc1 lds
    v_mfma_f32_16x16x32_bf16 v[232:235], v[92:95], a[128:131], v[232:235]
    v_accvgpr_write_b32 a123, v99
    v_mfma_f32_16x16x32_bf16 v[192:195], v[72:75], a[144:147], v[192:195]
    buffer_load_dwordx4 v9, s[20:23], s58 offen offset:1024 sc1 lds
    v_mfma_f32_16x16x32_bf16 v[196:199], v[72:75], a[148:151], v[196:199]
    v_accvgpr_write_b32 a124, v112
    v_accvgpr_write_b32 a125, v113
    v_mfma_f32_16x16x32_bf16 v[208:211], v[72:75], a[152:155], v[208:211]
    v_accvgpr_write_b32 a126, v114
    v_accvgpr_write_b32 a127, v115
    v_mfma_f32_16x16x32_bf16 v[212:215], v[72:75], a[156:159], v[212:215]
    s_waitcnt vmcnt(8)
    v_cmp_lt_u32 vcc, v23, v5
    s_nop 4
    s_cbranch_vccnz L_spin_3
L_back_4:
    s_waitcnt lgkmcnt(0)
    s_barrier
    v_mfma_f32_16x16x32_bf16 v[220:223], v[76:79], a[156:159], v[220:223]
    ds_read_b64_tr_b16 v[88:89], v13 offset:0
    ds_read_b64_tr_b16 v[90:91], v13 offset:512
    v_mfma_f32_16x16x32_bf16 v[216:219], v[76:79], a[152:155], v[216:219]
    s_lshr_b32 s8, s53, 1
    s_lshl_b32 s8, s8, 7
    s_sub_u32 s8, s8, 64
    v_mfma_f32_16x16x32_bf16 v[204:207], v[76:79], a[148:151], v[204:207]
    s_lshl_b32 s9, s48, 7
    v_mov_b32 v11, s8
    v_mfma_f32_16x16x32_bf16 v[200:203], v[76:79], a[144:147], v[200:203]
    v_mov_b32 v12, s9
    v_mfma_f32_16x16x32_bf16 v[224:227], v[80:83], a[144:147], v[224:227]
    ds_read_b64_tr_b16 v[92:93], v13 offset:8224
    ds_read_b64_tr_b16 v[94:95], v13 offset:8736
    v_mfma_f32_16x16x32_bf16 v[228:231], v[80:83], a[148:151], v[228:231]
    v_cmp_gt_u32 vcc, 16, v0
    s_nop 1
    v_cndmask_b32 v11, v11, v12, vcc
    v_mfma_f32_16x16x32_bf16 v[240:243], v[80:83], a[152:155], v[240:243]
    v_lshl_add_u32 v11, v0, 2, v11
    v_add_u32 v11, 16842752, v11
    v_mfma_f32_16x16x32_bf16 v[244:247], v[80:83], a[156:159], v[244:247]
    s_cmp_eq_u32 s3, 0
    s_cselect_b32 s8, 32, 0
    v_mfma_f32_16x16x32_bf16 v[252:255], v[84:87], a[156:159], v[252:255]
    ds_read_b64_tr_b16 v[72:73], v14 offset:0
    ds_read_b64_tr_b16 v[74:75], v14 offset:512
    v_mfma_f32_16x16x32_bf16 v[248:251], v[84:87], a[152:155], v[248:251]
    ds_read_b64_tr_b16 v[76:77], v14 offset:8224
    ds_read_b64_tr_b16 v[78:79], v14 offset:8736
    v_mfma_f32_16x16x32_bf16 v[236:239], v[84:87], a[148:151], v[236:239]
    v_cmp_gt_u32 vcc, s8, v0
    s_nop 1
    v_cndmask_b32 v11, v70, v11, vcc
    v_cndmask_b32 v12, 0, 1, vcc
    v_mfma_f32_16x16x32_bf16 v[232:235], v[84:87], a[144:147], v[232:235]
    s_waitcnt lgkmcnt(2)
    v_mfma_f32_16x16x32_bf16 v[192:195], v[88:91], a[160:163], v[192:195]
    ds_read_b64_tr_b16 v[80:81], v13 offset:4096
    ds_read_b64_tr_b16 v[82:83], v13 offset:4608
    v_mfma_f32_16x16x32_bf16 v[196:199], v[88:91], a[164:167], v[196:199]
    v_rcp_f32 v53, v53
    v_mfma_f32_16x16x32_bf16 v[208:211], v[88:91], a[168:171], v[208:211]
    v_rcp_f32 v54, v54
    v_mfma_f32_16x16x32_bf16 v[212:215], v[88:91], a[172:175], v[212:215]
    v_mfma_f32_16x16x32_bf16 v[220:223], v[92:95], a[172:175], v[220:223]
    ds_read_b64_tr_b16 v[84:85], v13 offset:12320
    ds_read_b64_tr_b16 v[86:87], v13 offset:12832
    v_mfma_f32_16x16x32_bf16 v[216:219], v[92:95], a[168:171], v[216:219]
    v_rcp_f32 v55, v55
    v_mfma_f32_16x16x32_bf16 v[204:207], v[92:95], a[164:167], v[204:207]
    v_rcp_f32 v56, v56
    v_mfma_f32_16x16x32_bf16 v[200:203], v[92:95], a[160:163], v[200:203]
    v_mfma_f32_16x16x32_bf16 v[224:227], v[72:75], a[160:163], v[224:227]
    ds_read_b64_tr_b16 v[88:89], v14 offset:4096
    ds_read_b64_tr_b16 v[90:91], v14 offset:4608
    v_mfma_f32_16x16x32_bf16 v[228:231], v[72:75], a[164:167], v[228:231]
    v_rcp_f32 v57, v57
    v_mfma_f32_16x16x32_bf16 v[240:243], v[72:75], a[168:171], v[240:243]
    v_rcp_f32 v58, v58
    v_mfma_f32_16x16x32_bf16 v[244:247], v[72:75], a[172:175], v[244:247]
    s_waitcnt lgkmcnt(0)
    v_mfma_f32_16x16x32_bf16 v[252:255], v[76:79], a[172:175], v[252:255]
    ds_read_b64_tr_b16 v[92:93], v14 offset:12320
    ds_read_b64_tr_b16 v[94:95], v14 offset:12832
    v_mfma_f32_16x16x32_bf16 v[248:251], v[76:79], a[168:171], v[248:251]
    v_subrev_u32 v13, 24608, v13
    v_subrev_u32 v14, 24608, v14
    v_mfma_f32_16x16x32_bf16 v[236:239], v[76:79], a[164:167], v[236:239]
    v_rcp_f32 v59, v59
    v_mfma_f32_16x16x32_bf16 v[232:235], v[76:79], a[160:163], v[232:235]
    v_mul_f32 v160, v160, v52
    v_mfma_f32_16x16x32_bf16 v[192:195], v[80:83], a[176:179], v[192:195]
    v_mul_f32 v161, v161, v53
    v_mul_f32 v162, v162, v54
    v_mfma_f32_16x16x32_bf16 v[196:199], v[80:83], a[180:183], v[196:199]
    v_mul_f32 v163, v163, v55
    v_mul_f32 v164, v164, v56
    v_mfma_f32_16x16x32_bf16 v[208:211], v[80:83], a[184:187], v[208:211]
    v_mul_f32 v165, v165, v57
    v_mul_f32 v166, v166, v58
    v_mfma_f32_16x16x32_bf16 v[212:215], v[80:83], a[188:191], v[212:215]
    s_waitcnt vmcnt(4) lgkmcnt(0)
    s_barrier
    v_mfma_f32_16x16x32_bf16 v[220:223], v[84:87], a[188:191], v[220:223]
    ds_read_b64_tr_b16 v[72:73], v13 offset:0
    ds_read_b64_tr_b16 v[74:75], v13 offset:512
    v_mfma_f32_16x16x32_bf16 v[216:219], v[84:87], a[184:187], v[216:219]
    s_add_u32 s11, s97, 0
    s_cmp_ge_i32 s10, 0
    s_cselect_b32 s11, s11, 2146435072
    v_mfma_f32_16x16x32_bf16 v[204:207], v[84:87], a[180:183], v[204:207]
    ds_write_b64 v63, v[60:61]
    s_add_u32 m0, s13, 113856
    v_mfma_f32_16x16x32_bf16 v[200:203], v[84:87], a[176:179], v[200:203]
    ds_write_b64 v63, v[60:61] offset:8
    v_mfma_f32_16x16x32_bf16 v[224:227], v[88:91], a[176:179], v[224:227]
    ds_read_b64_tr_b16 v[76:77], v13 offset:8224
    ds_read_b64_tr_b16 v[78:79], v13 offset:8736
    v_mfma_f32_16x16x32_bf16 v[228:231], v[88:91], a[180:183], v[228:231]
    buffer_load_dwordx4 v1, s[32:35], s11 offen sc1 lds
    v_mfma_f32_16x16x32_bf16 v[240:243], v[88:91], a[184:187], v[240:243]
    buffer_load_dwordx4 v1, s[32:35], s11 offen offset:1024 sc1 lds
    v_mfma_f32_16x16x32_bf16 v[244:247], v[88:91], a[188:191], v[244:247]
    v_mul_f32 v167, v167, v59
    v_mfma_f32_16x16x32_bf16 v[252:255], v[92:95], a[188:191], v[252:255]
    ds_read_b64_tr_b16 v[80:81], v14 offset:0
    ds_read_b64_tr_b16 v[82:83], v14 offset:512
    v_mfma_f32_16x16x32_bf16 v[248:251], v[92:95], a[184:187], v[248:251]
    ds_read_b64_tr_b16 v[84:85], v14 offset:8224
    ds_read_b64_tr_b16 v[86:87], v14 offset:8736
    v_mfma_f32_16x16x32_bf16 v[236:239], v[92:95], a[180:183], v[236:239]
    buffer_load_dwordx4 v1, s[32:35], s11 offen offset:2048 sc1 lds
    v_mfma_f32_16x16x32_bf16 v[232:235], v[92:95], a[176:179], v[232:235]
    v_cvt_pk_bf16_f32 v168, v160, v161
    s_waitcnt lgkmcnt(2)
    v_mfma_f32_16x16x32_bf16 v[192:195], v[72:75], a[192:195], v[192:195]
    ds_read_b64_tr_b16 v[88:89], v13 offset:4096
    ds_read_b64_tr_b16 v[90:91], v13 offset:4608
    v_mfma_f32_16x16x32_bf16 v[196:199], v[72:75], a[196:199], v[196:199]
    buffer_load_dwordx4 v1, s[32:35], s11 offen offset:3072 sc1 lds
    v_mfma_f32_16x16x32_bf16 v[208:211], v[72:75], a[200:203], v[208:211]
    s_add_u32 s11, s97, 4096
    s_cmp_ge_i32 s10, -2
    s_cselect_b32 s11, s11, 2146435072
    v_mfma_f32_16x16x32_bf16 v[212:215], v[72:75], a[204:207], v[212:215]
    s_add_u32 m0, s13, 118016
    v_mfma_f32_16x16x32_bf16 v[220:223], v[76:79], a[204:207], v[220:223]
    ds_read_b64_tr_b16 v[92:93], v13 offset:12320
    ds_read_b64_tr_b16 v[94:95], v13 offset:12832
    v_mfma_f32_16x16x32_bf16 v[216:219], v[76:79], a[200:203], v[216:219]
    buffer_load_dwordx4 v1, s[32:35], s11 offen sc1 lds
    v_mfma_f32_16x16x32_bf16 v[204:207], v[76:79], a[196:199], v[204:207]
    v_cvt_pk_bf16_f32 v169, v162, v163
    v_cvt_pk_bf16_f32 v170, v164, v165
    v_mfma_f32_16x16x32_bf16 v[200:203], v[76:79], a[192:195], v[200:203]
    v_cvt_pk_bf16_f32 v171, v166, v167
    v_mfma_f32_16x16x32_bf16 v[224:227], v[80:83], a[192:195], v[224:227]
    ds_read_b64_tr_b16 v[72:73], v14 offset:4096
    ds_read_b64_tr_b16 v[74:75], v14 offset:4608
    v_mfma_f32_16x16x32_bf16 v[228:231], v[80:83], a[196:199], v[228:231]
    buffer_load_dwordx4 v1, s[32:35], s11 offen offset:1024 sc1 lds
    v_mfma_f32_16x16x32_bf16 v[240:243], v[80:83], a[200:203], v[240:243]
    v_permlane32_swap_b32 v168, v170
    v_permlane32_swap_b32 v169, v171
    v_mfma_f32_16x16x32_bf16 v[244:247], v[80:83], a[204:207], v[244:247]
    v_mul_f32 v52, s4, v176
    s_waitcnt lgkmcnt(0)
    v_mfma_f32_16x16x32_bf16 v[252:255], v[84:87], a[204:207], v[252:255]
    ds_read_b64_tr_b16 v[76:77], v14 offset:12320
    ds_read_b64_tr_b16 v[78:79], v14 offset:12832
    v_mfma_f32_16x16x32_bf16 v[248:251], v[84:87], a[200:203], v[248:251]
    buffer_load_dword v23, v11, s[32:35], 0 offen sc1
    v_mfma_f32_16x16x32_bf16 v[236:239], v[84:87], a[196:199], v[236:239]
    v_subrev_u32 v13, 24608, v13
    v_subrev_u32 v14, 24608, v14
    v_mfma_f32_16x16x32_bf16 v[232:235], v[84:87], a[192:195], v[232:235]
    v_mul_f32 v53, s4, v177
    v_mfma_f32_16x16x32_bf16 v[192:195], v[88:91], a[208:211], v[192:195]
    buffer_load_dwordx4 v1, s[32:35], s11 offen offset:2048 sc1 lds
    v_mfma_f32_16x16x32_bf16 v[196:199], v[88:91], a[212:215], v[196:199]
    v_mul_f32 v54, s4, v178
    v_mul_f32 v55, s4, v179
    v_mfma_f32_16x16x32_bf16 v[208:211], v[88:91], a[216:219], v[208:211]
    v_mul_f32 v56, s4, v180
    v_mul_f32 v57, s4, v181
    v_mfma_f32_16x16x32_bf16 v[212:215], v[88:91], a[220:223], v[212:215]
    s_waitcnt vmcnt(8) lgkmcnt(0)
    s_barrier
    v_mfma_f32_16x16x32_bf16 v[220:223], v[92:95], a[220:223], v[220:223]
    ds_read_b64_tr_b16 v[80:81], v13 offset:0
    ds_read_b64_tr_b16 v[82:83], v13 offset:512
    v_mfma_f32_16x16x32_bf16 v[216:219], v[92:95], a[216:219], v[216:219]
    buffer_load_dwordx4 v1, s[32:35], s11 offen offset:3072 sc1 lds
    v_mfma_f32_16x16x32_bf16 v[204:207], v[92:95], a[212:215], v[204:207]
    s_add_u32 s11, s97, 8192
    s_cmp_ge_i32 s10, -4
    s_cselect_b32 s11, s11, 2146435072
    v_mfma_f32_16x16x32_bf16 v[200:203], v[92:95], a[208:211], v[200:203]
    s_add_u32 m0, s13, 122176
    v_mfma_f32_16x16x32_bf16 v[224:227], v[72:75], a[208:211], v[224:227]
    ds_read_b64_tr_b16 v[84:85], v13 offset:8224
    ds_read_b64_tr_b16 v[86:87], v13 offset:8736
    v_mfma_f32_16x16x32_bf16 v[228:231], v[72:75], a[212:215], v[228:231]
    buffer_load_dwordx4 v1, s[32:35], s11 offen sc1 lds
    v_mfma_f32_16x16x32_bf16 v[240:243], v[72:75], a[216:219], v[240:243]
    v_mul_f32 v58, s4, v182
    v_mul_f32 v59, s4, v183
    v_mfma_f32_16x16x32_bf16 v[244:247], v[72:75], a[220:223], v[244:247]
    v_mfma_f32_16x16x32_bf16 v[252:255], v[76:79], a[220:223], v[252:255]
    ds_read_b64_tr_b16 v[88:89], v14 offset:0
    ds_read_b64_tr_b16 v[90:91], v14 offset:512
    v_mfma_f32_16x16x32_bf16 v[248:251], v[76:79], a[216:219], v[248:251]
    ds_read_b64_tr_b16 v[92:93], v14 offset:8224
    ds_read_b64_tr_b16 v[94:95], v14 offset:8736
    v_mfma_f32_16x16x32_bf16 v[236:239], v[76:79], a[212:215], v[236:239]
    buffer_load_dwordx4 v1, s[32:35], s11 offen offset:1024 sc1 lds
    v_mfma_f32_16x16x32_bf16 v[232:235], v[76:79], a[208:211], v[232:235]
    s_waitcnt lgkmcnt(2)
    v_mfma_f32_16x16x32_bf16 v[192:195], v[80:83], a[224:227], v[192:195]
    ds_read_b64_tr_b16 v[72:73], v13 offset:4096
    ds_read_b64_tr_b16 v[74:75], v13 offset:4608
    v_mfma_f32_16x16x32_bf16 v[196:199], v[80:83], a[228:231], v[196:199]
    buffer_load_dwordx4 v1, s[32:35], s11 offen offset:2048 sc1 lds
    v_mfma_f32_16x16x32_bf16 v[208:211], v[80:83], a[232:235], v[208:211]
    v_exp_f32 v52, v52
    v_mfma_f32_16x16x32_bf16 v[212:215], v[80:83], a[236:239], v[212:215]
    v_mfma_f32_16x16x32_bf16 v[220:223], v[84:87], a[236:239], v[220:223]
    ds_read_b64_tr_b16 v[76:77], v13 offset:12320
    ds_read_b64_tr_b16 v[78:79], v13 offset:12832
    v_mfma_f32_16x16x32_bf16 v[216:219], v[84:87], a[232:235], v[216:219]
    buffer_load_dwordx4 v1, s[32:35], s11 offen offset:3072 sc1 lds
    v_mfma_f32_16x16x32_bf16 v[204:207], v[84:87], a[228:231], v[204:207]
    v_exp_f32 v53, v53
    v_mfma_f32_16x16x32_bf16 v[200:203], v[84:87], a[224:227], v[200:203]
    v_mfma_f32_16x16x32_bf16 v[224:227], v[88:91], a[224:227], v[224:227]
    ds_read_b64_tr_b16 v[80:81], v14 offset:4096
    ds_read_b64_tr_b16 v[82:83], v14 offset:4608
    v_mfma_f32_16x16x32_bf16 v[228:231], v[88:91], a[228:231], v[228:231]
    v_exp_f32 v54, v54
    v_mfma_f32_16x16x32_bf16 v[240:243], v[88:91], a[232:235], v[240:243]
    v_exp_f32 v55, v55
    v_mfma_f32_16x16x32_bf16 v[244:247], v[88:91], a[236:239], v[244:247]
    s_waitcnt lgkmcnt(0)
    v_mfma_f32_16x16x32_bf16 v[252:255], v[92:95], a[236:239], v[252:255]
    ds_read_b64_tr_b16 v[84:85], v14 offset:12320
    ds_read_b64_tr_b16 v[86:87], v14 offset:12832
    v_mfma_f32_16x16x32_bf16 v[248:251], v[92:95], a[232:235], v[248:251]
    v_exp_f32 v56, v56
    v_mfma_f32_16x16x32_bf16 v[236:239], v[92:95], a[228:231], v[236:239]
    v_exp_f32 v57, v57
    v_mfma_f32_16x16x32_bf16 v[232:235], v[92:95], a[224:227], v[232:235]
    v_mfma_f32_16x16x32_bf16 v[192:195], v[72:75], a[240:243], v[192:195]
    v_exp_f32 v58, v58
    v_mfma_f32_16x16x32_bf16 v[196:199], v[72:75], a[244:247], v[196:199]
    v_exp_f32 v59, v59
    v_mfma_f32_16x16x32_bf16 v[208:211], v[72:75], a[248:251], v[208:211]
    v_mul_f32 v176, v176, v184
    v_mul_f32 v177, v177, v185
    v_mfma_f32_16x16x32_bf16 v[212:215], v[72:75], a[252:255], v[212:215]
    s_waitcnt vmcnt(6)
    v_cmp_lt_u32 vcc, v23, v12
    s_nop 4
    s_cbranch_vccnz L_spin_5
L_back_6:
    s_waitcnt lgkmcnt(0)
    s_barrier
    v_mfma_f32_16x16x32_bf16 v[220:223], v[76:79], a[252:255], v[220:223]
    v_mul_f32 v178, v178, v186
    v_mul_f32 v179, v179, v187
    v_mfma_f32_16x16x32_bf16 v[216:219], v[76:79], a[248:251], v[216:219]
    v_mul_f32 v180, v180, v188
    v_mul_f32 v181, v181, v189
    v_mfma_f32_16x16x32_bf16 v[204:207], v[76:79], a[244:247], v[204:207]
    v_mul_f32 v182, v182, v190
    v_mul_f32 v183, v183, v191
    v_mfma_f32_16x16x32_bf16 v[200:203], v[76:79], a[240:243], v[200:203]
    v_add_f32 v52, 1.0, v52
    v_mfma_f32_16x16x32_bf16 v[224:227], v[80:83], a[240:243], v[224:227]
    v_add_f32 v53, 1.0, v53
    v_add_f32 v54, 1.0, v54
    v_mfma_f32_16x16x32_bf16 v[228:231], v[80:83], a[244:247], v[228:231]
    v_add_f32 v55, 1.0, v55
    v_add_f32 v56, 1.0, v56
    v_mfma_f32_16x16x32_bf16 v[240:243], v[80:83], a[248:251], v[240:243]
    v_add_f32 v57, 1.0, v57
    v_add_f32 v58, 1.0, v58
    v_mfma_f32_16x16x32_bf16 v[244:247], v[80:83], a[252:255], v[244:247]
    v_add_f32 v59, 1.0, v59
    v_mfma_f32_16x16x32_bf16 v[252:255], v[84:87], a[252:255], v[252:255]
    v_rcp_f32 v52, v52
    v_rcp_f32 v53, v53
    v_rcp_f32 v54, v54
    v_rcp_f32 v55, v55
    v_rcp_f32 v56, v56
    v_rcp_f32 v57, v57
    v_rcp_f32 v58, v58
    v_rcp_f32 v59, v59
    v_mul_f32 v176, v176, v52
    v_mul_f32 v177, v177, v53
    v_mul_f32 v178, v178, v54
    v_mul_f32 v179, v179, v55
    v_mul_f32 v180, v180, v56
    v_mul_f32 v181, v181, v57
    v_mul_f32 v182, v182, v58
    v_mul_f32 v183, v183, v59
    v_cvt_pk_bf16_f32 v184, v176, v177
    v_cvt_pk_bf16_f32 v185, v178, v179
    v_cvt_pk_bf16_f32 v186, v180, v181
    v_cvt_pk_bf16_f32 v187, v182, v183
    s_nop 0
    v_permlane32_swap_b32 v184, v186
    v_permlane32_swap_b32 v185, v187
    v_mfma_f32_16x16x32_bf16 v[248:251], v[84:87], a[248:251], v[248:251]
    buffer_store_dwordx4 v[168:171], v62, s[32:35], s98 offen offset:1024 sc1
    v_mfma_f32_16x16x32_bf16 v[236:239], v[84:87], a[244:247], v[236:239]
    buffer_store_dwordx4 v[184:187], v62, s[32:35], s99 offen offset:1024 sc1
    v_mfma_f32_16x16x32_bf16 v[232:235], v[84:87], a[240:243], v[232:235]
    s_add_u32 s12, s46, 8
    s_lshl_b32 s12, s12, 8
    s_add_u32 s12, s12, 16777216
    v_lshlrev_b32 v70, 3, v0
    v_pk_mul_f32 v[52:53], v[192:193], s[4:5]
    v_pk_mul_f32 v[54:55], v[194:195], s[4:5]
    v_pk_mul_f32 v[56:57], v[196:197], s[4:5]
    v_pk_mul_f32 v[58:59], v[198:199], s[4:5]
    v_exp_f32 v52, v52
    v_exp_f32 v53, v53
    v_exp_f32 v54, v54
    v_exp_f32 v55, v55
    v_exp_f32 v56, v56
    v_exp_f32 v57, v57
    v_exp_f32 v58, v58
    v_exp_f32 v59, v59
    v_pk_mul_f32 v[192:193], v[192:193], v[200:201]
    v_pk_mul_f32 v[194:195], v[194:195], v[202:203]
    v_pk_mul_f32 v[196:197], v[196:197], v[204:205]
    v_pk_mul_f32 v[198:199], v[198:199], v[206:207]
    v_pk_add_f32 v[52:53], v[52:53], 1.0 op_sel_hi:[1,0]
    v_pk_add_f32 v[54:55], v[54:55], 1.0 op_sel_hi:[1,0]
    v_pk_add_f32 v[56:57], v[56:57], 1.0 op_sel_hi:[1,0]
    v_pk_add_f32 v[58:59], v[58:59], 1.0 op_sel_hi:[1,0]
    v_rcp_f32 v52, v52
    v_rcp_f32 v53, v53
    v_rcp_f32 v54, v54
    v_rcp_f32 v55, v55
    v_rcp_f32 v56, v56
    v_rcp_f32 v57, v57
    v_rcp_f32 v58, v58
    v_rcp_f32 v59, v59
    v_pk_mul_f32 v[192:193], v[192:193], v[52:53]
    v_pk_mul_f32 v[194:195], v[194:195], v[54:55]
    v_pk_mul_f32 v[196:197], v[196:197], v[56:57]
    v_pk_mul_f32 v[198:199], v[198:199], v[58:59]
    v_cvt_pk_bf16_f32 v40, v192, v193
    buffer_load_dword v30, v70, s[32:35], s12 offen sc1
    v_cvt_pk_bf16_f32 v41, v194, v195
    v_cvt_pk_bf16_f32 v42, v196, v197
    v_cvt_pk_bf16_f32 v43, v198, v199
    v_pk_mul_f32 v[52:53], v[208:209], s[4:5]
    v_pk_mul_f32 v[54:55], v[210:211], s[4:5]
    v_permlane32_swap_b32 v40, v42
    v_permlane32_swap_b32 v41, v43
    v_pk_mul_f32 v[56:57], v[212:213], s[4:5]
    v_pk_mul_f32 v[58:59], v[214:215], s[4:5]
    v_exp_f32 v52, v52
    v_exp_f32 v53, v53
    v_exp_f32 v54, v54
    buffer_store_dwordx4 v[40:43], v62, s[32:35], s14 offen offset:0 sc1
    v_exp_f32 v55, v55
    v_exp_f32 v56, v56
    v_exp_f32 v57, v57
    v_exp_f32 v58, v58
    v_exp_f32 v59, v59
    v_pk_mul_f32 v[208:209], v[208:209], v[216:217]
    v_pk_mul_f32 v[210:211], v[210:211], v[218:219]
    v_pk_mul_f32 v[212:213], v[212:213], v[220:221]
    v_pk_mul_f32 v[214:215], v[214:215], v[222:223]
    v_pk_add_f32 v[52:53], v[52:53], 1.0 op_sel_hi:[1,0]
    v_pk_add_f32 v[54:55], v[54:55], 1.0 op_sel_hi:[1,0]
    v_pk_add_f32 v[56:57], v[56:57], 1.0 op_sel_hi:[1,0]
    v_pk_add_f32 v[58:59], v[58:59], 1.0 op_sel_hi:[1,0]
    v_rcp_f32 v52, v52
    v_rcp_f32 v53, v53
    v_rcp_f32 v54, v54
    v_rcp_f32 v55, v55
    v_rcp_f32 v56, v56
    v_rcp_f32 v57, v57
    v_rcp_f32 v58, v58
    v_rcp_f32 v59, v59
    v_pk_mul_f32 v[208:209], v[208:209], v[52:53]
    v_pk_mul_f32 v[210:211], v[210:211], v[54:55]
    v_pk_mul_f32 v[212:213], v[212:213], v[56:57]
    v_pk_mul_f32 v[214:215], v[214:215], v[58:59]
    v_cvt_pk_bf16_f32 v44, v208, v209
    v_cvt_pk_bf16_f32 v45, v210, v211
    v_cvt_pk_bf16_f32 v46, v212, v213
    v_cvt_pk_bf16_f32 v47, v214, v215
    v_pk_mul_f32 v[52:53], v[224:225], s[4:5]
    v_pk_mul_f32 v[54:55], v[226:227], s[4:5]
    s_waitcnt vmcnt(4)
    s_barrier
    v_permlane32_swap_b32 v44, v46
    ds_read_b128 a[80:83], v28 offset:0
    ds_read_b128 a[112:115], v28 offset:16640
    ds_read_b128 a[84:87], v28 offset:2048
    ds_read_b128 a[0:3], v29 offset:0
    ds_read_b128 a[64:67], v29 offset:16640
    ds_read_b128 a[4:7], v16 offset:0
    ds_read_b128 a[68:71], v16 offset:16640
    ds_read_b128 a[88:91], v28 offset:4160
    ds_read_b128 a[8:11], v6 offset:0
    ds_read_b128 a[12:15], v7 offset:0
    ds_read_b128 a[92:95], v28 offset:6208
    ds_read_b128 a[16:19], v29 offset:4160
    v_permlane32_swap_b32 v45, v47
    buffer_store_dwordx4 v[44:47], v62, s[32:35], s15 offen offset:0 sc1
    v_pk_mul_f32 v[56:57], v[228:229], s[4:5]
    v_pk_mul_f32 v[58:59], v[230:231], s[4:5]
    v_exp_f32 v52, v52
    v_exp_f32 v53, v53
    v_exp_f32 v54, v54
    v_exp_f32 v55, v55
    v_exp_f32 v56, v56
    v_exp_f32 v57, v57
    v_exp_f32 v58, v58
    v_exp_f32 v59, v59
    v_pk_mul_f32 v[224:225], v[224:225], v[232:233]
    v_pk_mul_f32 v[226:227], v[226:227], v[234:235]
    v_pk_mul_f32 v[228:229], v[228:229], v[236:237]
    v_pk_mul_f32 v[230:231], v[230:231], v[238:239]
    v_pk_add_f32 v[52:53], v[52:53], 1.0 op_sel_hi:[1,0]
    v_pk_add_f32 v[54:55], v[54:55], 1.0 op_sel_hi:[1,0]
    v_pk_add_f32 v[56:57], v[56:57], 1.0 op_sel_hi:[1,0]
    v_pk_add_f32 v[58:59], v[58:59], 1.0 op_sel_hi:[1,0]
    v_rcp_f32 v52, v52
    v_rcp_f32 v53, v53
    v_rcp_f32 v54, v54
    v_rcp_f32 v55, v55
    v_rcp_f32 v56, v56
    v_rcp_f32 v57, v57
    v_rcp_f32 v58, v58
    v_rcp_f32 v59, v59
    v_pk_mul_f32 v[224:225], v[224:225], v[52:53]
    v_pk_mul_f32 v[226:227], v[226:227], v[54:55]
    v_pk_mul_f32 v[228:229], v[228:229], v[56:57]
    v_pk_mul_f32 v[230:231], v[230:231], v[58:59]
    v_cvt_pk_bf16_f32 v48, v224, v225
    v_cvt_pk_bf16_f32 v49, v226, v227
    v_cvt_pk_bf16_f32 v50, v228, v229
    v_cvt_pk_bf16_f32 v51, v230, v231
    v_pk_mul_f32 v[52:53], v[240:241], s[4:5]
    v_pk_mul_f32 v[54:55], v[242:243], s[4:5]
    v_permlane32_swap_b32 v48, v50
    v_permlane32_swap_b32 v49, v51
    buffer_store_dwordx4 v[48:51], v62, s[32:35], s14 offen offset:1024 sc1
    v_pk_mul_f32 v[56:57], v[244:245], s[4:5]
    v_pk_mul_f32 v[58:59], v[246:247], s[4:5]
    v_exp_f32 v52, v52
    v_exp_f32 v53, v53
    v_exp_f32 v54, v54
    v_exp_f32 v55, v55
    v_exp_f32 v56, v56
    v_exp_f32 v57, v57
    v_exp_f32 v58, v58
    v_exp_f32 v59, v59
    v_pk_mul_f32 v[240:241], v[240:241], v[248:249]
    v_pk_mul_f32 v[242:243], v[242:243], v[250:251]
    v_pk_mul_f32 v[244:245], v[244:245], v[252:253]
    v_pk_mul_f32 v[246:247], v[246:247], v[254:255]
    v_pk_add_f32 v[52:53], v[52:53], 1.0 op_sel_hi:[1,0]
    v_pk_add_f32 v[54:55], v[54:55], 1.0 op_sel_hi:[1,0]
    v_pk_add_f32 v[56:57], v[56:57], 1.0 op_sel_hi:[1,0]
    v_pk_add_f32 v[58:59], v[58:59], 1.0 op_sel_hi:[1,0]
    v_rcp_f32 v52, v52
    v_rcp_f32 v53, v53
    v_rcp_f32 v54, v54
    v_rcp_f32 v55, v55
    v_rcp_f32 v56, v56
    v_rcp_f32 v57, v57
    v_rcp_f32 v58, v58
    v_rcp_f32 v59, v59
    v_pk_mul_f32 v[240:241], v[240:241], v[52:53]
    v_pk_mul_f32 v[242:243], v[242:243], v[54:55]
    v_pk_mul_f32 v[244:245], v[244:245], v[56:57]
    v_pk_mul_f32 v[246:247], v[246:247], v[58:59]
    v_cvt_pk_bf16_f32 v40, v240, v241
    v_cvt_pk_bf16_f32 v41, v242, v243
    v_cvt_pk_bf16_f32 v42, v244, v245
    v_cvt_pk_bf16_f32 v43, v246, v247
    s_nop 0
    v_permlane32_swap_b32 v40, v42
    v_permlane32_swap_b32 v41, v43
    buffer_store_dwordx4 v[40:43], v62, s[32:35], s15 offen offset:1024 sc1
    s_nop 1
    s_branch L_attn
L_typeR:
    v_lshlrev_b32 v1, 4, v0
    s_mov_b32 s32, s84
    s_mov_b32 s33, s85
    s_mov_b32 s34, 17039360
    s_mov_b32 s35, 0x20000
    s_add_u32 s59, s52, 1
    s_and_b32 s59, s59, 7
    s_lshl_b32 s56, s59, 7
    s_mul_i32 s57, s59, 196608
    s_add_u32 s58, s57, 1024
    s_add_u32 m0, s61, 41024
    s_nop 0
    buffer_load_dwordx4 v2, s[8:11], s56 offen sc1 lds
    buffer_load_dwordx4 v3, s[8:11], s56 offen offset:1024 sc1 lds
    buffer_load_dwordx4 v4, s[8:11], s56 offen offset:2048 sc1 lds
    buffer_load_dwordx4 v5, s[8:11], s56 offen offset:3072 sc1 lds
    s_add_u32 m0, s60, 57408
    s_nop 0
    buffer_load_dwordx4 v6, s[12:15], s57 offen sc1 lds
    v_lshrrev_b32 v40, 4, v0
    v_and_b32 v41, 15, v0
    v_bfe_u32 v42, v0, 2, 2
    v_and_b32 v43, 3, v0
    v_lshlrev_b32 v43, 3, v43
    v_lshrrev_b32 v44, 5, v0
    v_and_b32 v45, 1, v40
    s_lshr_b32 s6, s3, 1
    s_lshl_b32 s6, s6, 6
    v_add_lshl_u32 v46, s6, v41, 7
    v_lshrrev_b32 v47, 1, v41
    v_xor_b32 v47, v47, v40
    v_lshl_add_u32 v11, v47, 4, v46
    v_xor_b32 v12, 64, v11
    v_lshl_add_u32 v46, v40, 3, v42
    s_and_b32 s7, s3, 1
    v_lshrrev_b32 v47, 1, v42
    v_xor_b32 v47, s7, v47
    v_lshl_add_u32 v47, v47, 1, v45
    v_lshl_add_u32 v47, v47, 5, v43
    v_lshl_add_u32 v47, v46, 7, v47
    v_add_u32 v13, 16384, v47
    v_xor_b32 v14, 32, v13
    v_mul_u32_u24 v46, 192, v46
    v_add_u32 v46, v46, v43
    s_mul_i32 s7, s7, 3
    v_add_u32 v46, 138464, v46
    s_add_u32 s6, s7, 0
    v_xor_b32 v47, s6, v45
    v_lshl_add_u32 v56, v47, 5, v46
    s_add_u32 s6, s7, 1
    v_xor_b32 v47, s6, v45
    v_lshl_add_u32 v57, v47, 5, v46
    s_add_u32 s6, s7, 2
    v_xor_b32 v47, s6, v45
    v_lshl_add_u32 v58, v47, 5, v46
    s_mov_b32 s16, s72
    s_mov_b32 s17, s73
    s_mov_b32 s18, 1835008
    s_mov_b32 s19, 0x20000
    s_mov_b32 s20, s74
    s_mov_b32 s21, s75
    s_mov_b32 s22, 1835008
    s_mov_b32 s23, 0x20000
    s_mul_i32 s7, s51, 96
    s_add_u32 s7, s7, 32
    s_add_u32 s87, s87, s7
    s_lshl_b32 s6, s87, 1
    s_mul_i32 s7, s3, 192
    s_mov_b32 s98, 0x15555556
    s_mul_i32 s62, s3, 3072
    v_add_u32 v46, s7, v0
    v_mul_hi_u32 v47, v46, s98
    v_mul_u32_u24 v48, 12, v47
    v_sub_u32 v48, v46, v48
    v_bfe_u32 v46, v47, 3, 1
    v_lshlrev_b32 v46, 1, v46
    v_xor_b32 v48, v48, v46
    v_mul_u32_u24 v47, 3584, v47
    v_lshl_add_u32 v47, v48, 4, v47
    v_add_u32 v8, s6, v47
    v_add_u32 v46, s7, v0
    v_add_u32 v46, 64, v46
    v_mul_hi_u32 v47, v46, s98
    v_mul_u32_u24 v48, 12, v47
    v_sub_u32 v48, v46, v48
    v_bfe_u32 v46, v47, 3, 1
    v_lshlrev_b32 v46, 1, v46
    v_xor_b32 v48, v48, v46
    v_mul_u32_u24 v47, 3584, v47
    v_lshl_add_u32 v47, v48, 4, v47
    v_add_u32 v9, s6, v47
    v_subrev_u32 v9, 1024, v9
    v_add_u32 v46, s7, v0
    v_add_u32 v46, 128, v46
    v_mul_hi_u32 v47, v46, s98
    v_mul_u32_u24 v48, 12, v47
    v_sub_u32 v48, v46, v48
    v_bfe_u32 v46, v47, 3, 1
    v_lshlrev_b32 v46, 1, v46
    v_xor_b32 v48, v48, v46
    v_mul_u32_u24 v47, 3584, v47
    v_lshl_add_u32 v47, v48, 4, v47
    v_add_u32 v10, s6, v47
    v_subrev_u32 v10, 2048, v10
    s_mov_b32 s40, s82
    s_mov_b32 s41, s83
    s_mov_b32 s42, 256
    s_mov_b32 s43, 0x20000
    s_mov_b32 s24, s76
    s_mov_b32 s25, s77
    s_mov_b32 s26, 1835008
    s_mov_b32 s27, 0x20000
    s_mov_b32 s28, s68
    s_mov_b32 s29, s69
    s_mov_b32 s30, 524288
    s_mov_b32 s31, 0x20000
    s_mov_b32 s36, s80
    s_mov_b32 s37, s81
    s_mov_b32 s38, 2097152
    s_mov_b32 s39, 0x20000
    v_mov_b32 v20, 1
    s_mov_b32 s4, 0xbfb8aa3b
    s_mov_b32 s5, 0xbfb8aa3b
    buffer_load_dwordx4 v7, s[12:15], s57 offen offset:1024 sc1 lds
    s_add_u32 m0, s60, 65600
    s_nop 0
    buffer_load_dwordx4 v6, s[12:15], s58 offen sc1 lds
    buffer_load_dwordx4 v7, s[12:15], s58 offen offset:1024 sc1 lds
    s_waitcnt vmcnt(8)
    s_barrier
    ds_read_b128 a[0:3], v11 offset:0
    ds_read_b64_tr_b16 v[72:73], v13 offset:0
    ds_read_b64_tr_b16 v[74:75], v13 offset:512
    ds_read_b128 a[4:7], v11 offset:2048
    ds_read_b128 a[8:11], v11 offset:4096
    ds_read_b128 a[12:15], v11 offset:6144
    ds_read_b64_tr_b16 v[76:77], v14 offset:0
    ds_read_b64_tr_b16 v[78:79], v14 offset:512
    s_add_u32 s59, s52, 2
    s_and_b32 s59, s59, 7
    s_waitcnt lgkmcnt(5)
    v_mfma_f32_16x16x32_bf16 v[96:99], v[72:75], a[0:3], 0
    ds_read_b64_tr_b16 v[80:81], v13 offset:8192
    ds_read_b64_tr_b16 v[82:83], v13 offset:8704
    s_waitcnt lgkmcnt(6)
    v_mfma_f32_16x16x32_bf16 v[100:103], v[72:75], a[4:7], 0
    ds_read_b128 a[16:19], v12 offset:0
    s_lshl_b32 s56, s59, 7
    s_waitcnt lgkmcnt(3)
    v_mfma_f32_16x16x32_bf16 v[108:111], v[76:79], a[4:7], 0
    v_mfma_f32_16x16x32_bf16 v[104:107], v[76:79], a[0:3], 0
    s_mul_i32 s57, s59, 196608
    s_add_u32 s58, s57, 1024
    v_mfma_f32_16x16x32_bf16 v[112:115], v[72:75], a[8:11], 0
    ds_read_b64_tr_b16 v[84:85], v14 offset:8192
    ds_read_b64_tr_b16 v[86:87], v14 offset:8704
    v_mfma_f32_16x16x32_bf16 v[116:119], v[72:75], a[12:15], 0
    ds_read_b128 a[20:23], v12 offset:2048
    s_add_u32 m0, s61, 82048
    v_mfma_f32_16x16x32_bf16 v[124:127], v[76:79], a[12:15], 0
    buffer_load_dwordx4 v2, s[8:11], s56 offen sc1 lds
    v_mfma_f32_16x16x32_bf16 v[120:123], v[76:79], a[8:11], 0
    s_add_u32 s59, s52, 3
    s_and_b32 s59, s59, 7
    s_waitcnt lgkmcnt(1)
    v_mfma_f32_16x16x32_bf16 v[128:131], a[0:3], v[80:83], 0
    ds_read_b64_tr_b16 v[88:89], v13 offset:4096
    ds_read_b64_tr_b16 v[90:91], v13 offset:4608
    v_mfma_f32_16x16x32_bf16 v[136:139], a[4:7], v[80:83], 0
    ds_read_b128 a[24:27], v12 offset:4096
    v_add_u32 v11, 41024, v11
    v_mfma_f32_16x16x32_bf16 v[144:147], a[8:11], v[80:83], 0
    buffer_load_dwordx4 v3, s[8:11], s56 offen offset:1024 sc1 lds
    v_mfma_f32_16x16x32_bf16 v[152:155], a[12:15], v[80:83], 0
    v_mfma_f32_16x16x32_bf16 v[156:159], a[12:15], v[84:87], 0
    ds_read_b64_tr_b16 v[92:93], v14 offset:4096
    ds_read_b64_tr_b16 v[94:95], v14 offset:4608
    v_mfma_f32_16x16x32_bf16 v[148:151], a[8:11], v[84:87], 0
    ds_read_b128 a[28:31], v12 offset:6144
    v_mfma_f32_16x16x32_bf16 v[140:143], a[4:7], v[84:87], 0
    buffer_load_dwordx4 v4, s[8:11], s56 offen offset:2048 sc1 lds
    v_mfma_f32_16x16x32_bf16 v[132:135], a[0:3], v[84:87], 0
    v_add_u32 v12, 41024, v12
    s_waitcnt lgkmcnt(1)
    v_mfma_f32_16x16x32_bf16 v[96:99], v[88:91], a[16:19], v[96:99]
    ds_read_b64_tr_b16 v[72:73], v13 offset:12288
    ds_read_b64_tr_b16 v[74:75], v13 offset:12800
    v_mfma_f32_16x16x32_bf16 v[100:103], v[88:91], a[20:23], v[100:103]
    ds_read_b64_tr_b16 v[76:77], v14 offset:12288
    ds_read_b64_tr_b16 v[78:79], v14 offset:12800
    v_mfma_f32_16x16x32_bf16 v[112:115], v[88:91], a[24:27], v[112:115]
    buffer_load_dwordx4 v5, s[8:11], s56 offen offset:3072 sc1 lds
    s_waitcnt lgkmcnt(4)
    v_mfma_f32_16x16x32_bf16 v[116:119], v[88:91], a[28:31], v[116:119]
    s_waitcnt vmcnt(4) lgkmcnt(0)
    s_barrier
    v_add_u32 v13, 41024, v13
    v_add_u32 v14, 41024, v14
    v_mfma_f32_16x16x32_bf16 v[124:127], v[92:95], a[28:31], v[124:127]
    ds_read_b64_tr_b16 v[80:81], v13 offset:0
    ds_read_b64_tr_b16 v[82:83], v13 offset:512
    v_mfma_f32_16x16x32_bf16 v[120:123], v[92:95], a[24:27], v[120:123]
    s_add_u32 m0, s60, 98432
    s_lshl_b32 s56, s59, 7
    buffer_load_dwordx4 v6, s[12:15], s57 offen sc1 lds
    buffer_load_dwordx4 v7, s[12:15], s57 offen offset:1024 sc1 lds
    s_add_u32 m0, s60, 106624
    s_nop 0
    buffer_load_dwordx4 v6, s[12:15], s58 offen sc1 lds
    buffer_load_dwordx4 v7, s[12:15], s58 offen offset:1024 sc1 lds
    v_mfma_f32_16x16x32_bf16 v[108:111], v[92:95], a[20:23], v[108:111]
    v_mfma_f32_16x16x32_bf16 v[104:107], v[92:95], a[16:19], v[104:107]
    s_add_u32 m0, s61, 0
    s_mul_i32 s57, s59, 196608
    v_mfma_f32_16x16x32_bf16 v[128:131], a[16:19], v[72:75], v[128:131]
    ds_read_b64_tr_b16 v[84:85], v14 offset:0
    ds_read_b64_tr_b16 v[86:87], v14 offset:512
    v_mfma_f32_16x16x32_bf16 v[136:139], a[20:23], v[72:75], v[136:139]
    ds_read_b128 a[32:35], v11 offset:0
    s_add_u32 s58, s57, 1024
    v_mfma_f32_16x16x32_bf16 v[144:147], a[24:27], v[72:75], v[144:147]
    buffer_load_dwordx4 v2, s[8:11], s56 offen sc1 lds
    v_mfma_f32_16x16x32_bf16 v[152:155], a[28:31], v[72:75], v[152:155]
    ds_read_b128 a[36:39], v11 offset:2048
    v_mfma_f32_16x16x32_bf16 v[156:159], a[28:31], v[76:79], v[156:159]
    ds_read_b64_tr_b16 v[88:89], v13 offset:8192
    ds_read_b64_tr_b16 v[90:91], v13 offset:8704
    v_mfma_f32_16x16x32_bf16 v[148:151], a[24:27], v[76:79], v[148:151]
    ds_read_b128 a[40:43], v11 offset:4096
    s_add_u32 s59, s52, 4
    v_mfma_f32_16x16x32_bf16 v[140:143], a[20:23], v[76:79], v[140:143]
    buffer_load_dwordx4 v3, s[8:11], s56 offen offset:1024 sc1 lds
    v_mfma_f32_16x16x32_bf16 v[132:135], a[16:19], v[76:79], v[132:135]
    ds_read_b128 a[44:47], v11 offset:6144
    s_waitcnt lgkmcnt(2)
    v_mfma_f32_16x16x32_bf16 v[96:99], v[80:83], a[32:35], v[96:99]
    ds_read_b64_tr_b16 v[92:93], v14 offset:8192
    ds_read_b64_tr_b16 v[94:95], v14 offset:8704
    v_mfma_f32_16x16x32_bf16 v[100:103], v[80:83], a[36:39], v[100:103]
    ds_read_b128 a[48:51], v12 offset:0
    s_and_b32 s59, s59, 7
    v_mfma_f32_16x16x32_bf16 v[108:111], v[84:87], a[36:39], v[108:111]
    buffer_load_dwordx4 v4, s[8:11], s56 offen offset:2048 sc1 lds
    v_mfma_f32_16x16x32_bf16 v[104:107], v[84:87], a[32:35], v[104:107]
    v_add_u32 v11, 41024, v11
    s_waitcnt lgkmcnt(1)
    v_mfma_f32_16x16x32_bf16 v[112:115], v[80:83], a[40:43], v[112:115]
    ds_read_b64_tr_b16 v[72:73], v13 offset:4096
    ds_read_b64_tr_b16 v[74:75], v13 offset:4608
    v_mfma_f32_16x16x32_bf16 v[116:119], v[80:83], a[44:47], v[116:119]
    ds_read_b128 a[52:55], v12 offset:2048
    v_mfma_f32_16x16x32_bf16 v[124:127], v[84:87], a[44:47], v[124:127]
    buffer_load_dwordx4 v5, s[8:11], s56 offen offset:3072 sc1 lds
    v_mfma_f32_16x16x32_bf16 v[120:123], v[84:87], a[40:43], v[120:123]
    s_add_u32 m0, s60, 16384
    s_lshl_b32 s56, s59, 7
    v_mfma_f32_16x16x32_bf16 v[128:131], a[32:35], v[88:91], v[128:131]
    ds_read_b64_tr_b16 v[76:77], v14 offset:4096
    ds_read_b64_tr_b16 v[78:79], v14 offset:4608
    v_mfma_f32_16x16x32_bf16 v[136:139], a[36:39], v[88:91], v[136:139]
    ds_read_b128 a[56:59], v12 offset:4096
    v_mfma_f32_16x16x32_bf16 v[144:147], a[40:43], v[88:91], v[144:147]
    buffer_load_dwordx4 v6, s[12:15], s57 offen sc1 lds
    v_mfma_f32_16x16x32_bf16 v[152:155], a[44:47], v[88:91], v[152:155]
    v_mfma_f32_16x16x32_bf16 v[156:159], a[44:47], v[92:95], v[156:159]
    ds_read_b64_tr_b16 v[80:81], v13 offset:12288
    ds_read_b64_tr_b16 v[82:83], v13 offset:12800
    v_mfma_f32_16x16x32_bf16 v[148:151], a[40:43], v[92:95], v[148:151]
    ds_read_b128 a[60:63], v12 offset:6144
    v_mfma_f32_16x16x32_bf16 v[140:143], a[36:39], v[92:95], v[140:143]
    buffer_load_dwordx4 v7, s[12:15], s57 offen offset:1024 sc1 lds
    v_mfma_f32_16x16x32_bf16 v[132:135], a[32:35], v[92:95], v[132:135]
    s_add_u32 m0, s60, 24576
    s_mul_i32 s57, s59, 196608
    s_waitcnt lgkmcnt(1)
    v_mfma_f32_16x16x32_bf16 v[96:99], v[72:75], a[48:51], v[96:99]
    ds_read_b64_tr_b16 v[84:85], v14 offset:12288
    ds_read_b64_tr_b16 v[86:87], v14 offset:12800
    v_mfma_f32_16x16x32_bf16 v[100:103], v[72:75], a[52:55], v[100:103]
    v_add_u32 v13, 41024, v13
    v_add_u32 v14, 41024, v14
    v_mfma_f32_16x16x32_bf16 v[112:115], v[72:75], a[56:59], v[112:115]
    buffer_load_dwordx4 v6, s[12:15], s58 offen sc1 lds
    s_waitcnt lgkmcnt(2)
    v_mfma_f32_16x16x32_bf16 v[116:119], v[72:75], a[60:63], v[116:119]
    s_waitcnt vmcnt(7) lgkmcnt(0)
    s_barrier
    v_mfma_f32_16x16x32_bf16 v[124:127], v[76:79], a[60:63], v[124:127]
    ds_read_b64_tr_b16 v[88:89], v13 offset:0
    ds_read_b64_tr_b16 v[90:91], v13 offset:512
    v_mfma_f32_16x16x32_bf16 v[120:123], v[76:79], a[56:59], v[120:123]
    buffer_load_dwordx4 v7, s[12:15], s58 offen offset:1024 sc1 lds
    v_mfma_f32_16x16x32_bf16 v[108:111], v[76:79], a[52:55], v[108:111]
    v_mfma_f32_16x16x32_bf16 v[104:107], v[76:79], a[48:51], v[104:107]
    s_add_u32 m0, s61, 41024
    s_add_u32 s58, s57, 1024
    v_mfma_f32_16x16x32_bf16 v[128:131], a[48:51], v[80:83], v[128:131]
    ds_read_b64_tr_b16 v[92:93], v14 offset:0
    ds_read_b64_tr_b16 v[94:95], v14 offset:512
    v_mfma_f32_16x16x32_bf16 v[136:139], a[52:55], v[80:83], v[136:139]
    ds_read_b128 a[64:67], v11 offset:0
    v_add_u32 v12, 41024, v12
    v_mfma_f32_16x16x32_bf16 v[144:147], a[56:59], v[80:83], v[144:147]
    buffer_load_dwordx4 v2, s[8:11], s56 offen sc1 lds
    v_mfma_f32_16x16x32_bf16 v[152:155], a[60:63], v[80:83], v[152:155]
    ds_read_b128 a[68:71], v11 offset:2048
    v_mfma_f32_16x16x32_bf16 v[156:159], a[60:63], v[84:87], v[156:159]
    ds_read_b64_tr_b16 v[72:73], v13 offset:8192
    ds_read_b64_tr_b16 v[74:75], v13 offset:8704
    v_mfma_f32_16x16x32_bf16 v[148:151], a[56:59], v[84:87], v[148:151]
    ds_read_b128 a[72:75], v11 offset:4096
    s_add_u32 s59, s52, 5
    v_mfma_f32_16x16x32_bf16 v[140:143], a[52:55], v[84:87], v[140:143]
    buffer_load_dwordx4 v3, s[8:11], s56 offen offset:1024 sc1 lds
    v_mfma_f32_16x16x32_bf16 v[132:135], a[48:51], v[84:87], v[132:135]
    ds_read_b128 a[76:79], v11 offset:6144
    s_waitcnt lgkmcnt(2)
    v_mfma_f32_16x16x32_bf16 v[96:99], v[88:91], a[64:67], v[96:99]
    ds_read_b64_tr_b16 v[76:77], v14 offset:8192
    ds_read_b64_tr_b16 v[78:79], v14 offset:8704
    v_mfma_f32_16x16x32_bf16 v[100:103], v[88:91], a[68:71], v[100:103]
    ds_read_b128 a[80:83], v12 offset:0
    s_and_b32 s59, s59, 7
    v_mfma_f32_16x16x32_bf16 v[108:111], v[92:95], a[68:71], v[108:111]
    buffer_load_dwordx4 v4, s[8:11], s56 offen offset:2048 sc1 lds
    v_mfma_f32_16x16x32_bf16 v[104:107], v[92:95], a[64:67], v[104:107]
    v_subrev_u32 v11, 82048, v11
    s_waitcnt lgkmcnt(1)
    v_mfma_f32_16x16x32_bf16 v[112:115], v[88:91], a[72:75], v[112:115]
    ds_read_b64_tr_b16 v[80:81], v13 offset:4096
    ds_read_b64_tr_b16 v[82:83], v13 offset:4608
    v_mfma_f32_16x16x32_bf16 v[116:119], v[88:91], a[76:79], v[116:119]
    ds_read_b128 a[84:87], v12 offset:2048
    v_mfma_f32_16x16x32_bf16 v[124:127], v[92:95], a[76:79], v[124:127]
    buffer_load_dwordx4 v5, s[8:11], s56 offen offset:3072 sc1 lds
    v_mfma_f32_16x16x32_bf16 v[120:123], v[92:95], a[72:75], v[120:123]
    s_add_u32 m0, s60, 57408
    s_lshl_b32 s56, s59, 7
    v_mfma_f32_16x16x32_bf16 v[128:131], a[64:67], v[72:75], v[128:131]
    ds_read_b64_tr_b16 v[84:85], v14 offset:4096
    ds_read_b64_tr_b16 v[86:87], v14 offset:4608
    v_mfma_f32_16x16x32_bf16 v[136:139], a[68:71], v[72:75], v[136:139]
    ds_read_b128 a[88:91], v12 offset:4096
    v_mfma_f32_16x16x32_bf16 v[144:147], a[72:75], v[72:75], v[144:147]
    buffer_load_dwordx4 v6, s[12:15], s57 offen sc1 lds
    v_mfma_f32_16x16x32_bf16 v[152:155], a[76:79], v[72:75], v[152:155]
    v_mfma_f32_16x16x32_bf16 v[156:159], a[76:79], v[76:79], v[156:159]
    ds_read_b64_tr_b16 v[88:89], v13 offset:12288
    ds_read_b64_tr_b16 v[90:91], v13 offset:12800
    v_mfma_f32_16x16x32_bf16 v[148:151], a[72:75], v[76:79], v[148:151]
    ds_read_b128 a[92:95], v12 offset:6144
    v_mfma_f32_16x16x32_bf16 v[140:143], a[68:71], v[76:79], v[140:143]
    buffer_load_dwordx4 v7, s[12:15], s57 offen offset:1024 sc1 lds
    v_mfma_f32_16x16x32_bf16 v[132:135], a[64:67], v[76:79], v[132:135]
    s_add_u32 m0, s60, 65600
    s_mul_i32 s57, s59, 196608
    s_waitcnt lgkmcnt(1)
    v_mfma_f32_16x16x32_bf16 v[96:99], v[80:83], a[80:83], v[96:99]
    ds_read_b64_tr_b16 v[92:93], v14 offset:12288
    ds_read_b64_tr_b16 v[94:95], v14 offset:12800
    v_mfma_f32_16x16x32_bf16 v[100:103], v[80:83], a[84:87], v[100:103]
    v_subrev_u32 v13, 82048, v13
    v_subrev_u32 v14, 82048, v14
    v_mfma_f32_16x16x32_bf16 v[112:115], v[80:83], a[88:91], v[112:115]
    s_and_b32 s7, s3, 1
    s_lshl_b32 s6, s86, 1
    s_add_u32 s6, s6, s7
    s_lshl_b32 s6, s6, 7
    s_lshl_b32 s99, s48, 2
    s_and_b32 s98, s3, 2
    s_add_u32 s99, s99, s98
    s_sub_u32 s46, s99, 8
    s_add_u32 s6, s6, s99
    s_lshl_b32 s96, s6, 11
    s_add_u32 s96, s96, 2097152
    s_add_u32 s97, s96, 131072
    s_mul_i32 s99, s99, 144
    s_lshr_b32 s6, s87, 4
    s_add_u32 s99, s99, s6
    s_mul_i32 s7, s7, 3
    s_add_u32 s99, s99, s7
    s_lshl_b32 s98, s99, 10
    s_add_u32 s98, s98, 6291456
    s_add_u32 s99, s98, 147456
    s_lshl_b32 s6, s48, 2
    s_add_u32 s6, s6, s50
    s_lshl_b32 s6, s6, 1
    s_lshr_b32 s7, s3, 1
    s_add_u32 s6, s6, s7
    s_lshl_b32 s6, s6, 5
    s_lshl_b32 s7, s51, 1
    s_add_u32 s6, s6, s7
    s_and_b32 s7, s3, 1
    s_add_u32 s6, s6, s7
    s_lshl_b32 s6, s6, 2
    s_add_u32 s6, s6, 16908288
    s_lshl_b32 s7, s48, 5
    s_add_u32 s7, s7, s49
    s_lshl_b32 s7, s7, 2
    s_add_u32 s7, s7, 16842752
    s_cmp_eq_u32 s3, 0
    s_cselect_b32 s7, s7, 2146435072
    s_cselect_b32 s47, 16, 0
    s_and_b32 s49, s3, 1
    s_lshl_b32 s86, s86, 1
    s_add_u32 s49, s49, s86
    s_lshl_b32 s49, s49, 1
    s_add_u32 s49, s49, 1
    v_mov_b32 v18, 2146435072
    v_mov_b32 v19, 2146435072
    v_writelane_b32 v18, s7, 0
    v_writelane_b32 v19, s6, 0
    v_cmp_gt_u32 vcc, s47, v0
    v_mov_b32 v70, 2146435072
    v_mov_b32 v22, 0
    v_cndmask_b32 v21, v70, v1, vcc
    v_cndmask_b32 v22, 0, 1, vcc
    s_lshl_b32 s6, s54, 7
    v_lshlrev_b32 v24, 10, v60
    v_add3_u32 v24, v24, v61, s6
    v_add_u32 v25, 7168, v24
    v_add_u32 v26, 14336, v24
    v_add_u32 v27, 21504, v24
    s_and_b32 s6, s53, 3
    s_lshl_b32 s55, s6, 1
    v_lshl_add_u32 v65, v44, 2, v42
    v_lshrrev_b32 v64, 1, v42
    s_lshr_b32 s6, s3, 1
    v_xor_b32 v64, s6, v64
    v_lshl_add_u32 v64, v64, 6, v43
    v_lshl_add_u32 v64, v65, 7, v64
    v_lshl_add_u32 v64, v45, 5, v64
    v_add_u32 v64, s61, v64
    v_xor_b32 v65, 64, v64
    v_add_u32 v66, 0x10000, v64
    v_add_u32 v67, 0x10000, v65
    v_add_u32 v68, 0x20000, v64
    v_add_u32 v69, 0x20000, v65
    v_lshl_add_u32 v46, v44, 4, v41
    v_lshl_add_u32 v62, v45, 5, v46
    v_lshlrev_b32 v62, 4, v62
    v_lshl_add_u32 v47, v45, 4, v41
    v_lshlrev_b32 v47, 4, v47
    v_lshl_add_u32 v17, v44, 17, v47
    v_add_u32 v17, 1024, v17
    s_and_b32 s6, s3, 1
    s_mul_i32 s6, s6, 24960
    s_lshr_b32 s7, s3, 1
    s_mul_i32 s7, s7, 4160
    s_add_u32 s6, s6, s7
    s_add_u32 s6, s6, 113856
    v_add_u32 v28, s6, v1
    v_lshl_add_u32 v29, v46, 4, s6
    v_add_u32 v29, 1024, v29
    s_add_u32 s6, s6, 4096
    v_mov_b32 v59, s6
    v_cmp_eq_u32 s[44:45], 1, v45
    v_min_u32 v46, 11, v0
    v_mul_u32_u24 v63, 4160, v46
    v_add_u32 v63, 117952, v63
    v_subrev_u32 v47, 6, v46
    v_min_u32 v46, v46, v47
    s_lshl_b32 s7, s48, 1
    s_sub_u32 s7, 4, s7
    v_mov_b32 v60, 0x3f803f80
    v_cmp_le_i32 vcc, s7, v46
    v_and_b32 v30, 31, v0
    v_lshlrev_b32 v31, 2, v44
    v_cndmask_b32 v60, 0, v60, vcc
    v_mov_b32 v61, v60
    v_sub_u32 v30, v30, v31
    v_cmp_gt_i32 s[64:65], 0, v30
    v_cmp_gt_i32 s[66:67], 1, v30
    v_cmp_gt_i32 s[68:69], 2, v30
    v_cmp_gt_i32 s[70:71], 3, v30
    v_cmp_gt_i32 s[72:73], 8, v30
    v_cmp_gt_i32 s[74:75], 9, v30
    v_cmp_gt_i32 s[76:77], 10, v30
    v_cmp_gt_i32 s[78:79], 11, v30
    v_cmp_gt_i32 s[80:81], 16, v30
    v_cmp_gt_i32 s[82:83], 17, v30
    v_cmp_gt_i32 s[84:85], 18, v30
    v_cmp_gt_i32 s[86:87], 19, v30
    v_cmp_gt_i32 s[88:89], 24, v30
    v_cmp_gt_i32 s[90:91], 25, v30
    v_cmp_gt_i32 s[92:93], 26, v30
    v_cmp_gt_i32 s[94:95], 27, v30
    v_mov_b32 v46, 0xffff
    v_mov_b32 v47, 0xffff0000
    v_cndmask_b32 v32, 0, v46, s[64:65]
    v_cndmask_b32 v48, 0, v47, s[66:67]
    v_or_b32 v32, v32, v48
    v_cndmask_b32 v33, 0, v46, s[68:69]
    v_cndmask_b32 v48, 0, v47, s[70:71]
    v_or_b32 v33, v33, v48
    v_cndmask_b32 v34, 0, v46, s[72:73]
    v_cndmask_b32 v48, 0, v47, s[74:75]
    v_or_b32 v34, v34, v48
    v_cndmask_b32 v35, 0, v46, s[76:77]
    v_cndmask_b32 v48, 0, v47, s[78:79]
    v_or_b32 v35, v35, v48
    v_cndmask_b32 v36, 0, v46, s[80:81]
    v_cndmask_b32 v48, 0, v47, s[82:83]
    v_or_b32 v36, v36, v48
    v_cndmask_b32 v37, 0, v46, s[84:85]
    v_cndmask_b32 v48, 0, v47, s[86:87]
    v_or_b32 v37, v37, v48
    v_cndmask_b32 v38, 0, v46, s[88:89]
    v_cndmask_b32 v48, 0, v47, s[90:91]
    v_or_b32 v38, v38, v48
    v_cndmask_b32 v39, 0, v46, s[92:93]
    v_cndmask_b32 v48, 0, v47, s[94:95]
    v_or_b32 v39, v39, v48
    s_waitcnt lgkmcnt(2)
    v_mfma_f32_16x16x32_bf16 v[116:119], v[80:83], a[92:95], v[116:119]
    s_waitcnt vmcnt(6) lgkmcnt(0)
    s_barrier
    v_mfma_f32_16x16x32_bf16 v[124:127], v[84:87], a[92:95], v[124:127]
    ds_read_b64_tr_b16 v[72:73], v13 offset:0
    ds_read_b64_tr_b16 v[74:75], v13 offset:512
    v_mfma_f32_16x16x32_bf16 v[120:123], v[84:87], a[88:91], v[120:123]
    buffer_load_dwordx4 v6, s[12:15], s58 offen sc1 lds
    buffer_load_dwordx4 v7, s[12:15], s58 offen offset:1024 sc1 lds
    v_mfma_f32_16x16x32_bf16 v[108:111], v[84:87], a[84:87], v[108:111]
    v_mfma_f32_16x16x32_bf16 v[104:107], v[84:87], a[80:83], v[104:107]
    s_add_u32 m0, s61, 82048
    s_add_u32 s58, s57, 1024
    v_mfma_f32_16x16x32_bf16 v[128:131], a[80:83], v[88:91], v[128:131]
    ds_read_b64_tr_b16 v[76:77], v14 offset:0
    ds_read_b64_tr_b16 v[78:79], v14 offset:512
    v_mfma_f32_16x16x32_bf16 v[136:139], a[84:87], v[88:91], v[136:139]
    ds_read_b128 a[96:99], v11 offset:0
    v_subrev_u32 v12, 82048, v12
    v_mfma_f32_16x16x32_bf16 v[144:147], a[88:91], v[88:91], v[144:147]
    buffer_load_dwordx4 v2, s[8:11], s56 offen sc1 lds
    v_mfma_f32_16x16x32_bf16 v[152:155], a[92:95], v[88:91], v[152:155]
    ds_read_b128 a[100:103], v11 offset:2048
    v_mfma_f32_16x16x32_bf16 v[156:159], a[92:95], v[92:95], v[156:159]
    ds_read_b64_tr_b16 v[80:81], v13 offset:8192
    ds_read_b64_tr_b16 v[82:83], v13 offset:8704
    v_mfma_f32_16x16x32_bf16 v[148:151], a[88:91], v[92:95], v[148:151]
    ds_read_b128 a[104:107], v11 offset:4096
    s_add_u32 s59, s52, 6
    v_mfma_f32_16x16x32_bf16 v[140:143], a[84:87], v[92:95], v[140:143]
    buffer_load_dwordx4 v3, s[8:11], s56 offen offset:1024 sc1 lds
    v_mfma_f32_16x16x32_bf16 v[132:135], a[80:83], v[92:95], v[132:135]
    ds_read_b128 a[108:111], v11 offset:6144
    s_waitcnt lgkmcnt(2)
    v_mfma_f32_16x16x32_bf16 v[96:99], v[72:75], a[96:99], v[96:99]
    ds_read_b64_tr_b16 v[84:85], v14 offset:8192
    ds_read_b64_tr_b16 v[86:87], v14 offset:8704
    v_mfma_f32_16x16x32_bf16 v[100:103], v[72:75], a[100:103], v[100:103]
    ds_read_b128 a[112:115], v12 offset:0
    s_and_b32 s59, s59, 7
    v_mfma_f32_16x16x32_bf16 v[108:111], v[76:79], a[100:103], v[108:111]
    buffer_load_dwordx4 v4, s[8:11], s56 offen offset:2048 sc1 lds
    v_mfma_f32_16x16x32_bf16 v[104:107], v[76:79], a[96:99], v[104:107]
    v_add_u32 v11, 41024, v11
    s_waitcnt lgkmcnt(1)
    v_mfma_f32_16x16x32_bf16 v[112:115], v[72:75], a[104:107], v[112:115]
    ds_read_b64_tr_b16 v[88:89], v13 offset:4096
    ds_read_b64_tr_b16 v[90:91], v13 offset:4608
    v_mfma_f32_16x16x32_bf16 v[116:119], v[72:75], a[108:111], v[116:119]
    ds_read_b128 a[116:119], v12 offset:2048
    v_mfma_f32_16x16x32_bf16 v[124:127], v[76:79], a[108:111], v[124:127]
    buffer_load_dwordx4 v5, s[8:11], s56 offen offset:3072 sc1 lds
    v_mfma_f32_16x16x32_bf16 v[120:123], v[76:79], a[104:107], v[120:123]
    s_add_u32 m0, s60, 98432
    s_lshl_b32 s56, s59, 7
    v_mfma_f32_16x16x32_bf16 v[128:131], a[96:99], v[80:83], v[128:131]
    ds_read_b64_tr_b16 v[92:93], v14 offset:4096
    ds_read_b64_tr_b16 v[94:95], v14 offset:4608
    v_mfma_f32_16x16x32_bf16 v[136:139], a[100:103], v[80:83], v[136:139]
    ds_read_b128 a[120:123], v12 offset:4096
    v_mfma_f32_16x16x32_bf16 v[144:147], a[104:107], v[80:83], v[144:147]
    buffer_load_dwordx4 v6, s[12:15], s57 offen sc1 lds
    v_mfma_f32_16x16x32_bf16 v[152:155], a[108:111], v[80:83], v[152:155]
    v_mfma_f32_16x16x32_bf16 v[156:159], a[108:111], v[84:87], v[156:159]
    ds_read_b64_tr_b16 v[72:73], v13 offset:12288
    ds_read_b64_tr_b16 v[74:75], v13 offset:12800
    v_mfma_f32_16x16x32_bf16 v[148:151], a[104:107], v[84:87], v[148:151]
    ds_read_b128 a[124:127], v12 offset:6144
    v_mfma_f32_16x16x32_bf16 v[140:143], a[100:103], v[84:87], v[140:143]
    buffer_load_dwordx4 v7, s[12:15], s57 offen offset:1024 sc1 lds
    v_mfma_f32_16x16x32_bf16 v[132:135], a[96:99], v[84:87], v[132:135]
    s_add_u32 m0, s60, 106624
    s_mul_i32 s57, s59, 196608
    s_waitcnt lgkmcnt(1)
    v_mfma_f32_16x16x32_bf16 v[96:99], v[88:91], a[112:115], v[96:99]
    ds_read_b64_tr_b16 v[76:77], v14 offset:12288
    ds_read_b64_tr_b16 v[78:79], v14 offset:12800
    v_mfma_f32_16x16x32_bf16 v[100:103], v[88:91], a[116:119], v[100:103]
    v_add_u32 v13, 41024, v13
    v_add_u32 v14, 41024, v14
    v_mfma_f32_16x16x32_bf16 v[112:115], v[88:91], a[120:123], v[112:115]
    buffer_load_dwordx4 v6, s[12:15], s58 offen sc1 lds
    s_waitcnt lgkmcnt(2)
    v_mfma_f32_16x16x32_bf16 v[116:119], v[88:91], a[124:127], v[116:119]
    s_waitcnt vmcnt(7) lgkmcnt(0)
    s_barrier
    v_mfma_f32_16x16x32_bf16 v[124:127], v[92:95], a[124:127], v[124:127]
    ds_read_b64_tr_b16 v[80:81], v13 offset:0
    ds_read_b64_tr_b16 v[82:83], v13 offset:512
    v_mfma_f32_16x16x32_bf16 v[120:123], v[92:95], a[120:123], v[120:123]
    buffer_load_dwordx4 v7, s[12:15], s58 offen offset:1024 sc1 lds
    v_mfma_f32_16x16x32_bf16 v[108:111], v[92:95], a[116:119], v[108:111]
    v_mfma_f32_16x16x32_bf16 v[104:107], v[92:95], a[112:115], v[104:107]
    s_add_u32 m0, s61, 0
    s_add_u32 s58, s57, 1024
    v_mfma_f32_16x16x32_bf16 v[128:131], a[112:115], v[72:75], v[128:131]
    ds_read_b64_tr_b16 v[84:85], v14 offset:0
    ds_read_b64_tr_b16 v[86:87], v14 offset:512
    v_mfma_f32_16x16x32_bf16 v[136:139], a[116:119], v[72:75], v[136:139]
    ds_read_b128 a[128:131], v11 offset:0
    v_add_u32 v12, 41024, v12
    v_mfma_f32_16x16x32_bf16 v[144:147], a[120:123], v[72:75], v[144:147]
    buffer_load_dwordx4 v2, s[8:11], s56 offen sc1 lds
    v_mfma_f32_16x16x32_bf16 v[152:155], a[124:127], v[72:75], v[152:155]
    ds_read_b128 a[132:135], v11 offset:2048
    v_mfma_f32_16x16x32_bf16 v[156:159], a[124:127], v[76:79], v[156:159]
    ds_read_b64_tr_b16 v[88:89], v13 offset:8192
    ds_read_b64_tr_b16 v[90:91], v13 offset:8704
    v_mfma_f32_16x16x32_bf16 v[148:151], a[120:123], v[76:79], v[148:151]
    ds_read_b128 a[136:139], v11 offset:4096
    s_add_u32 s59, s52, 7
    v_mfma_f32_16x16x32_bf16 v[140:143], a[116:119], v[76:79], v[140:143]
    buffer_load_dwordx4 v3, s[8:11], s56 offen offset:1024 sc1 lds
    v_mfma_f32_16x16x32_bf16 v[132:135], a[112:115], v[76:79], v[132:135]
    ds_read_b128 a[140:143], v11 offset:6144
    s_waitcnt lgkmcnt(2)
    v_mfma_f32_16x16x32_bf16 v[96:99], v[80:83], a[128:131], v[96:99]
    ds_read_b64_tr_b16 v[92:93], v14 offset:8192
    ds_read_b64_tr_b16 v[94:95], v14 offset:8704
    v_mfma_f32_16x16x32_bf16 v[100:103], v[80:83], a[132:135], v[100:103]
    ds_read_b128 a[144:147], v12 offset:0
    s_and_b32 s59, s59, 7
    v_mfma_f32_16x16x32_bf16 v[108:111], v[84:87], a[132:135], v[108:111]
    buffer_load_dwordx4 v4, s[8:11], s56 offen offset:2048 sc1 lds
    v_mfma_f32_16x16x32_bf16 v[104:107], v[84:87], a[128:131], v[104:107]
    v_add_u32 v11, 41024, v11
    s_waitcnt lgkmcnt(1)
    v_mfma_f32_16x16x32_bf16 v[112:115], v[80:83], a[136:139], v[112:115]
    ds_read_b64_tr_b16 v[72:73], v13 offset:4096
    ds_read_b64_tr_b16 v[74:75], v13 offset:4608
    v_mfma_f32_16x16x32_bf16 v[116:119], v[80:83], a[140:143], v[116:119]
    ds_read_b128 a[148:151], v12 offset:2048
    v_mfma_f32_16x16x32_bf16 v[124:127], v[84:87], a[140:143], v[124:127]
    buffer_load_dwordx4 v5, s[8:11], s56 offen offset:3072 sc1 lds
    v_mfma_f32_16x16x32_bf16 v[120:123], v[84:87], a[136:139], v[120:123]
    s_add_u32 m0, s60, 16384
    s_lshl_b32 s56, s59, 7
    v_mfma_f32_16x16x32_bf16 v[128:131], a[128:131], v[88:91], v[128:131]
    ds_read_b64_tr_b16 v[76:77], v14 offset:4096
    ds_read_b64_tr_b16 v[78:79], v14 offset:4608
    v_mfma_f32_16x16x32_bf16 v[136:139], a[132:135], v[88:91], v[136:139]
    ds_read_b128 a[152:155], v12 offset:4096
    v_mfma_f32_16x16x32_bf16 v[144:147], a[136:139], v[88:91], v[144:147]
    buffer_load_dwordx4 v6, s[12:15], s57 offen sc1 lds
    v_mfma_f32_16x16x32_bf16 v[152:155], a[140:143], v[88:91], v[152:155]
    v_mfma_f32_16x16x32_bf16 v[156:159], a[140:143], v[92:95], v[156:159]
    ds_read_b64_tr_b16 v[80:81], v13 offset:12288
    ds_read_b64_tr_b16 v[82:83], v13 offset:12800
    v_mfma_f32_16x16x32_bf16 v[148:151], a[136:139], v[92:95], v[148:151]
    ds_read_b128 a[156:159], v12 offset:6144
    v_mfma_f32_16x16x32_bf16 v[140:143], a[132:135], v[92:95], v[140:143]
    buffer_load_dwordx4 v7, s[12:15], s57 offen offset:1024 sc1 lds
    v_mfma_f32_16x16x32_bf16 v[132:135], a[128:131], v[92:95], v[132:135]
    s_add_u32 m0, s60, 24576
    s_mul_i32 s57, s59, 196608
    s_waitcnt lgkmcnt(1)
    v_mfma_f32_16x16x32_bf16 v[96:99], v[72:75], a[144:147], v[96:99]
    ds_read_b64_tr_b16 v[84:85], v14 offset:12288
    ds_read_b64_tr_b16 v[86:87], v14 offset:12800
    v_mfma_f32_16x16x32_bf16 v[100:103], v[72:75], a[148:151], v[100:103]
    v_add_u32 v13, 41024, v13
    v_add_u32 v14, 41024, v14
    v_mfma_f32_16x16x32_bf16 v[112:115], v[72:75], a[152:155], v[112:115]
    buffer_load_dwordx4 v6, s[12:15], s58 offen sc1 lds
    s_waitcnt lgkmcnt(2)
    v_mfma_f32_16x16x32_bf16 v[116:119], v[72:75], a[156:159], v[116:119]
    s_waitcnt vmcnt(7) lgkmcnt(0)
    s_barrier
    v_mfma_f32_16x16x32_bf16 v[124:127], v[76:79], a[156:159], v[124:127]
    ds_read_b64_tr_b16 v[88:89], v13 offset:0
    ds_read_b64_tr_b16 v[90:91], v13 offset:512
    v_mfma_f32_16x16x32_bf16 v[120:123], v[76:79], a[152:155], v[120:123]
    buffer_load_dwordx4 v7, s[12:15], s58 offen offset:1024 sc1 lds
    v_mfma_f32_16x16x32_bf16 v[108:111], v[76:79], a[148:151], v[108:111]
    v_mfma_f32_16x16x32_bf16 v[104:107], v[76:79], a[144:147], v[104:107]
    s_add_u32 m0, s61, 41024
    s_add_u32 s58, s57, 1024
    v_mfma_f32_16x16x32_bf16 v[128:131], a[144:147], v[80:83], v[128:131]
    ds_read_b64_tr_b16 v[92:93], v14 offset:0
    ds_read_b64_tr_b16 v[94:95], v14 offset:512
    v_mfma_f32_16x16x32_bf16 v[136:139], a[148:151], v[80:83], v[136:139]
    ds_read_b128 a[160:163], v11 offset:0
    v_add_u32 v12, 41024, v12
    v_mfma_f32_16x16x32_bf16 v[144:147], a[152:155], v[80:83], v[144:147]
    buffer_load_dwordx4 v2, s[8:11], s56 offen sc1 lds
    v_mfma_f32_16x16x32_bf16 v[152:155], a[156:159], v[80:83], v[152:155]
    ds_read_b128 a[164:167], v11 offset:2048
    v_mfma_f32_16x16x32_bf16 v[156:159], a[156:159], v[84:87], v[156:159]
    ds_read_b64_tr_b16 v[72:73], v13 offset:8192
    ds_read_b64_tr_b16 v[74:75], v13 offset:8704
    v_mfma_f32_16x16x32_bf16 v[148:151], a[152:155], v[84:87], v[148:151]
    ds_read_b128 a[168:171], v11 offset:4096
    s_add_u32 s59, s52, 0
    v_mfma_f32_16x16x32_bf16 v[140:143], a[148:151], v[84:87], v[140:143]
    buffer_load_dwordx4 v3, s[8:11], s56 offen offset:1024 sc1 lds
    v_mfma_f32_16x16x32_bf16 v[132:135], a[144:147], v[84:87], v[132:135]
    ds_read_b128 a[172:175], v11 offset:6144
    s_waitcnt lgkmcnt(2)
    v_mfma_f32_16x16x32_bf16 v[96:99], v[88:91], a[160:163], v[96:99]
    ds_read_b64_tr_b16 v[76:77], v14 offset:8192
    ds_read_b64_tr_b16 v[78:79], v14 offset:8704
    v_mfma_f32_16x16x32_bf16 v[100:103], v[88:91], a[164:167], v[100:103]
    ds_read_b128 a[176:179], v12 offset:0
    s_and_b32 s59, s59, 7
    v_mfma_f32_16x16x32_bf16 v[108:111], v[92:95], a[164:167], v[108:111]
    buffer_load_dwordx4 v4, s[8:11], s56 offen offset:2048 sc1 lds
    v_mfma_f32_16x16x32_bf16 v[104:107], v[92:95], a[160:163], v[104:107]
    v_subrev_u32 v11, 82048, v11
    s_waitcnt lgkmcnt(1)
    v_mfma_f32_16x16x32_bf16 v[112:115], v[88:91], a[168:171], v[112:115]
    ds_read_b64_tr_b16 v[80:81], v13 offset:4096
    ds_read_b64_tr_b16 v[82:83], v13 offset:4608
    v_mfma_f32_16x16x32_bf16 v[116:119], v[88:91], a[172:175], v[116:119]
    ds_read_b128 a[180:183], v12 offset:2048
    v_mfma_f32_16x16x32_bf16 v[124:127], v[92:95], a[172:175], v[124:127]
    buffer_load_dwordx4 v5, s[8:11], s56 offen offset:3072 sc1 lds
    v_mfma_f32_16x16x32_bf16 v[120:123], v[92:95], a[168:171], v[120:123]
    s_add_u32 m0, s60, 57408
    v_mfma_f32_16x16x32_bf16 v[128:131], a[160:163], v[72:75], v[128:131]
    ds_read_b64_tr_b16 v[84:85], v14 offset:4096
    ds_read_b64_tr_b16 v[86:87], v14 offset:4608
    v_mfma_f32_16x16x32_bf16 v[136:139], a[164:167], v[72:75], v[136:139]
    ds_read_b128 a[184:187], v12 offset:4096
    v_mfma_f32_16x16x32_bf16 v[144:147], a[168:171], v[72:75], v[144:147]
    buffer_load_dwordx4 v6, s[12:15], s57 offen sc1 lds
    v_mfma_f32_16x16x32_bf16 v[152:155], a[172:175], v[72:75], v[152:155]
    v_mfma_f32_16x16x32_bf16 v[156:159], a[172:175], v[76:79], v[156:159]
    ds_read_b64_tr_b16 v[88:89], v13 offset:12288
    ds_read_b64_tr_b16 v[90:91], v13 offset:12800
    v_mfma_f32_16x16x32_bf16 v[148:151], a[168:171], v[76:79], v[148:151]
    ds_read_b128 a[188:191], v12 offset:6144
    v_mfma_f32_16x16x32_bf16 v[140:143], a[164:167], v[76:79], v[140:143]
    buffer_load_dwordx4 v7, s[12:15], s57 offen offset:1024 sc1 lds
    v_mfma_f32_16x16x32_bf16 v[132:135], a[160:163], v[76:79], v[132:135]
    s_add_u32 m0, s60, 65600
    s_waitcnt lgkmcnt(1)
    v_mfma_f32_16x16x32_bf16 v[96:99], v[80:83], a[176:179], v[96:99]
    ds_read_b64_tr_b16 v[92:93], v14 offset:12288
    ds_read_b64_tr_b16 v[94:95], v14 offset:12800
    v_mfma_f32_16x16x32_bf16 v[100:103], v[80:83], a[180:183], v[100:103]
    v_subrev_u32 v13, 82048, v13
    v_subrev_u32 v14, 82048, v14
    v_mfma_f32_16x16x32_bf16 v[112:115], v[80:83], a[184:187], v[112:115]
    buffer_load_dwordx4 v6, s[12:15], s58 offen sc1 lds
    s_waitcnt lgkmcnt(2)
    v_mfma_f32_16x16x32_bf16 v[116:119], v[80:83], a[188:191], v[116:119]
    s_waitcnt vmcnt(7) lgkmcnt(0)
    s_barrier
    v_mfma_f32_16x16x32_bf16 v[124:127], v[84:87], a[188:191], v[124:127]
    ds_read_b64_tr_b16 v[72:73], v13 offset:0
    ds_read_b64_tr_b16 v[74:75], v13 offset:512
    v_mfma_f32_16x16x32_bf16 v[120:123], v[84:87], a[184:187], v[120:123]
    buffer_load_dwordx4 v7, s[12:15], s58 offen offset:1024 sc1 lds
    v_mfma_f32_16x16x32_bf16 v[108:111], v[84:87], a[180:183], v[108:111]
    s_add_u32 m0, s62, 138464
    s_mul_i32 s58, s59, 229376
    s_lshr_b32 s8, s51, 1
    v_mfma_f32_16x16x32_bf16 v[104:107], v[84:87], a[176:179], v[104:107]
    v_subrev_u32 v12, 82048, v12
    v_mfma_f32_16x16x32_bf16 v[128:131], a[176:179], v[88:91], v[128:131]
    ds_read_b64_tr_b16 v[76:77], v14 offset:0
    ds_read_b64_tr_b16 v[78:79], v14 offset:512
    v_mfma_f32_16x16x32_bf16 v[136:139], a[180:183], v[88:91], v[136:139]
    ds_read_b128 a[192:195], v11 offset:0
    s_lshl_b32 s9, s50, 2
    v_mfma_f32_16x16x32_bf16 v[144:147], a[184:187], v[88:91], v[144:147]
    buffer_load_dwordx4 v8, s[16:19], s58 offen sc1 lds
    v_mfma_f32_16x16x32_bf16 v[152:155], a[188:191], v[88:91], v[152:155]
    ds_read_b128 a[196:199], v11 offset:2048
    v_mfma_f32_16x16x32_bf16 v[156:159], a[188:191], v[92:95], v[156:159]
    ds_read_b64_tr_b16 v[80:81], v13 offset:8192
    ds_read_b64_tr_b16 v[82:83], v13 offset:8704
    v_mfma_f32_16x16x32_bf16 v[148:151], a[184:187], v[92:95], v[148:151]
    ds_read_b128 a[200:203], v11 offset:4096
    s_add_u32 s59, s52, 1
    v_mfma_f32_16x16x32_bf16 v[140:143], a[180:183], v[92:95], v[140:143]
    v_mfma_f32_16x16x32_bf16 v[132:135], a[176:179], v[92:95], v[132:135]
    ds_read_b128 a[204:207], v11 offset:6144
    s_waitcnt lgkmcnt(2)
    v_mfma_f32_16x16x32_bf16 v[96:99], v[72:75], a[192:195], v[96:99]
    ds_read_b64_tr_b16 v[84:85], v14 offset:8192
    ds_read_b64_tr_b16 v[86:87], v14 offset:8704
    v_mfma_f32_16x16x32_bf16 v[100:103], v[72:75], a[196:199], v[100:103]
    ds_read_b128 a[208:211], v12 offset:0
    s_and_b32 s59, s59, 7
    v_mfma_f32_16x16x32_bf16 v[108:111], v[76:79], a[196:199], v[108:111]
    buffer_load_dwordx4 v9, s[16:19], s58 offen offset:1024 sc1 lds
    v_mfma_f32_16x16x32_bf16 v[104:107], v[76:79], a[192:195], v[104:107]
    v_add_u32 v11, 41024, v11
    s_waitcnt lgkmcnt(1)
    v_mfma_f32_16x16x32_bf16 v[112:115], v[72:75], a[200:203], v[112:115]
    ds_read_b64_tr_b16 v[88:89], v13 offset:4096
    ds_read_b64_tr_b16 v[90:91], v13 offset:4608
    v_mfma_f32_16x16x32_bf16 v[116:119], v[72:75], a[204:207], v[116:119]
    ds_read_b128 a[212:215], v12 offset:2048
    s_add_u32 s8, s8, s9
    v_mfma_f32_16x16x32_bf16 v[124:127], v[76:79], a[204:207], v[124:127]
    buffer_load_dwordx4 v10, s[16:19], s58 offen offset:2048 sc1 lds
    v_mfma_f32_16x16x32_bf16 v[120:123], v[76:79], a[200:203], v[120:123]
    s_add_u32 m0, s62, 150784
    s_lshl_b32 s8, s8, 2
    v_mfma_f32_16x16x32_bf16 v[128:131], a[192:195], v[80:83], v[128:131]
    ds_read_b64_tr_b16 v[92:93], v14 offset:4096
    ds_read_b64_tr_b16 v[94:95], v14 offset:4608
    v_mfma_f32_16x16x32_bf16 v[136:139], a[196:199], v[80:83], v[136:139]
    ds_read_b128 a[216:219], v12 offset:4096
    s_lshl_b32 s9, s48, 7
    v_mfma_f32_16x16x32_bf16 v[144:147], a[200:203], v[80:83], v[144:147]
    v_mfma_f32_16x16x32_bf16 v[152:155], a[204:207], v[80:83], v[152:155]
    s_add_u32 s8, s8, s9
    s_add_u32 s8, s8, 16842756
    v_mfma_f32_16x16x32_bf16 v[156:159], a[204:207], v[84:87], v[156:159]
    ds_read_b64_tr_b16 v[72:73], v13 offset:12288
    ds_read_b64_tr_b16 v[74:75], v13 offset:12800
    v_mfma_f32_16x16x32_bf16 v[148:151], a[200:203], v[84:87], v[148:151]
    ds_read_b128 a[220:223], v12 offset:6144
    v_lshlrev_b32 v4, 7, v0
    v_mfma_f32_16x16x32_bf16 v[140:143], a[196:199], v[84:87], v[140:143]
    buffer_load_dwordx4 v8, s[20:23], s58 offen sc1 lds
    v_mfma_f32_16x16x32_bf16 v[132:135], a[192:195], v[84:87], v[132:135]
    v_add_u32 v12, 41024, v12
    s_waitcnt lgkmcnt(1)
    v_mfma_f32_16x16x32_bf16 v[96:99], v[88:91], a[208:211], v[96:99]
    ds_read_b64_tr_b16 v[76:77], v14 offset:12288
    ds_read_b64_tr_b16 v[78:79], v14 offset:12800
    v_mfma_f32_16x16x32_bf16 v[100:103], v[88:91], a[212:215], v[100:103]
    v_add_u32 v13, 41024, v13
    v_add_u32 v14, 41024, v14
    v_mfma_f32_16x16x32_bf16 v[112:115], v[88:91], a[216:219], v[112:115]
    buffer_load_dwordx4 v9, s[20:23], s58 offen offset:1024 sc1 lds
    s_waitcnt lgkmcnt(2)
    v_mfma_f32_16x16x32_bf16 v[116:119], v[88:91], a[220:223], v[116:119]
    s_waitcnt vmcnt(5) lgkmcnt(0)
    s_barrier
    v_mfma_f32_16x16x32_bf16 v[124:127], v[92:95], a[220:223], v[124:127]
    ds_read_b64_tr_b16 v[80:81], v13 offset:0
    ds_read_b64_tr_b16 v[82:83], v13 offset:512
    v_mfma_f32_16x16x32_bf16 v[120:123], v[92:95], a[216:219], v[120:123]
    buffer_load_dwordx4 v10, s[20:23], s58 offen offset:2048 sc1 lds
    v_mfma_f32_16x16x32_bf16 v[108:111], v[92:95], a[212:215], v[108:111]
    s_add_u32 m0, s62, 113856
    s_mul_i32 s58, s59, 229376
    v_mfma_f32_16x16x32_bf16 v[104:107], v[92:95], a[208:211], v[104:107]
    v_sub_u32 v4, s8, v4
    v_mfma_f32_16x16x32_bf16 v[128:131], a[208:211], v[72:75], v[128:131]
    ds_read_b64_tr_b16 v[84:85], v14 offset:0
    ds_read_b64_tr_b16 v[86:87], v14 offset:512
    v_mfma_f32_16x16x32_bf16 v[136:139], a[212:215], v[72:75], v[136:139]
    ds_read_b128 a[224:227], v11 offset:0
    s_min_u32 s8, s48, 2
    v_mfma_f32_16x16x32_bf16 v[144:147], a[216:219], v[72:75], v[144:147]
    v_mfma_f32_16x16x32_bf16 v[152:155], a[220:223], v[72:75], v[152:155]
    ds_read_b128 a[228:231], v11 offset:2048
    v_mfma_f32_16x16x32_bf16 v[156:159], a[220:223], v[76:79], v[156:159]
    ds_read_b64_tr_b16 v[88:89], v13 offset:8192
    ds_read_b64_tr_b16 v[90:91], v13 offset:8704
    v_mfma_f32_16x16x32_bf16 v[148:151], a[216:219], v[76:79], v[148:151]
    ds_read_b128 a[232:235], v11 offset:4096
    v_mfma_f32_16x16x32_bf16 v[140:143], a[212:215], v[76:79], v[140:143]
    buffer_load_dwordx4 v8, s[16:19], s58 offen sc1 lds
    v_mfma_f32_16x16x32_bf16 v[132:135], a[208:211], v[76:79], v[132:135]
    ds_read_b128 a[236:239], v11 offset:6144
    s_waitcnt lgkmcnt(2)
    v_mfma_f32_16x16x32_bf16 v[96:99], v[80:83], a[224:227], v[96:99]
    ds_read_b64_tr_b16 v[92:93], v14 offset:8192
    ds_read_b64_tr_b16 v[94:95], v14 offset:8704
    v_mfma_f32_16x16x32_bf16 v[100:103], v[80:83], a[228:231], v[100:103]
    ds_read_b128 a[240:243], v12 offset:0
    s_add_u32 s59, s52, 2
    v_mfma_f32_16x16x32_bf16 v[108:111], v[84:87], a[228:231], v[108:111]
    buffer_load_dwordx4 v9, s[16:19], s58 offen offset:1024 sc1 lds
    v_mfma_f32_16x16x32_bf16 v[104:107], v[84:87], a[224:227], v[104:107]
    s_and_b32 s59, s59, 7
    s_waitcnt lgkmcnt(1)
    v_mfma_f32_16x16x32_bf16 v[112:115], v[80:83], a[232:235], v[112:115]
    ds_read_b64_tr_b16 v[72:73], v13 offset:4096
    ds_read_b64_tr_b16 v[74:75], v13 offset:4608
    v_mfma_f32_16x16x32_bf16 v[116:119], v[80:83], a[236:239], v[116:119]
    ds_read_b128 a[244:247], v12 offset:2048
    v_mfma_f32_16x16x32_bf16 v[124:127], v[84:87], a[236:239], v[124:127]
    v_mfma_f32_16x16x32_bf16 v[120:123], v[84:87], a[232:235], v[120:123]
    s_cmp_eq_u32 s3, 0
    s_cselect_b32 s8, s8, -1
    v_mfma_f32_16x16x32_bf16 v[128:131], a[224:227], v[88:91], v[128:131]
    ds_read_b64_tr_b16 v[76:77], v14 offset:4096
    ds_read_b64_tr_b16 v[78:79], v14 offset:4608
    v_mfma_f32_16x16x32_bf16 v[136:139], a[228:231], v[88:91], v[136:139]
    ds_read_b128 a[248:251], v12 offset:4096
    v_mfma_f32_16x16x32_bf16 v[144:147], a[232:235], v[88:91], v[144:147]
    buffer_load_dwordx4 v10, s[16:19], s58 offen offset:2048 sc1 lds
    v_mfma_f32_16x16x32_bf16 v[152:155], a[236:239], v[88:91], v[152:155]
    s_add_u32 m0, s62, 126176
    v_mfma_f32_16x16x32_bf16 v[156:159], a[236:239], v[92:95], v[156:159]
    ds_read_b64_tr_b16 v[80:81], v13 offset:12288
    ds_read_b64_tr_b16 v[82:83], v13 offset:12800
    v_mfma_f32_16x16x32_bf16 v[148:151], a[232:235], v[92:95], v[148:151]
    ds_read_b128 a[252:255], v12 offset:6144
    v_mfma_f32_16x16x32_bf16 v[140:143], a[228:231], v[92:95], v[140:143]
    buffer_load_dwordx4 v8, s[20:23], s58 offen sc1 lds
    v_mfma_f32_16x16x32_bf16 v[132:135], a[224:227], v[92:95], v[132:135]
    s_waitcnt lgkmcnt(1)
    v_mfma_f32_16x16x32_bf16 v[96:99], v[72:75], a[240:243], v[96:99]
    ds_read_b64_tr_b16 v[84:85], v14 offset:12288
    ds_read_b64_tr_b16 v[86:87], v14 offset:12800
    v_mfma_f32_16x16x32_bf16 v[100:103], v[72:75], a[244:247], v[100:103]
    v_mov_b32 v13, v56
    v_mov_b32 v14, v57
    v_mfma_f32_16x16x32_bf16 v[112:115], v[72:75], a[248:251], v[112:115]
    s_waitcnt lgkmcnt(2)
    v_mfma_f32_16x16x32_bf16 v[116:119], v[72:75], a[252:255], v[116:119]
    v_mov_b32 v15, v58
    v_mfma_f32_16x16x32_bf16 v[124:127], v[76:79], a[252:255], v[124:127]
    v_cmp_ge_i32 vcc, s8, v0
    s_nop 1
    v_cndmask_b32 v4, v70, v4, vcc
    v_cndmask_b32 v5, 0, 1, vcc
    v_mfma_f32_16x16x32_bf16 v[120:123], v[76:79], a[248:251], v[120:123]
    buffer_load_dwordx4 v9, s[20:23], s58 offen offset:1024 sc1 lds
    v_mfma_f32_16x16x32_bf16 v[108:111], v[76:79], a[244:247], v[108:111]
    v_mfma_f32_16x16x32_bf16 v[104:107], v[76:79], a[240:243], v[104:107]
    s_add_u32 s14, s98, 4096
    s_add_u32 s15, s99, 4096
    v_mfma_f32_16x16x32_bf16 v[128:131], a[240:243], v[80:83], v[128:131]
    s_and_b32 s12, s3, 1
    s_lshl_b32 s13, s53, 1
    s_add_u32 s12, s12, s13
    v_mfma_f32_16x16x32_bf16 v[136:139], a[244:247], v[80:83], v[136:139]
    s_xor_b32 s13, s12, 1
    s_mul_i32 s12, s12, 147456
    s_mul_i32 s13, s13, 147456
    v_mfma_f32_16x16x32_bf16 v[144:147], a[248:251], v[80:83], v[144:147]
    buffer_load_dwordx4 v10, s[20:23], s58 offen offset:2048 sc1 lds
    v_mfma_f32_16x16x32_bf16 v[152:155], a[252:255], v[80:83], v[152:155]
    s_add_u32 m0, s62, 89248
    s_mul_i32 s58, s59, 229376
    s_waitcnt lgkmcnt(0)
    v_mfma_f32_16x16x32_bf16 v[156:159], a[252:255], v[84:87], v[156:159]
    s_add_u32 s12, s12, 6291456
    s_add_u32 s13, s13, 6291456
    v_mfma_f32_16x16x32_bf16 v[148:151], a[248:251], v[84:87], v[148:151]
    v_add_u32 v2, s12, v1
    v_add_u32 v3, s13, v1
    v_mfma_f32_16x16x32_bf16 v[140:143], a[244:247], v[84:87], v[140:143]
    v_mfma_f32_16x16x32_bf16 v[132:135], a[240:243], v[84:87], v[132:135]
    v_add_u32 v16, 512, v29
    v_add_u32 v6, 2048, v29
    v_add_u32 v7, 2560, v29
    v_cndmask_b32 v29, v29, v59, s[44:45]
    v_cndmask_b32 v16, v16, v59, s[44:45]
    v_cndmask_b32 v6, v6, v59, s[44:45]
    v_cndmask_b32 v7, v7, v59, s[44:45]
    v_cvt_pk_bf16_f32 v96, v96, v97
    buffer_load_dwordx4 v8, s[16:19], s58 offen sc1 lds
    s_add_u32 s59, s52, 3
    s_and_b32 s59, s59, 7
    v_cvt_pk_bf16_f32 v97, v98, v99
    v_cvt_pk_bf16_f32 v98, v100, v101
    v_cvt_pk_bf16_f32 v99, v102, v103
    v_cvt_pk_bf16_f32 v100, v104, v105
    v_cvt_pk_bf16_f32 v101, v106, v107
    v_cvt_pk_bf16_f32 v102, v108, v109
    v_cvt_pk_bf16_f32 v103, v110, v111
    v_permlane16_swap_b32 v96, v98
    v_permlane16_swap_b32 v97, v99
    v_permlane16_swap_b32 v100, v102
    v_permlane16_swap_b32 v101, v103
    buffer_store_dwordx4 v[96:99], v1, s[32:35], s96 offen offset:0 sc1
    buffer_store_dwordx4 v[100:103], v1, s[32:35], s97 offen offset:0 sc1
    v_cvt_pk_bf16_f32 v112, v112, v113
    v_cvt_pk_bf16_f32 v113, v114, v115
    v_cvt_pk_bf16_f32 v114, v116, v117
    v_cvt_pk_bf16_f32 v115, v118, v119
    v_cvt_pk_bf16_f32 v116, v120, v121
    v_cvt_pk_bf16_f32 v117, v122, v123
    v_cvt_pk_bf16_f32 v118, v124, v125
    v_cvt_pk_bf16_f32 v119, v126, v127
    v_permlane16_swap_b32 v112, v114
    v_permlane16_swap_b32 v113, v115
    v_permlane16_swap_b32 v116, v118
    v_permlane16_swap_b32 v117, v119
    v_cvt_pk_bf16_f32 v128, v128, v129
    v_cvt_pk_bf16_f32 v129, v130, v131
    v_cvt_pk_bf16_f32 v130, v132, v133
    v_cvt_pk_bf16_f32 v131, v134, v135
    v_cvt_pk_bf16_f32 v132, v136, v137
    v_cvt_pk_bf16_f32 v133, v138, v139
    v_cvt_pk_bf16_f32 v134, v140, v141
    v_cvt_pk_bf16_f32 v135, v142, v143
    v_permlane32_swap_b32 v128, v130
    v_permlane32_swap_b32 v129, v131
    v_permlane32_swap_b32 v132, v134
    v_permlane32_swap_b32 v133, v135
    v_cvt_pk_bf16_f32 v144, v144, v145
    v_cvt_pk_bf16_f32 v145, v146, v147
    v_cvt_pk_bf16_f32 v146, v148, v149
    v_cvt_pk_bf16_f32 v147, v150, v151
    v_cvt_pk_bf16_f32 v148, v152, v153
    v_cvt_pk_bf16_f32 v149, v154, v155
    v_cvt_pk_bf16_f32 v150, v156, v157
    v_cvt_pk_bf16_f32 v151, v158, v159
    v_permlane32_swap_b32 v144, v146
    v_permlane32_swap_b32 v145, v147
    v_permlane32_swap_b32 v148, v150
    v_permlane32_swap_b32 v149, v151
    s_waitcnt vmcnt(9)
    s_barrier
    ds_read_b64_tr_b16 v[88:89], v13 offset:0
    ds_read_b64_tr_b16 v[90:91], v13 offset:768
    ds_read_b64_tr_b16 v[92:93], v13 offset:12320
    ds_read_b64_tr_b16 v[94:95], v13 offset:13088
    ds_read_b64_tr_b16 v[72:73], v14 offset:0
    ds_read_b64_tr_b16 v[74:75], v14 offset:768
    s_waitcnt lgkmcnt(4)
    v_mfma_f32_16x16x32_bf16 v[160:163], v[88:91], a[0:3], 0
    ds_read_b64_tr_b16 v[76:77], v14 offset:12320
    ds_read_b64_tr_b16 v[78:79], v14 offset:13088
    v_mfma_f32_16x16x32_bf16 v[164:167], v[88:91], a[4:7], 0
    ds_read_b64_tr_b16 v[80:81], v15 offset:0
    ds_read_b64_tr_b16 v[82:83], v15 offset:768
    v_mfma_f32_16x16x32_bf16 v[176:179], v[88:91], a[8:11], 0
    buffer_load_dwordx4 v9, s[16:19], s58 offen offset:1024 sc1 lds
    v_mfma_f32_16x16x32_bf16 v[180:183], v[88:91], a[12:15], 0
    s_waitcnt lgkmcnt(2)
    v_mfma_f32_16x16x32_bf16 v[188:191], v[92:95], a[12:15], 0
    ds_read_b64_tr_b16 v[84:85], v15 offset:12320
    ds_read_b64_tr_b16 v[86:87], v15 offset:13088
    v_mfma_f32_16x16x32_bf16 v[184:187], v[92:95], a[8:11], 0
    v_mfma_f32_16x16x32_bf16 v[172:175], v[92:95], a[4:7], 0
    v_mfma_f32_16x16x32_bf16 v[168:171], v[92:95], a[0:3], 0
    v_mfma_f32_16x16x32_bf16 v[192:195], v[72:75], a[0:3], 0
    ds_read_b64_tr_b16 v[88:89], v13 offset:6144
    ds_read_b64_tr_b16 v[90:91], v13 offset:6912
    v_mfma_f32_16x16x32_bf16 v[196:199], v[72:75], a[4:7], 0
    buffer_load_dwordx4 v10, s[16:19], s58 offen offset:2048 sc1 lds
    v_mfma_f32_16x16x32_bf16 v[208:211], v[72:75], a[8:11], 0
    v_mfma_f32_16x16x32_bf16 v[212:215], v[72:75], a[12:15], 0
    s_add_u32 m0, s62, 101568
    v_mfma_f32_16x16x32_bf16 v[220:223], v[76:79], a[12:15], 0
    ds_read_b64_tr_b16 v[92:93], v13 offset:18464
    ds_read_b64_tr_b16 v[94:95], v13 offset:19232
    v_mfma_f32_16x16x32_bf16 v[216:219], v[76:79], a[8:11], 0
    v_mfma_f32_16x16x32_bf16 v[204:207], v[76:79], a[4:7], 0
    buffer_load_dwordx4 v8, s[20:23], s58 offen sc1 lds
    v_mfma_f32_16x16x32_bf16 v[200:203], v[76:79], a[0:3], 0
    s_waitcnt lgkmcnt(0)
    v_mfma_f32_16x16x32_bf16 v[224:227], v[80:83], a[0:3], 0
    ds_read_b64_tr_b16 v[72:73], v14 offset:6144
    ds_read_b64_tr_b16 v[74:75], v14 offset:6912
    v_mfma_f32_16x16x32_bf16 v[228:231], v[80:83], a[4:7], 0
    v_mfma_f32_16x16x32_bf16 v[240:243], v[80:83], a[8:11], 0
    v_mfma_f32_16x16x32_bf16 v[244:247], v[80:83], a[12:15], 0
    v_mfma_f32_16x16x32_bf16 v[252:255], v[84:87], a[12:15], 0
    ds_read_b64_tr_b16 v[76:77], v14 offset:18464
    ds_read_b64_tr_b16 v[78:79], v14 offset:19232
    v_mfma_f32_16x16x32_bf16 v[248:251], v[84:87], a[8:11], 0
    buffer_load_dwordx4 v9, s[20:23], s58 offen offset:1024 sc1 lds
    v_mfma_f32_16x16x32_bf16 v[236:239], v[84:87], a[4:7], 0
    v_mfma_f32_16x16x32_bf16 v[232:235], v[84:87], a[0:3], 0
    v_mfma_f32_16x16x32_bf16 v[160:163], v[88:91], a[16:19], v[160:163]
    ds_read_b64_tr_b16 v[80:81], v15 offset:6144
    ds_read_b64_tr_b16 v[82:83], v15 offset:6912
    v_mfma_f32_16x16x32_bf16 v[164:167], v[88:91], a[20:23], v[164:167]
    v_mfma_f32_16x16x32_bf16 v[176:179], v[88:91], a[24:27], v[176:179]
    buffer_load_dwordx4 v10, s[20:23], s58 offen offset:2048 sc1 lds
    v_mfma_f32_16x16x32_bf16 v[180:183], v[88:91], a[28:31], v[180:183]
    s_add_u32 m0, s62, 64640
    s_mul_i32 s58, s59, 229376
    v_mfma_f32_16x16x32_bf16 v[188:191], v[92:95], a[28:31], v[188:191]
    ds_read_b64_tr_b16 v[84:85], v15 offset:18464
    ds_read_b64_tr_b16 v[86:87], v15 offset:19232
    v_mfma_f32_16x16x32_bf16 v[184:187], v[92:95], a[24:27], v[184:187]
    v_subrev_u32 v13, 24608, v13
    v_subrev_u32 v14, 24608, v14
    v_mfma_f32_16x16x32_bf16 v[172:175], v[92:95], a[20:23], v[172:175]
    v_mfma_f32_16x16x32_bf16 v[168:171], v[92:95], a[16:19], v[168:171]
    v_subrev_u32 v15, 24608, v15
    s_waitcnt lgkmcnt(0)
    v_mfma_f32_16x16x32_bf16 v[192:195], v[72:75], a[16:19], v[192:195]
    buffer_store_dwordx4 v[112:115], v1, s[32:35], s96 offen offset:2048 sc1
    v_mfma_f32_16x16x32_bf16 v[196:199], v[72:75], a[20:23], v[196:199]
    v_mfma_f32_16x16x32_bf16 v[208:211], v[72:75], a[24:27], v[208:211]
    v_mfma_f32_16x16x32_bf16 v[212:215], v[72:75], a[28:31], v[212:215]
    s_waitcnt vmcnt(9)
    s_barrier
    v_mfma_f32_16x16x32_bf16 v[220:223], v[76:79], a[28:31], v[220:223]
    ds_read_b64_tr_b16 v[88:89], v13 offset:0
    ds_read_b64_tr_b16 v[90:91], v13 offset:768
    v_mfma_f32_16x16x32_bf16 v[216:219], v[76:79], a[24:27], v[216:219]
    v_mfma_f32_16x16x32_bf16 v[204:207], v[76:79], a[20:23], v[204:207]
    v_mfma_f32_16x16x32_bf16 v[200:203], v[76:79], a[16:19], v[200:203]
    v_mfma_f32_16x16x32_bf16 v[224:227], v[80:83], a[16:19], v[224:227]
    ds_read_b64_tr_b16 v[92:93], v13 offset:12320
    ds_read_b64_tr_b16 v[94:95], v13 offset:13088
    v_mfma_f32_16x16x32_bf16 v[228:231], v[80:83], a[20:23], v[228:231]
    v_mfma_f32_16x16x32_bf16 v[240:243], v[80:83], a[24:27], v[240:243]
    v_mfma_f32_16x16x32_bf16 v[244:247], v[80:83], a[28:31], v[244:247]
    v_mfma_f32_16x16x32_bf16 v[252:255], v[84:87], a[28:31], v[252:255]
    ds_read_b64_tr_b16 v[72:73], v14 offset:0
    ds_read_b64_tr_b16 v[74:75], v14 offset:768
    v_mfma_f32_16x16x32_bf16 v[248:251], v[84:87], a[24:27], v[248:251]
    ds_read_b64_tr_b16 v[76:77], v14 offset:12320
    ds_read_b64_tr_b16 v[78:79], v14 offset:13088
    v_mfma_f32_16x16x32_bf16 v[236:239], v[84:87], a[20:23], v[236:239]
    buffer_store_dwordx4 v[116:119], v1, s[32:35], s97 offen offset:2048 sc1
    v_mfma_f32_16x16x32_bf16 v[232:235], v[84:87], a[16:19], v[232:235]
    s_waitcnt lgkmcnt(2)
    v_mfma_f32_16x16x32_bf16 v[160:163], v[88:91], a[32:35], v[160:163]
    ds_read_b64_tr_b16 v[80:81], v15 offset:0
    ds_read_b64_tr_b16 v[82:83], v15 offset:768
    v_mfma_f32_16x16x32_bf16 v[164:167], v[88:91], a[36:39], v[164:167]
    v_mfma_f32_16x16x32_bf16 v[176:179], v[88:91], a[40:43], v[176:179]
    v_mfma_f32_16x16x32_bf16 v[180:183], v[88:91], a[44:47], v[180:183]
    v_mfma_f32_16x16x32_bf16 v[188:191], v[92:95], a[44:47], v[188:191]
    ds_read_b64_tr_b16 v[84:85], v15 offset:12320
    ds_read_b64_tr_b16 v[86:87], v15 offset:13088
    v_mfma_f32_16x16x32_bf16 v[184:187], v[92:95], a[40:43], v[184:187]
    v_mfma_f32_16x16x32_bf16 v[172:175], v[92:95], a[36:39], v[172:175]
    v_mfma_f32_16x16x32_bf16 v[168:171], v[92:95], a[32:35], v[168:171]
    v_mfma_f32_16x16x32_bf16 v[192:195], v[72:75], a[32:35], v[192:195]
    ds_read_b64_tr_b16 v[88:89], v13 offset:6144
    ds_read_b64_tr_b16 v[90:91], v13 offset:6912
    v_mfma_f32_16x16x32_bf16 v[196:199], v[72:75], a[36:39], v[196:199]
    v_mfma_f32_16x16x32_bf16 v[208:211], v[72:75], a[40:43], v[208:211]
    v_mfma_f32_16x16x32_bf16 v[212:215], v[72:75], a[44:47], v[212:215]
    s_waitcnt lgkmcnt(0)
    v_mfma_f32_16x16x32_bf16 v[220:223], v[76:79], a[44:47], v[220:223]
    ds_read_b64_tr_b16 v[92:93], v13 offset:18464
    ds_read_b64_tr_b16 v[94:95], v13 offset:19232
    v_mfma_f32_16x16x32_bf16 v[216:219], v[76:79], a[40:43], v[216:219]
    buffer_store_dwordx4 v[128:131], v17, s[32:35], s96 offen offset:0 sc1
    v_mfma_f32_16x16x32_bf16 v[204:207], v[76:79], a[36:39], v[204:207]
    v_mfma_f32_16x16x32_bf16 v[200:203], v[76:79], a[32:35], v[200:203]
    v_mfma_f32_16x16x32_bf16 v[224:227], v[80:83], a[32:35], v[224:227]
    ds_read_b64_tr_b16 v[72:73], v14 offset:6144
    ds_read_b64_tr_b16 v[74:75], v14 offset:6912
    v_mfma_f32_16x16x32_bf16 v[228:231], v[80:83], a[36:39], v[228:231]
    v_mfma_f32_16x16x32_bf16 v[240:243], v[80:83], a[40:43], v[240:243]
    v_mfma_f32_16x16x32_bf16 v[244:247], v[80:83], a[44:47], v[244:247]
    v_mfma_f32_16x16x32_bf16 v[252:255], v[84:87], a[44:47], v[252:255]
    ds_read_b64_tr_b16 v[76:77], v14 offset:18464
    ds_read_b64_tr_b16 v[78:79], v14 offset:19232
    v_mfma_f32_16x16x32_bf16 v[248:251], v[84:87], a[40:43], v[248:251]
    v_mfma_f32_16x16x32_bf16 v[236:239], v[84:87], a[36:39], v[236:239]
    v_mfma_f32_16x16x32_bf16 v[232:235], v[84:87], a[32:35], v[232:235]
    v_mfma_f32_16x16x32_bf16 v[160:163], v[88:91], a[48:51], v[160:163]
    ds_read_b64_tr_b16 v[80:81], v15 offset:6144
    ds_read_b64_tr_b16 v[82:83], v15 offset:6912
    v_mfma_f32_16x16x32_bf16 v[164:167], v[88:91], a[52:55], v[164:167]
    v_mfma_f32_16x16x32_bf16 v[176:179], v[88:91], a[56:59], v[176:179]
    buffer_store_dwordx4 v[132:135], v17, s[32:35], s96 offen offset:512 sc1
    v_mfma_f32_16x16x32_bf16 v[180:183], v[88:91], a[60:63], v[180:183]
    s_waitcnt lgkmcnt(0)
    v_mfma_f32_16x16x32_bf16 v[188:191], v[92:95], a[60:63], v[188:191]
    ds_read_b64_tr_b16 v[84:85], v15 offset:18464
    ds_read_b64_tr_b16 v[86:87], v15 offset:19232
    v_mfma_f32_16x16x32_bf16 v[184:187], v[92:95], a[56:59], v[184:187]
    v_subrev_u32 v13, 24608, v13
    v_subrev_u32 v14, 24608, v14
    v_mfma_f32_16x16x32_bf16 v[172:175], v[92:95], a[52:55], v[172:175]
    v_mfma_f32_16x16x32_bf16 v[168:171], v[92:95], a[48:51], v[168:171]
    buffer_store_dwordx4 v[144:147], v17, s[32:35], s96 offen offset:2048 sc1
    buffer_store_dwordx4 v[148:151], v17, s[32:35], s96 offen offset:2560 sc1
    v_mfma_f32_16x16x32_bf16 v[192:195], v[72:75], a[48:51], v[192:195]
    v_subrev_u32 v15, 24608, v15
    v_mfma_f32_16x16x32_bf16 v[196:199], v[72:75], a[52:55], v[196:199]
    v_mfma_f32_16x16x32_bf16 v[208:211], v[72:75], a[56:59], v[208:211]
    v_mfma_f32_16x16x32_bf16 v[212:215], v[72:75], a[60:63], v[212:215]
    s_waitcnt vmcnt(6) lgkmcnt(0)
    s_barrier
    v_mfma_f32_16x16x32_bf16 v[220:223], v[76:79], a[60:63], v[220:223]
    ds_read_b64_tr_b16 v[88:89], v13 offset:0
    ds_read_b64_tr_b16 v[90:91], v13 offset:768
    v_mfma_f32_16x16x32_bf16 v[216:219], v[76:79], a[56:59], v[216:219]
    buffer_load_dwordx4 v8, s[16:19], s58 offen sc1 lds
    buffer_load_dwordx4 v9, s[16:19], s58 offen offset:1024 sc1 lds
    buffer_load_dwordx4 v10, s[16:19], s58 offen offset:2048 sc1 lds
    s_add_u32 m0, s62, 76960
    s_nop 0
    buffer_load_dwordx4 v8, s[20:23], s58 offen sc1 lds
    buffer_load_dwordx4 v9, s[20:23], s58 offen offset:1024 sc1 lds
    buffer_load_dwordx4 v10, s[20:23], s58 offen offset:2048 sc1 lds
    buffer_load_dword v23, v21, s[40:43], 0 offen sc1
    v_mfma_f32_16x16x32_bf16 v[204:207], v[76:79], a[52:55], v[204:207]
    s_add_u32 m0, s62, 138464
    s_add_u32 s59, s52, 4
    s_and_b32 s59, s59, 7
    v_mfma_f32_16x16x32_bf16 v[200:203], v[76:79], a[48:51], v[200:203]
    s_mul_i32 s58, s59, 229376
    v_mfma_f32_16x16x32_bf16 v[224:227], v[80:83], a[48:51], v[224:227]
    ds_read_b64_tr_b16 v[92:93], v13 offset:12320
    ds_read_b64_tr_b16 v[94:95], v13 offset:13088
    v_mfma_f32_16x16x32_bf16 v[228:231], v[80:83], a[52:55], v[228:231]
    buffer_load_dwordx4 v8, s[16:19], s58 offen sc1 lds
    v_mfma_f32_16x16x32_bf16 v[240:243], v[80:83], a[56:59], v[240:243]
    v_mfma_f32_16x16x32_bf16 v[244:247], v[80:83], a[60:63], v[244:247]
    s_add_u32 s59, s52, 5
    s_and_b32 s59, s59, 7
    v_mfma_f32_16x16x32_bf16 v[252:255], v[84:87], a[60:63], v[252:255]
    ds_read_b64_tr_b16 v[72:73], v14 offset:0
    ds_read_b64_tr_b16 v[74:75], v14 offset:768
    v_mfma_f32_16x16x32_bf16 v[248:251], v[84:87], a[56:59], v[248:251]
    ds_read_b64_tr_b16 v[76:77], v14 offset:12320
    ds_read_b64_tr_b16 v[78:79], v14 offset:13088
    v_mfma_f32_16x16x32_bf16 v[236:239], v[84:87], a[52:55], v[236:239]
    buffer_load_dwordx4 v9, s[16:19], s58 offen offset:1024 sc1 lds
    v_mfma_f32_16x16x32_bf16 v[232:235], v[84:87], a[48:51], v[232:235]
    s_waitcnt lgkmcnt(2)
    v_mfma_f32_16x16x32_bf16 v[160:163], v[88:91], a[64:67], v[160:163]
    ds_read_b64_tr_b16 v[80:81], v15 offset:0
    ds_read_b64_tr_b16 v[82:83], v15 offset:768
    v_mfma_f32_16x16x32_bf16 v[164:167], v[88:91], a[68:71], v[164:167]
    v_mfma_f32_16x16x32_bf16 v[176:179], v[88:91], a[72:75], v[176:179]
    v_mfma_f32_16x16x32_bf16 v[180:183], v[88:91], a[76:79], v[180:183]
    v_mfma_f32_16x16x32_bf16 v[188:191], v[92:95], a[76:79], v[188:191]
    ds_read_b64_tr_b16 v[84:85], v15 offset:12320
    ds_read_b64_tr_b16 v[86:87], v15 offset:13088
    v_mfma_f32_16x16x32_bf16 v[184:187], v[92:95], a[72:75], v[184:187]
    buffer_load_dwordx4 v10, s[16:19], s58 offen offset:2048 sc1 lds
    v_mfma_f32_16x16x32_bf16 v[172:175], v[92:95], a[68:71], v[172:175]
    v_mfma_f32_16x16x32_bf16 v[168:171], v[92:95], a[64:67], v[168:171]
    s_add_u32 m0, s62, 150784
    v_mfma_f32_16x16x32_bf16 v[192:195], v[72:75], a[64:67], v[192:195]
    ds_read_b64_tr_b16 v[88:89], v13 offset:6144
    ds_read_b64_tr_b16 v[90:91], v13 offset:6912
    v_mfma_f32_16x16x32_bf16 v[196:199], v[72:75], a[68:71], v[196:199]
    buffer_load_dwordx4 v8, s[20:23], s58 offen sc1 lds
    v_mfma_f32_16x16x32_bf16 v[208:211], v[72:75], a[72:75], v[208:211]
    v_mfma_f32_16x16x32_bf16 v[212:215], v[72:75], a[76:79], v[212:215]
    s_waitcnt lgkmcnt(0)
    v_mfma_f32_16x16x32_bf16 v[220:223], v[76:79], a[76:79], v[220:223]
    ds_read_b64_tr_b16 v[92:93], v13 offset:18464
    ds_read_b64_tr_b16 v[94:95], v13 offset:19232
    v_mfma_f32_16x16x32_bf16 v[216:219], v[76:79], a[72:75], v[216:219]
    v_mfma_f32_16x16x32_bf16 v[204:207], v[76:79], a[68:71], v[204:207]
    v_mfma_f32_16x16x32_bf16 v[200:203], v[76:79], a[64:67], v[200:203]
    v_mfma_f32_16x16x32_bf16 v[224:227], v[80:83], a[64:67], v[224:227]
    ds_read_b64_tr_b16 v[72:73], v14 offset:6144
    ds_read_b64_tr_b16 v[74:75], v14 offset:6912
    v_mfma_f32_16x16x32_bf16 v[228:231], v[80:83], a[68:71], v[228:231]
    buffer_load_dwordx4 v9, s[20:23], s58 offen offset:1024 sc1 lds
    v_mfma_f32_16x16x32_bf16 v[240:243], v[80:83], a[72:75], v[240:243]
    v_mfma_f32_16x16x32_bf16 v[244:247], v[80:83], a[76:79], v[244:247]
    v_mfma_f32_16x16x32_bf16 v[252:255], v[84:87], a[76:79], v[252:255]
    ds_read_b64_tr_b16 v[76:77], v14 offset:18464
    ds_read_b64_tr_b16 v[78:79], v14 offset:19232
    v_mfma_f32_16x16x32_bf16 v[248:251], v[84:87], a[72:75], v[248:251]
    v_mfma_f32_16x16x32_bf16 v[236:239], v[84:87], a[68:71], v[236:239]
    buffer_load_dwordx4 v10, s[20:23], s58 offen offset:2048 sc1 lds
    v_mfma_f32_16x16x32_bf16 v[232:235], v[84:87], a[64:67], v[232:235]
    s_add_u32 s101, s55, 0
    s_mul_i32 s58, s59, 229376
    v_mfma_f32_16x16x32_bf16 v[160:163], v[88:91], a[80:83], v[160:163]
    ds_read_b64_tr_b16 v[80:81], v15 offset:6144
    ds_read_b64_tr_b16 v[82:83], v15 offset:6912
    v_mfma_f32_16x16x32_bf16 v[164:167], v[88:91], a[84:87], v[164:167]
    s_cmp_ge_u32 s101, 7
    s_cselect_b32 s100, 7, 0
    s_sub_u32 s101, s101, s100
    v_mfma_f32_16x16x32_bf16 v[176:179], v[88:91], a[88:91], v[176:179]
    v_mfma_f32_16x16x32_bf16 v[180:183], v[88:91], a[92:95], v[180:183]
    s_mul_i32 s100, s3, 7
    s_add_u32 s101, s101, s100
    s_waitcnt lgkmcnt(0)
    v_mfma_f32_16x16x32_bf16 v[188:191], v[92:95], a[92:95], v[188:191]
    ds_read_b64_tr_b16 v[84:85], v15 offset:18464
    ds_read_b64_tr_b16 v[86:87], v15 offset:19232
    v_mfma_f32_16x16x32_bf16 v[184:187], v[92:95], a[88:91], v[184:187]
    s_lshl_b32 s100, s101, 16
    s_add_u32 m0, s61, 0
    v_mfma_f32_16x16x32_bf16 v[172:175], v[92:95], a[84:87], v[172:175]
    buffer_load_dwordx4 v24, s[24:27], s100 offen sc1 lds
    v_mfma_f32_16x16x32_bf16 v[168:171], v[92:95], a[80:83], v[168:171]
    v_subrev_u32 v13, 24608, v13
    v_mfma_f32_16x16x32_bf16 v[192:195], v[72:75], a[80:83], v[192:195]
    s_waitcnt vmcnt(7)
    v_cmp_lt_u32 vcc, v23, v22
    s_nop 4
    s_cbranch_vccnz L_spin_501
L_back_502:
    v_mfma_f32_16x16x32_bf16 v[196:199], v[72:75], a[84:87], v[196:199]
    v_subrev_u32 v14, 24608, v14
    v_subrev_u32 v15, 24608, v15
    v_mfma_f32_16x16x32_bf16 v[208:211], v[72:75], a[88:91], v[208:211]
    buffer_load_dwordx4 v25, s[24:27], s100 offen offset:1024 sc1 lds
    v_mfma_f32_16x16x32_bf16 v[212:215], v[72:75], a[92:95], v[212:215]
    s_waitcnt lgkmcnt(0)
    s_barrier
    v_mfma_f32_16x16x32_bf16 v[220:223], v[76:79], a[92:95], v[220:223]
    ds_read_b64_tr_b16 v[88:89], v13 offset:0
    ds_read_b64_tr_b16 v[90:91], v13 offset:768
    buffer_store_dword v20, v18, s[32:35], 0 offen sc1
    v_mfma_f32_16x16x32_bf16 v[216:219], v[76:79], a[88:91], v[216:219]
    buffer_load_dwordx4 v26, s[24:27], s100 offen offset:2048 sc1 lds
    v_mfma_f32_16x16x32_bf16 v[204:207], v[76:79], a[84:87], v[204:207]
    buffer_load_dwordx4 v27, s[24:27], s100 offen offset:3072 sc1 lds
    v_mfma_f32_16x16x32_bf16 v[200:203], v[76:79], a[80:83], v[200:203]
    s_add_u32 m0, s62, 113856
    v_mfma_f32_16x16x32_bf16 v[224:227], v[80:83], a[80:83], v[224:227]
    ds_read_b64_tr_b16 v[92:93], v13 offset:12320
    ds_read_b64_tr_b16 v[94:95], v13 offset:13088
    v_mfma_f32_16x16x32_bf16 v[228:231], v[80:83], a[84:87], v[228:231]
    buffer_load_dwordx4 v8, s[16:19], s58 offen sc1 lds
    v_mfma_f32_16x16x32_bf16 v[240:243], v[80:83], a[88:91], v[240:243]
    v_mfma_f32_16x16x32_bf16 v[244:247], v[80:83], a[92:95], v[244:247]
    s_add_u32 s59, s52, 6
    s_and_b32 s59, s59, 7
    v_mfma_f32_16x16x32_bf16 v[252:255], v[84:87], a[92:95], v[252:255]
    ds_read_b64_tr_b16 v[72:73], v14 offset:0
    ds_read_b64_tr_b16 v[74:75], v14 offset:768
    v_mfma_f32_16x16x32_bf16 v[248:251], v[84:87], a[88:91], v[248:251]
    ds_read_b64_tr_b16 v[76:77], v14 offset:12320
    ds_read_b64_tr_b16 v[78:79], v14 offset:13088
    v_mfma_f32_16x16x32_bf16 v[236:239], v[84:87], a[84:87], v[236:239]
    v_mfma_f32_16x16x32_bf16 v[232:235], v[84:87], a[80:83], v[232:235]
    s_waitcnt lgkmcnt(2)
    v_mfma_f32_16x16x32_bf16 v[160:163], v[88:91], a[96:99], v[160:163]
    ds_read_b64_tr_b16 v[80:81], v15 offset:0
    ds_read_b64_tr_b16 v[82:83], v15 offset:768
    v_mfma_f32_16x16x32_bf16 v[164:167], v[88:91], a[100:103], v[164:167]
    buffer_load_dwordx4 v9, s[16:19], s58 offen offset:1024 sc1 lds
    v_mfma_f32_16x16x32_bf16 v[176:179], v[88:91], a[104:107], v[176:179]
    v_mfma_f32_16x16x32_bf16 v[180:183], v[88:91], a[108:111], v[180:183]
    v_mfma_f32_16x16x32_bf16 v[188:191], v[92:95], a[108:111], v[188:191]
    ds_read_b64_tr_b16 v[84:85], v15 offset:12320
    ds_read_b64_tr_b16 v[86:87], v15 offset:13088
    v_mfma_f32_16x16x32_bf16 v[184:187], v[92:95], a[104:107], v[184:187]
    v_mfma_f32_16x16x32_bf16 v[172:175], v[92:95], a[100:103], v[172:175]
    buffer_load_dwordx4 v10, s[16:19], s58 offen offset:2048 sc1 lds
    v_mfma_f32_16x16x32_bf16 v[168:171], v[92:95], a[96:99], v[168:171]
    s_add_u32 m0, s62, 126176
    v_mfma_f32_16x16x32_bf16 v[192:195], v[72:75], a[96:99], v[192:195]
    ds_read_b64_tr_b16 v[88:89], v13 offset:6144
    ds_read_b64_tr_b16 v[90:91], v13 offset:6912
    v_mfma_f32_16x16x32_bf16 v[196:199], v[72:75], a[100:103], v[196:199]
    v_mfma_f32_16x16x32_bf16 v[208:211], v[72:75], a[104:107], v[208:211]
    v_mfma_f32_16x16x32_bf16 v[212:215], v[72:75], a[108:111], v[212:215]
    s_waitcnt lgkmcnt(0)
    v_mfma_f32_16x16x32_bf16 v[220:223], v[76:79], a[108:111], v[220:223]
    ds_read_b64_tr_b16 v[92:93], v13 offset:18464
    ds_read_b64_tr_b16 v[94:95], v13 offset:19232
    v_mfma_f32_16x16x32_bf16 v[216:219], v[76:79], a[104:107], v[216:219]
    buffer_load_dwordx4 v8, s[20:23], s58 offen sc1 lds
    v_mfma_f32_16x16x32_bf16 v[204:207], v[76:79], a[100:103], v[204:207]
    v_mfma_f32_16x16x32_bf16 v[200:203], v[76:79], a[96:99], v[200:203]
    v_mfma_f32_16x16x32_bf16 v[224:227], v[80:83], a[96:99], v[224:227]
    ds_read_b64_tr_b16 v[72:73], v14 offset:6144
    ds_read_b64_tr_b16 v[74:75], v14 offset:6912
    v_mfma_f32_16x16x32_bf16 v[228:231], v[80:83], a[100:103], v[228:231]
    v_mfma_f32_16x16x32_bf16 v[240:243], v[80:83], a[104:107], v[240:243]
    buffer_load_dwordx4 v9, s[20:23], s58 offen offset:1024 sc1 lds
    v_mfma_f32_16x16x32_bf16 v[244:247], v[80:83], a[108:111], v[244:247]
    v_mfma_f32_16x16x32_bf16 v[252:255], v[84:87], a[108:111], v[252:255]
    ds_read_b64_tr_b16 v[76:77], v14 offset:18464
    ds_read_b64_tr_b16 v[78:79], v14 offset:19232
    v_mfma_f32_16x16x32_bf16 v[248:251], v[84:87], a[104:107], v[248:251]
    v_mfma_f32_16x16x32_bf16 v[236:239], v[84:87], a[100:103], v[236:239]
    v_mfma_f32_16x16x32_bf16 v[232:235], v[84:87], a[96:99], v[232:235]
    v_mfma_f32_16x16x32_bf16 v[160:163], v[88:91], a[112:115], v[160:163]
    ds_read_b64_tr_b16 v[80:81], v15 offset:6144
    ds_read_b64_tr_b16 v[82:83], v15 offset:6912
    v_mfma_f32_16x16x32_bf16 v[164:167], v[88:91], a[116:119], v[164:167]
    buffer_load_dwordx4 v10, s[20:23], s58 offen offset:2048 sc1 lds
    v_mfma_f32_16x16x32_bf16 v[176:179], v[88:91], a[120:123], v[176:179]
    v_mfma_f32_16x16x32_bf16 v[180:183], v[88:91], a[124:127], v[180:183]
    s_add_u32 s100, s100, 32768
    s_add_u32 m0, s61, 16384
    s_waitcnt lgkmcnt(0)
    v_mfma_f32_16x16x32_bf16 v[188:191], v[92:95], a[124:127], v[188:191]
    ds_read_b64_tr_b16 v[84:85], v15 offset:18464
    ds_read_b64_tr_b16 v[86:87], v15 offset:19232
    v_mfma_f32_16x16x32_bf16 v[184:187], v[92:95], a[120:123], v[184:187]
    s_mul_i32 s58, s59, 229376
    v_add_u32 v13, 73824, v13
    v_mfma_f32_16x16x32_bf16 v[172:175], v[92:95], a[116:119], v[172:175]
    v_mfma_f32_16x16x32_bf16 v[168:171], v[92:95], a[112:115], v[168:171]
    v_add_u32 v14, 73824, v14
    v_mfma_f32_16x16x32_bf16 v[192:195], v[72:75], a[112:115], v[192:195]
    v_add_u32 v15, 73824, v15
    v_mfma_f32_16x16x32_bf16 v[196:199], v[72:75], a[116:119], v[196:199]
    buffer_load_dwordx4 v24, s[24:27], s100 offen sc1 lds
    v_mfma_f32_16x16x32_bf16 v[208:211], v[72:75], a[120:123], v[208:211]
    buffer_load_dwordx4 v25, s[24:27], s100 offen offset:1024 sc1 lds
    v_mfma_f32_16x16x32_bf16 v[212:215], v[72:75], a[124:127], v[212:215]
    s_waitcnt vmcnt(13) lgkmcnt(0)
    s_barrier
    v_mfma_f32_16x16x32_bf16 v[220:223], v[76:79], a[124:127], v[220:223]
    ds_read_b64_tr_b16 v[88:89], v13 offset:0
    ds_read_b64_tr_b16 v[90:91], v13 offset:768
    v_mfma_f32_16x16x32_bf16 v[216:219], v[76:79], a[120:123], v[216:219]
    v_mfma_f32_16x16x32_bf16 v[204:207], v[76:79], a[116:119], v[204:207]
    buffer_load_dwordx4 v26, s[24:27], s100 offen offset:2048 sc1 lds
    v_mfma_f32_16x16x32_bf16 v[200:203], v[76:79], a[112:115], v[200:203]
    v_mfma_f32_16x16x32_bf16 v[224:227], v[80:83], a[112:115], v[224:227]
    ds_read_b64_tr_b16 v[92:93], v13 offset:12320
    ds_read_b64_tr_b16 v[94:95], v13 offset:13088
    v_mfma_f32_16x16x32_bf16 v[228:231], v[80:83], a[116:119], v[228:231]
    v_mfma_f32_16x16x32_bf16 v[240:243], v[80:83], a[120:123], v[240:243]
    buffer_load_dwordx4 v27, s[24:27], s100 offen offset:3072 sc1 lds
    v_mfma_f32_16x16x32_bf16 v[244:247], v[80:83], a[124:127], v[244:247]
    s_add_u32 m0, s62, 89248
    v_mfma_f32_16x16x32_bf16 v[252:255], v[84:87], a[124:127], v[252:255]
    ds_read_b64_tr_b16 v[72:73], v14 offset:0
    ds_read_b64_tr_b16 v[74:75], v14 offset:768
    v_mfma_f32_16x16x32_bf16 v[248:251], v[84:87], a[120:123], v[248:251]
    ds_read_b64_tr_b16 v[76:77], v14 offset:12320
    ds_read_b64_tr_b16 v[78:79], v14 offset:13088
    v_mfma_f32_16x16x32_bf16 v[236:239], v[84:87], a[116:119], v[236:239]
    buffer_load_dwordx4 v8, s[16:19], s58 offen sc1 lds
    v_mfma_f32_16x16x32_bf16 v[232:235], v[84:87], a[112:115], v[232:235]
    s_add_u32 s59, s52, 7
    s_and_b32 s59, s59, 7
    s_waitcnt lgkmcnt(2)
    v_mfma_f32_16x16x32_bf16 v[160:163], v[88:91], a[128:131], v[160:163]
    ds_read_b64_tr_b16 v[80:81], v15 offset:0
    ds_read_b64_tr_b16 v[82:83], v15 offset:768
    v_mfma_f32_16x16x32_bf16 v[164:167], v[88:91], a[132:135], v[164:167]
    v_mfma_f32_16x16x32_bf16 v[176:179], v[88:91], a[136:139], v[176:179]
    v_mfma_f32_16x16x32_bf16 v[180:183], v[88:91], a[140:143], v[180:183]
    v_mfma_f32_16x16x32_bf16 v[188:191], v[92:95], a[140:143], v[188:191]
    ds_read_b64_tr_b16 v[84:85], v15 offset:12320
    ds_read_b64_tr_b16 v[86:87], v15 offset:13088
    v_mfma_f32_16x16x32_bf16 v[184:187], v[92:95], a[136:139], v[184:187]
    buffer_load_dwordx4 v9, s[16:19], s58 offen offset:1024 sc1 lds
    v_mfma_f32_16x16x32_bf16 v[172:175], v[92:95], a[132:135], v[172:175]
    v_mfma_f32_16x16x32_bf16 v[168:171], v[92:95], a[128:131], v[168:171]
    v_mfma_f32_16x16x32_bf16 v[192:195], v[72:75], a[128:131], v[192:195]
    ds_read_b64_tr_b16 v[88:89], v13 offset:6144
    ds_read_b64_tr_b16 v[90:91], v13 offset:6912
    v_mfma_f32_16x16x32_bf16 v[196:199], v[72:75], a[132:135], v[196:199]
    v_mfma_f32_16x16x32_bf16 v[208:211], v[72:75], a[136:139], v[208:211]
    buffer_load_dwordx4 v10, s[16:19], s58 offen offset:2048 sc1 lds
    v_mfma_f32_16x16x32_bf16 v[212:215], v[72:75], a[140:143], v[212:215]
    s_add_u32 m0, s62, 101568
    s_waitcnt lgkmcnt(0)
    v_mfma_f32_16x16x32_bf16 v[220:223], v[76:79], a[140:143], v[220:223]
    ds_read_b64_tr_b16 v[92:93], v13 offset:18464
    ds_read_b64_tr_b16 v[94:95], v13 offset:19232
    v_mfma_f32_16x16x32_bf16 v[216:219], v[76:79], a[136:139], v[216:219]
    v_mfma_f32_16x16x32_bf16 v[204:207], v[76:79], a[132:135], v[204:207]
    v_mfma_f32_16x16x32_bf16 v[200:203], v[76:79], a[128:131], v[200:203]
    v_mfma_f32_16x16x32_bf16 v[224:227], v[80:83], a[128:131], v[224:227]
    ds_read_b64_tr_b16 v[72:73], v14 offset:6144
    ds_read_b64_tr_b16 v[74:75], v14 offset:6912
    v_mfma_f32_16x16x32_bf16 v[228:231], v[80:83], a[132:135], v[228:231]
    buffer_load_dwordx4 v8, s[20:23], s58 offen sc1 lds
    v_mfma_f32_16x16x32_bf16 v[240:243], v[80:83], a[136:139], v[240:243]
    v_mfma_f32_16x16x32_bf16 v[244:247], v[80:83], a[140:143], v[244:247]
    v_mfma_f32_16x16x32_bf16 v[252:255], v[84:87], a[140:143], v[252:255]
    ds_read_b64_tr_b16 v[76:77], v14 offset:18464
    ds_read_b64_tr_b16 v[78:79], v14 offset:19232
    v_mfma_f32_16x16x32_bf16 v[248:251], v[84:87], a[136:139], v[248:251]
    v_mfma_f32_16x16x32_bf16 v[236:239], v[84:87], a[132:135], v[236:239]
    v_mfma_f32_16x16x32_bf16 v[232:235], v[84:87], a[128:131], v[232:235]
    v_mfma_f32_16x16x32_bf16 v[160:163], v[88:91], a[144:147], v[160:163]
    ds_read_b64_tr_b16 v[80:81], v15 offset:6144
    ds_read_b64_tr_b16 v[82:83], v15 offset:6912
    v_mfma_f32_16x16x32_bf16 v[164:167], v[88:91], a[148:151], v[164:167]
    buffer_load_dwordx4 v9, s[20:23], s58 offen offset:1024 sc1 lds
    v_mfma_f32_16x16x32_bf16 v[176:179], v[88:91], a[152:155], v[176:179]
    v_mfma_f32_16x16x32_bf16 v[180:183], v[88:91], a[156:159], v[180:183]
    s_waitcnt lgkmcnt(0)
    v_mfma_f32_16x16x32_bf16 v[188:191], v[92:95], a[156:159], v[188:191]
    ds_read_b64_tr_b16 v[84:85], v15 offset:18464
    ds_read_b64_tr_b16 v[86:87], v15 offset:19232
    v_mfma_f32_16x16x32_bf16 v[184:187], v[92:95], a[152:155], v[184:187]
    v_subrev_u32 v13, 24608, v13
    v_subrev_u32 v14, 24608, v14
    v_mfma_f32_16x16x32_bf16 v[172:175], v[92:95], a[148:151], v[172:175]
    buffer_load_dwordx4 v10, s[20:23], s58 offen offset:2048 sc1 lds
    v_mfma_f32_16x16x32_bf16 v[168:171], v[92:95], a[144:147], v[168:171]
    s_add_u32 s101, s55, 1
    s_mul_i32 s58, s59, 229376
    v_mfma_f32_16x16x32_bf16 v[192:195], v[72:75], a[144:147], v[192:195]
    s_cmp_ge_u32 s101, 7
    s_cselect_b32 s100, 7, 0
    s_sub_u32 s101, s101, s100
    v_mfma_f32_16x16x32_bf16 v[196:199], v[72:75], a[148:151], v[196:199]
    s_mul_i32 s100, s3, 7
    s_add_u32 s101, s101, s100
    s_lshl_b32 s100, s101, 16
    v_mfma_f32_16x16x32_bf16 v[208:211], v[72:75], a[152:155], v[208:211]
    v_mfma_f32_16x16x32_bf16 v[212:215], v[72:75], a[156:159], v[212:215]
    s_waitcnt vmcnt(10) lgkmcnt(0)
    s_barrier
    v_subrev_u32 v15, 24608, v15
    v_mfma_f32_16x16x32_bf16 v[220:223], v[76:79], a[156:159], v[220:223]
    ds_read_b64_tr_b16 v[88:89], v13 offset:0
    ds_read_b64_tr_b16 v[90:91], v13 offset:768
    v_mfma_f32_16x16x32_bf16 v[216:219], v[76:79], a[152:155], v[216:219]
    s_add_u32 m0, s61, 32768
    v_mfma_f32_16x16x32_bf16 v[204:207], v[76:79], a[148:151], v[204:207]
    buffer_load_dword v23, v4, s[32:35], 0 offen sc1
    v_mfma_f32_16x16x32_bf16 v[200:203], v[76:79], a[144:147], v[200:203]
    s_lshl_b32 s10, s48, 2
    s_lshr_b32 s8, s3, 1
    v_mfma_f32_16x16x32_bf16 v[224:227], v[80:83], a[144:147], v[224:227]
    ds_read_b64_tr_b16 v[92:93], v13 offset:12320
    ds_read_b64_tr_b16 v[94:95], v13 offset:13088
    v_mfma_f32_16x16x32_bf16 v[228:231], v[80:83], a[148:151], v[228:231]
    buffer_load_dwordx4 v24, s[24:27], s100 offen sc1 lds
    v_mfma_f32_16x16x32_bf16 v[240:243], v[80:83], a[152:155], v[240:243]
    v_mfma_f32_16x16x32_bf16 v[244:247], v[80:83], a[156:159], v[244:247]
    s_mul_i32 s9, s8, 6
    s_add_u32 s10, s10, s9
    v_mfma_f32_16x16x32_bf16 v[252:255], v[84:87], a[156:159], v[252:255]
    ds_read_b64_tr_b16 v[72:73], v14 offset:0
    ds_read_b64_tr_b16 v[74:75], v14 offset:768
    v_mfma_f32_16x16x32_bf16 v[248:251], v[84:87], a[152:155], v[248:251]
    ds_read_b64_tr_b16 v[76:77], v14 offset:12320
    ds_read_b64_tr_b16 v[78:79], v14 offset:13088
    v_mfma_f32_16x16x32_bf16 v[236:239], v[84:87], a[148:151], v[236:239]
    buffer_load_dwordx4 v25, s[24:27], s100 offen offset:1024 sc1 lds
    v_mfma_f32_16x16x32_bf16 v[232:235], v[84:87], a[144:147], v[232:235]
    s_sub_u32 s10, s10, 8
    s_mul_i32 s13, s8, 12480
    s_waitcnt lgkmcnt(2)
    v_mfma_f32_16x16x32_bf16 v[160:163], v[88:91], a[160:163], v[160:163]
    ds_read_b64_tr_b16 v[80:81], v15 offset:0
    ds_read_b64_tr_b16 v[82:83], v15 offset:768
    v_mfma_f32_16x16x32_bf16 v[164:167], v[88:91], a[164:167], v[164:167]
    buffer_load_dwordx4 v26, s[24:27], s100 offen offset:2048 sc1 lds
    v_mfma_f32_16x16x32_bf16 v[176:179], v[88:91], a[168:171], v[176:179]
    buffer_load_dwordx4 v27, s[24:27], s100 offen offset:3072 sc1 lds
    v_mfma_f32_16x16x32_bf16 v[180:183], v[88:91], a[172:175], v[180:183]
    s_add_u32 m0, s62, 64640
    s_and_b32 s8, s3, 1
    v_mfma_f32_16x16x32_bf16 v[188:191], v[92:95], a[172:175], v[188:191]
    ds_read_b64_tr_b16 v[84:85], v15 offset:12320
    ds_read_b64_tr_b16 v[86:87], v15 offset:13088
    v_mfma_f32_16x16x32_bf16 v[184:187], v[92:95], a[168:171], v[184:187]
    s_mul_i32 s9, s8, 24960
    s_add_u32 s13, s13, s9
    s_lshl_b32 s12, s49, 6
    v_mfma_f32_16x16x32_bf16 v[172:175], v[92:95], a[164:167], v[172:175]
    buffer_load_dwordx4 v8, s[16:19], s58 offen sc1 lds
    v_mfma_f32_16x16x32_bf16 v[168:171], v[92:95], a[160:163], v[168:171]
    s_add_u32 s8, s12, s10
    s_lshl_b32 s97, s8, 11
    v_mfma_f32_16x16x32_bf16 v[192:195], v[72:75], a[160:163], v[192:195]
    ds_read_b64_tr_b16 v[88:89], v13 offset:6144
    ds_read_b64_tr_b16 v[90:91], v13 offset:6912
    v_mfma_f32_16x16x32_bf16 v[196:199], v[72:75], a[164:167], v[196:199]
    s_add_u32 s97, s97, 2097152
    s_add_u32 s12, s12, s46
    s_add_u32 s12, s12, 8
    v_mfma_f32_16x16x32_bf16 v[208:211], v[72:75], a[168:171], v[208:211]
    v_mfma_f32_16x16x32_bf16 v[212:215], v[72:75], a[172:175], v[212:215]
    s_lshl_b32 s12, s12, 10
    s_waitcnt lgkmcnt(0)
    v_mfma_f32_16x16x32_bf16 v[220:223], v[76:79], a[172:175], v[220:223]
    ds_read_b64_tr_b16 v[92:93], v13 offset:18464
    ds_read_b64_tr_b16 v[94:95], v13 offset:19232
    v_mfma_f32_16x16x32_bf16 v[216:219], v[76:79], a[168:171], v[216:219]
    buffer_load_dwordx4 v9, s[16:19], s58 offen offset:1024 sc1 lds
    v_mfma_f32_16x16x32_bf16 v[204:207], v[76:79], a[164:167], v[204:207]
    v_mfma_f32_16x16x32_bf16 v[200:203], v[76:79], a[160:163], v[200:203]
    v_mfma_f32_16x16x32_bf16 v[224:227], v[80:83], a[160:163], v[224:227]
    ds_read_b64_tr_b16 v[72:73], v14 offset:6144
    ds_read_b64_tr_b16 v[74:75], v14 offset:6912
    v_mfma_f32_16x16x32_bf16 v[228:231], v[80:83], a[164:167], v[228:231]
    v_mfma_f32_16x16x32_bf16 v[240:243], v[80:83], a[168:171], v[240:243]
    buffer_load_dwordx4 v10, s[16:19], s58 offen offset:2048 sc1 lds
    v_mfma_f32_16x16x32_bf16 v[244:247], v[80:83], a[172:175], v[244:247]
    s_add_u32 m0, s62, 76960
    v_mfma_f32_16x16x32_bf16 v[252:255], v[84:87], a[172:175], v[252:255]
    ds_read_b64_tr_b16 v[76:77], v14 offset:18464
    ds_read_b64_tr_b16 v[78:79], v14 offset:19232
    v_mfma_f32_16x16x32_bf16 v[248:251], v[84:87], a[168:171], v[248:251]
    v_mfma_f32_16x16x32_bf16 v[236:239], v[84:87], a[164:167], v[236:239]
    v_mfma_f32_16x16x32_bf16 v[232:235], v[84:87], a[160:163], v[232:235]
    v_mfma_f32_16x16x32_bf16 v[160:163], v[88:91], a[176:179], v[160:163]
    ds_read_b64_tr_b16 v[80:81], v15 offset:6144
    ds_read_b64_tr_b16 v[82:83], v15 offset:6912
    v_mfma_f32_16x16x32_bf16 v[164:167], v[88:91], a[180:183], v[164:167]
    buffer_load_dwordx4 v8, s[20:23], s58 offen sc1 lds
    v_mfma_f32_16x16x32_bf16 v[176:179], v[88:91], a[184:187], v[176:179]
    v_mfma_f32_16x16x32_bf16 v[180:183], v[88:91], a[188:191], v[180:183]
    s_waitcnt lgkmcnt(0)
    v_mfma_f32_16x16x32_bf16 v[188:191], v[92:95], a[188:191], v[188:191]
    ds_read_b64_tr_b16 v[84:85], v15 offset:18464
    ds_read_b64_tr_b16 v[86:87], v15 offset:19232
    v_mfma_f32_16x16x32_bf16 v[184:187], v[92:95], a[184:187], v[184:187]
    v_subrev_u32 v13, 24608, v13
    v_subrev_u32 v14, 24608, v14
    v_mfma_f32_16x16x32_bf16 v[172:175], v[92:95], a[180:183], v[172:175]
    v_mfma_f32_16x16x32_bf16 v[168:171], v[92:95], a[176:179], v[168:171]
    v_subrev_u32 v15, 24608, v15
    v_mfma_f32_16x16x32_bf16 v[192:195], v[72:75], a[176:179], v[192:195]
    buffer_load_dwordx4 v9, s[20:23], s58 offen offset:1024 sc1 lds
    v_mfma_f32_16x16x32_bf16 v[196:199], v[72:75], a[180:183], v[196:199]
    v_mfma_f32_16x16x32_bf16 v[208:211], v[72:75], a[184:187], v[208:211]
    v_mfma_f32_16x16x32_bf16 v[212:215], v[72:75], a[188:191], v[212:215]
    s_waitcnt vmcnt(9)
    v_cmp_lt_u32 vcc, v23, v5
    s_nop 4
    s_cbranch_vccnz L_spin_503
L_back_504:
    s_waitcnt lgkmcnt(0)
    s_barrier
    v_mfma_f32_16x16x32_bf16 v[220:223], v[76:79], a[188:191], v[220:223]
    ds_read_b64_tr_b16 v[88:89], v13 offset:0
    ds_read_b64_tr_b16 v[90:91], v13 offset:768
    v_mfma_f32_16x16x32_bf16 v[216:219], v[76:79], a[184:187], v[216:219]
    buffer_load_dwordx4 v10, s[20:23], s58 offen offset:2048 sc1 lds
    v_mfma_f32_16x16x32_bf16 v[204:207], v[76:79], a[180:183], v[204:207]
    v_mfma_f32_16x16x32_bf16 v[200:203], v[76:79], a[176:179], v[200:203]
    s_add_u32 s11, s97, 0
    s_lshr_b32 s8, s53, 1
    v_mfma_f32_16x16x32_bf16 v[224:227], v[80:83], a[176:179], v[224:227]
    ds_read_b64_tr_b16 v[92:93], v13 offset:12320
    ds_read_b64_tr_b16 v[94:95], v13 offset:13088
    v_mfma_f32_16x16x32_bf16 v[228:231], v[80:83], a[180:183], v[228:231]
    s_cmp_ge_i32 s10, 0
    s_cselect_b32 s11, s11, 2146435072
    s_add_u32 m0, s13, 113856
    v_mfma_f32_16x16x32_bf16 v[240:243], v[80:83], a[184:187], v[240:243]
    buffer_load_dwordx4 v1, s[32:35], s11 offen sc1 lds
    v_mfma_f32_16x16x32_bf16 v[244:247], v[80:83], a[188:191], v[244:247]
    s_lshl_b32 s8, s8, 7
    s_sub_u32 s8, s8, 64
    v_mfma_f32_16x16x32_bf16 v[252:255], v[84:87], a[188:191], v[252:255]
    ds_read_b64_tr_b16 v[72:73], v14 offset:0
    ds_read_b64_tr_b16 v[74:75], v14 offset:768
    v_mfma_f32_16x16x32_bf16 v[248:251], v[84:87], a[184:187], v[248:251]
    ds_read_b64_tr_b16 v[76:77], v14 offset:12320
    ds_read_b64_tr_b16 v[78:79], v14 offset:13088
    v_mfma_f32_16x16x32_bf16 v[236:239], v[84:87], a[180:183], v[236:239]
    buffer_load_dwordx4 v1, s[32:35], s11 offen offset:1024 sc1 lds
    v_mfma_f32_16x16x32_bf16 v[232:235], v[84:87], a[176:179], v[232:235]
    s_lshl_b32 s9, s48, 7
    s_waitcnt lgkmcnt(2)
    v_mfma_f32_16x16x32_bf16 v[160:163], v[88:91], a[192:195], v[160:163]
    ds_read_b64_tr_b16 v[80:81], v15 offset:0
    ds_read_b64_tr_b16 v[82:83], v15 offset:768
    v_mfma_f32_16x16x32_bf16 v[164:167], v[88:91], a[196:199], v[164:167]
    v_mov_b32 v11, s8
    v_mov_b32 v12, s9
    v_mfma_f32_16x16x32_bf16 v[176:179], v[88:91], a[200:203], v[176:179]
    buffer_load_dwordx4 v1, s[32:35], s11 offen offset:2048 sc1 lds
    v_mfma_f32_16x16x32_bf16 v[180:183], v[88:91], a[204:207], v[180:183]
    ds_write_b64 v63, v[60:61]
    v_mfma_f32_16x16x32_bf16 v[188:191], v[92:95], a[204:207], v[188:191]
    ds_read_b64_tr_b16 v[84:85], v15 offset:12320
    ds_read_b64_tr_b16 v[86:87], v15 offset:13088
    v_mfma_f32_16x16x32_bf16 v[184:187], v[92:95], a[200:203], v[184:187]
    v_cmp_gt_u32 vcc, 16, v0
    s_nop 1
    v_cndmask_b32 v11, v11, v12, vcc
    v_mfma_f32_16x16x32_bf16 v[172:175], v[92:95], a[196:199], v[172:175]
    buffer_load_dwordx4 v1, s[32:35], s11 offen offset:3072 sc1 lds
    v_mfma_f32_16x16x32_bf16 v[168:171], v[92:95], a[192:195], v[168:171]
    s_add_u32 s11, s97, 4096
    v_mfma_f32_16x16x32_bf16 v[192:195], v[72:75], a[192:195], v[192:195]
    ds_read_b64_tr_b16 v[88:89], v13 offset:6144
    ds_read_b64_tr_b16 v[90:91], v13 offset:6912
    v_mfma_f32_16x16x32_bf16 v[196:199], v[72:75], a[196:199], v[196:199]
    s_cmp_ge_i32 s10, -2
    s_cselect_b32 s11, s11, 2146435072
    s_add_u32 m0, s13, 118016
    v_mfma_f32_16x16x32_bf16 v[208:211], v[72:75], a[200:203], v[208:211]
    buffer_load_dwordx4 v1, s[32:35], s11 offen sc1 lds
    v_mfma_f32_16x16x32_bf16 v[212:215], v[72:75], a[204:207], v[212:215]
    v_lshl_add_u32 v11, v0, 2, v11
    s_waitcnt lgkmcnt(0)
    v_mfma_f32_16x16x32_bf16 v[220:223], v[76:79], a[204:207], v[220:223]
    ds_read_b64_tr_b16 v[92:93], v13 offset:18464
    ds_read_b64_tr_b16 v[94:95], v13 offset:19232
    v_mfma_f32_16x16x32_bf16 v[216:219], v[76:79], a[200:203], v[216:219]
    ds_write_b64 v63, v[60:61] offset:8
    v_add_u32 v11, 16842752, v11
    v_mfma_f32_16x16x32_bf16 v[204:207], v[76:79], a[196:199], v[204:207]
    buffer_load_dwordx4 v1, s[32:35], s11 offen offset:1024 sc1 lds
    v_mfma_f32_16x16x32_bf16 v[200:203], v[76:79], a[192:195], v[200:203]
    s_cmp_eq_u32 s3, 0
    s_cselect_b32 s8, 32, 0
    v_mfma_f32_16x16x32_bf16 v[224:227], v[80:83], a[192:195], v[224:227]
    ds_read_b64_tr_b16 v[72:73], v14 offset:6144
    ds_read_b64_tr_b16 v[74:75], v14 offset:6912
    v_mfma_f32_16x16x32_bf16 v[228:231], v[80:83], a[196:199], v[228:231]
    v_cmp_gt_u32 vcc, s8, v0
    s_nop 1
    v_cndmask_b32 v11, v70, v11, vcc
    v_cndmask_b32 v12, 0, 1, vcc
    v_mfma_f32_16x16x32_bf16 v[240:243], v[80:83], a[200:203], v[240:243]
    buffer_load_dwordx4 v1, s[32:35], s11 offen offset:2048 sc1 lds
    v_mfma_f32_16x16x32_bf16 v[244:247], v[80:83], a[204:207], v[244:247]
    v_mfma_f32_16x16x32_bf16 v[252:255], v[84:87], a[204:207], v[252:255]
    ds_read_b64_tr_b16 v[76:77], v14 offset:18464
    ds_read_b64_tr_b16 v[78:79], v14 offset:19232
    v_mfma_f32_16x16x32_bf16 v[248:251], v[84:87], a[200:203], v[248:251]
    buffer_load_dwordx4 v1, s[32:35], s11 offen offset:3072 sc1 lds
    v_mfma_f32_16x16x32_bf16 v[236:239], v[84:87], a[196:199], v[236:239]
    v_mfma_f32_16x16x32_bf16 v[232:235], v[84:87], a[192:195], v[232:235]
    s_add_u32 s11, s97, 8192
    v_mfma_f32_16x16x32_bf16 v[160:163], v[88:91], a[208:211], v[160:163]
    ds_read_b64_tr_b16 v[80:81], v15 offset:6144
    ds_read_b64_tr_b16 v[82:83], v15 offset:6912
    v_mfma_f32_16x16x32_bf16 v[164:167], v[88:91], a[212:215], v[164:167]
    s_cmp_ge_i32 s10, -4
    s_cselect_b32 s11, s11, 2146435072
    s_add_u32 m0, s13, 122176
    v_mfma_f32_16x16x32_bf16 v[176:179], v[88:91], a[216:219], v[176:179]
    buffer_load_dwordx4 v1, s[32:35], s11 offen sc1 lds
    v_mfma_f32_16x16x32_bf16 v[180:183], v[88:91], a[220:223], v[180:183]
    s_waitcnt lgkmcnt(0)
    v_mfma_f32_16x16x32_bf16 v[188:191], v[92:95], a[220:223], v[188:191]
    ds_read_b64_tr_b16 v[84:85], v15 offset:18464
    ds_read_b64_tr_b16 v[86:87], v15 offset:19232
    v_mfma_f32_16x16x32_bf16 v[184:187], v[92:95], a[216:219], v[184:187]
    buffer_load_dword v23, v11, s[32:35], 0 offen sc1
    v_mfma_f32_16x16x32_bf16 v[172:175], v[92:95], a[212:215], v[172:175]
    buffer_load_dwordx4 v1, s[32:35], s11 offen offset:1024 sc1 lds
    v_mfma_f32_16x16x32_bf16 v[168:171], v[92:95], a[208:211], v[168:171]
    v_subrev_u32 v13, 24608, v13
    v_mfma_f32_16x16x32_bf16 v[192:195], v[72:75], a[208:211], v[192:195]
    v_subrev_u32 v14, 24608, v14
    v_subrev_u32 v15, 24608, v15
    v_mfma_f32_16x16x32_bf16 v[196:199], v[72:75], a[212:215], v[196:199]
    v_mfma_f32_16x16x32_bf16 v[208:211], v[72:75], a[216:219], v[208:211]
    buffer_load_dwordx4 v1, s[32:35], s11 offen offset:2048 sc1 lds
    v_mfma_f32_16x16x32_bf16 v[212:215], v[72:75], a[220:223], v[212:215]
    s_waitcnt vmcnt(12) lgkmcnt(0)
    s_barrier
    v_mfma_f32_16x16x32_bf16 v[220:223], v[76:79], a[220:223], v[220:223]
    ds_read_b64_tr_b16 v[88:89], v13 offset:0
    ds_read_b64_tr_b16 v[90:91], v13 offset:768
    v_mfma_f32_16x16x32_bf16 v[216:219], v[76:79], a[216:219], v[216:219]
    v_mfma_f32_16x16x32_bf16 v[204:207], v[76:79], a[212:215], v[204:207]
    buffer_load_dwordx4 v1, s[32:35], s11 offen offset:3072 sc1 lds
    v_mfma_f32_16x16x32_bf16 v[200:203], v[76:79], a[208:211], v[200:203]
    v_mfma_f32_16x16x32_bf16 v[224:227], v[80:83], a[208:211], v[224:227]
    ds_read_b64_tr_b16 v[92:93], v13 offset:12320
    ds_read_b64_tr_b16 v[94:95], v13 offset:13088
    v_mfma_f32_16x16x32_bf16 v[228:231], v[80:83], a[212:215], v[228:231]
    v_mfma_f32_16x16x32_bf16 v[240:243], v[80:83], a[216:219], v[240:243]
    v_mfma_f32_16x16x32_bf16 v[244:247], v[80:83], a[220:223], v[244:247]
    v_mfma_f32_16x16x32_bf16 v[252:255], v[84:87], a[220:223], v[252:255]
    ds_read_b64_tr_b16 v[72:73], v14 offset:0
    ds_read_b64_tr_b16 v[74:75], v14 offset:768
    v_mfma_f32_16x16x32_bf16 v[248:251], v[84:87], a[216:219], v[248:251]
    ds_read_b64_tr_b16 v[76:77], v14 offset:12320
    ds_read_b64_tr_b16 v[78:79], v14 offset:13088
    v_mfma_f32_16x16x32_bf16 v[236:239], v[84:87], a[212:215], v[236:239]
    v_mfma_f32_16x16x32_bf16 v[232:235], v[84:87], a[208:211], v[232:235]
    s_waitcnt lgkmcnt(2)
    v_mfma_f32_16x16x32_bf16 v[160:163], v[88:91], a[224:227], v[160:163]
    ds_read_b64_tr_b16 v[80:81], v15 offset:0
    ds_read_b64_tr_b16 v[82:83], v15 offset:768
    v_mfma_f32_16x16x32_bf16 v[164:167], v[88:91], a[228:231], v[164:167]
    v_mfma_f32_16x16x32_bf16 v[176:179], v[88:91], a[232:235], v[176:179]
    v_mfma_f32_16x16x32_bf16 v[180:183], v[88:91], a[236:239], v[180:183]
    v_mfma_f32_16x16x32_bf16 v[188:191], v[92:95], a[236:239], v[188:191]
    ds_read_b64_tr_b16 v[84:85], v15 offset:12320
    ds_read_b64_tr_b16 v[86:87], v15 offset:13088
    v_mfma_f32_16x16x32_bf16 v[184:187], v[92:95], a[232:235], v[184:187]
    v_mfma_f32_16x16x32_bf16 v[172:175], v[92:95], a[228:231], v[172:175]
    v_mfma_f32_16x16x32_bf16 v[168:171], v[92:95], a[224:227], v[168:171]
    v_mfma_f32_16x16x32_bf16 v[192:195], v[72:75], a[224:227], v[192:195]
    ds_read_b64_tr_b16 v[88:89], v13 offset:6144
    ds_read_b64_tr_b16 v[90:91], v13 offset:6912
    v_mfma_f32_16x16x32_bf16 v[196:199], v[72:75], a[228:231], v[196:199]
    v_mfma_f32_16x16x32_bf16 v[208:211], v[72:75], a[232:235], v[208:211]
    v_mfma_f32_16x16x32_bf16 v[212:215], v[72:75], a[236:239], v[212:215]
    s_waitcnt lgkmcnt(0)
    v_mfma_f32_16x16x32_bf16 v[220:223], v[76:79], a[236:239], v[220:223]
    ds_read_b64_tr_b16 v[92:93], v13 offset:18464
    ds_read_b64_tr_b16 v[94:95], v13 offset:19232
    v_mfma_f32_16x16x32_bf16 v[216:219], v[76:79], a[232:235], v[216:219]
    v_mfma_f32_16x16x32_bf16 v[204:207], v[76:79], a[228:231], v[204:207]
    v_mfma_f32_16x16x32_bf16 v[200:203], v[76:79], a[224:227], v[200:203]
    v_mfma_f32_16x16x32_bf16 v[224:227], v[80:83], a[224:227], v[224:227]
    ds_read_b64_tr_b16 v[72:73], v14 offset:6144
    ds_read_b64_tr_b16 v[74:75], v14 offset:6912
    v_mfma_f32_16x16x32_bf16 v[228:231], v[80:83], a[228:231], v[228:231]
    v_mfma_f32_16x16x32_bf16 v[240:243], v[80:83], a[232:235], v[240:243]
    v_mfma_f32_16x16x32_bf16 v[244:247], v[80:83], a[236:239], v[244:247]
    v_mfma_f32_16x16x32_bf16 v[252:255], v[84:87], a[236:239], v[252:255]
    ds_read_b64_tr_b16 v[76:77], v14 offset:18464
    ds_read_b64_tr_b16 v[78:79], v14 offset:19232
    v_mfma_f32_16x16x32_bf16 v[248:251], v[84:87], a[232:235], v[248:251]
    v_mfma_f32_16x16x32_bf16 v[236:239], v[84:87], a[228:231], v[236:239]
    v_mfma_f32_16x16x32_bf16 v[232:235], v[84:87], a[224:227], v[232:235]
    v_mfma_f32_16x16x32_bf16 v[160:163], v[88:91], a[240:243], v[160:163]
    ds_read_b64_tr_b16 v[80:81], v15 offset:6144
    ds_read_b64_tr_b16 v[82:83], v15 offset:6912
    v_mfma_f32_16x16x32_bf16 v[164:167], v[88:91], a[244:247], v[164:167]
    v_mfma_f32_16x16x32_bf16 v[176:179], v[88:91], a[248:251], v[176:179]
    v_mfma_f32_16x16x32_bf16 v[180:183], v[88:91], a[252:255], v[180:183]
    s_waitcnt lgkmcnt(0)
    v_mfma_f32_16x16x32_bf16 v[188:191], v[92:95], a[252:255], v[188:191]
    ds_read_b64_tr_b16 v[84:85], v15 offset:18464
    ds_read_b64_tr_b16 v[86:87], v15 offset:19232
    v_mfma_f32_16x16x32_bf16 v[184:187], v[92:95], a[248:251], v[184:187]
    v_mfma_f32_16x16x32_bf16 v[172:175], v[92:95], a[244:247], v[172:175]
    v_mfma_f32_16x16x32_bf16 v[168:171], v[92:95], a[240:243], v[168:171]
    v_mfma_f32_16x16x32_bf16 v[192:195], v[72:75], a[240:243], v[192:195]
    v_mfma_f32_16x16x32_bf16 v[196:199], v[72:75], a[244:247], v[196:199]
    v_mfma_f32_16x16x32_bf16 v[208:211], v[72:75], a[248:251], v[208:211]
    v_mfma_f32_16x16x32_bf16 v[212:215], v[72:75], a[252:255], v[212:215]
    s_waitcnt vmcnt(3)
    v_cmp_lt_u32 vcc, v23, v12
    s_nop 4
    s_cbranch_vccnz L_spin_505
L_back_506:
    s_waitcnt lgkmcnt(0)
    s_barrier
    v_mfma_f32_16x16x32_bf16 v[220:223], v[76:79], a[252:255], v[220:223]
    buffer_load_dwordx4 a[120:123], v1, s[32:35], s12 offen offset:0 sc1
    v_mfma_f32_16x16x32_bf16 v[216:219], v[76:79], a[248:251], v[216:219]
    buffer_load_dwordx4 a[124:127], v1, s[32:35], s12 offen offset:1024 sc1
    v_mfma_f32_16x16x32_bf16 v[204:207], v[76:79], a[244:247], v[204:207]
    s_add_u32 s12, s46, 8
    s_lshl_b32 s12, s12, 8
    s_add_u32 s12, s12, 16777216
    v_lshlrev_b32 v70, 3, v0
    v_mfma_f32_16x16x32_bf16 v[200:203], v[76:79], a[240:243], v[200:203]
    v_mfma_f32_16x16x32_bf16 v[224:227], v[80:83], a[240:243], v[224:227]
    buffer_load_dword v30, v70, s[32:35], s12 offen sc1
    v_mfma_f32_16x16x32_bf16 v[228:231], v[80:83], a[244:247], v[228:231]
    v_mfma_f32_16x16x32_bf16 v[240:243], v[80:83], a[248:251], v[240:243]
    v_mfma_f32_16x16x32_bf16 v[244:247], v[80:83], a[252:255], v[244:247]
    v_mfma_f32_16x16x32_bf16 v[252:255], v[84:87], a[252:255], v[252:255]
    v_mfma_f32_16x16x32_bf16 v[248:251], v[84:87], a[248:251], v[248:251]
    v_mfma_f32_16x16x32_bf16 v[236:239], v[84:87], a[244:247], v[236:239]
    v_mfma_f32_16x16x32_bf16 v[232:235], v[84:87], a[240:243], v[232:235]
    v_pk_mul_f32 v[52:53], v[160:161], s[4:5]
    v_pk_mul_f32 v[54:55], v[162:163], s[4:5]
    v_pk_mul_f32 v[56:57], v[164:165], s[4:5]
    v_pk_mul_f32 v[58:59], v[166:167], s[4:5]
    v_exp_f32 v52, v52
    v_exp_f32 v53, v53
    v_exp_f32 v54, v54
    v_exp_f32 v55, v55
    v_exp_f32 v56, v56
    v_exp_f32 v57, v57
    v_exp_f32 v58, v58
    v_exp_f32 v59, v59
    v_pk_mul_f32 v[160:161], v[160:161], v[168:169]
    v_pk_mul_f32 v[162:163], v[162:163], v[170:171]
    v_pk_mul_f32 v[164:165], v[164:165], v[172:173]
    v_pk_mul_f32 v[166:167], v[166:167], v[174:175]
    v_pk_add_f32 v[52:53], v[52:53], 1.0 op_sel_hi:[1,0]
    v_pk_add_f32 v[54:55], v[54:55], 1.0 op_sel_hi:[1,0]
    v_pk_add_f32 v[56:57], v[56:57], 1.0 op_sel_hi:[1,0]
    v_pk_add_f32 v[58:59], v[58:59], 1.0 op_sel_hi:[1,0]
    v_rcp_f32 v52, v52
    v_rcp_f32 v53, v53
    v_rcp_f32 v54, v54
    v_rcp_f32 v55, v55
    v_rcp_f32 v56, v56
    v_rcp_f32 v57, v57
    v_rcp_f32 v58, v58
    v_rcp_f32 v59, v59
    v_pk_mul_f32 v[160:161], v[160:161], v[52:53]
    v_pk_mul_f32 v[162:163], v[162:163], v[54:55]
    v_pk_mul_f32 v[164:165], v[164:165], v[56:57]
    v_pk_mul_f32 v[166:167], v[166:167], v[58:59]
    v_cvt_pk_bf16_f32 v40, v160, v161
    v_cvt_pk_bf16_f32 v41, v162, v163
    v_cvt_pk_bf16_f32 v42, v164, v165
    v_cvt_pk_bf16_f32 v43, v166, v167
    v_pk_mul_f32 v[52:53], v[176:177], s[4:5]
    v_pk_mul_f32 v[54:55], v[178:179], s[4:5]
    v_permlane32_swap_b32 v40, v42
    v_permlane32_swap_b32 v41, v43
    buffer_store_dwordx4 v[40:43], v62, s[32:35], s98 offen offset:0 sc1
    v_pk_mul_f32 v[56:57], v[180:181], s[4:5]
    v_pk_mul_f32 v[58:59], v[182:183], s[4:5]
    v_exp_f32 v52, v52
    v_exp_f32 v53, v53
    v_exp_f32 v54, v54
    v_exp_f32 v55, v55
    v_exp_f32 v56, v56
    v_exp_f32 v57, v57
    v_exp_f32 v58, v58
    v_exp_f32 v59, v59
    v_pk_mul_f32 v[176:177], v[176:177], v[184:185]
    v_pk_mul_f32 v[178:179], v[178:179], v[186:187]
    v_pk_mul_f32 v[180:181], v[180:181], v[188:189]
    v_pk_mul_f32 v[182:183], v[182:183], v[190:191]
    v_pk_add_f32 v[52:53], v[52:53], 1.0 op_sel_hi:[1,0]
    v_pk_add_f32 v[54:55], v[54:55], 1.0 op_sel_hi:[1,0]
    v_pk_add_f32 v[56:57], v[56:57], 1.0 op_sel_hi:[1,0]
    v_pk_add_f32 v[58:59], v[58:59], 1.0 op_sel_hi:[1,0]
    v_rcp_f32 v52, v52
    v_rcp_f32 v53, v53
    v_rcp_f32 v54, v54
    v_rcp_f32 v55, v55
    v_rcp_f32 v56, v56
    v_rcp_f32 v57, v57
    v_rcp_f32 v58, v58
    v_rcp_f32 v59, v59
    v_pk_mul_f32 v[176:177], v[176:177], v[52:53]
    v_pk_mul_f32 v[178:179], v[178:179], v[54:55]
    v_pk_mul_f32 v[180:181], v[180:181], v[56:57]
    v_pk_mul_f32 v[182:183], v[182:183], v[58:59]
    v_cvt_pk_bf16_f32 v44, v176, v177
    v_cvt_pk_bf16_f32 v45, v178, v179
    v_cvt_pk_bf16_f32 v46, v180, v181
    v_cvt_pk_bf16_f32 v47, v182, v183
    v_pk_mul_f32 v[52:53], v[192:193], s[4:5]
    v_pk_mul_f32 v[54:55], v[194:195], s[4:5]
    s_waitcnt vmcnt(4)
    s_barrier
    v_permlane32_swap_b32 v44, v46
    ds_read_b128 a[80:83], v28 offset:0
    ds_read_b128 a[112:115], v28 offset:16640
    ds_read_b128 a[84:87], v28 offset:2048
    ds_read_b128 a[0:3], v29 offset:0
    ds_read_b128 a[64:67], v29 offset:16640
    ds_read_b128 a[4:7], v16 offset:0
    ds_read_b128 a[68:71], v16 offset:16640
    ds_read_b128 a[88:91], v28 offset:4160
    ds_read_b128 a[8:11], v6 offset:0
    ds_read_b128 a[12:15], v7 offset:0
    ds_read_b128 a[92:95], v28 offset:6208
    ds_read_b128 a[16:19], v29 offset:4160
    v_permlane32_swap_b32 v45, v47
    buffer_store_dwordx4 v[44:47], v62, s[32:35], s99 offen offset:0 sc1
    v_pk_mul_f32 v[56:57], v[196:197], s[4:5]
    v_pk_mul_f32 v[58:59], v[198:199], s[4:5]
    v_exp_f32 v52, v52
    v_exp_f32 v53, v53
    v_exp_f32 v54, v54
    v_exp_f32 v55, v55
    v_exp_f32 v56, v56
    v_exp_f32 v57, v57
    v_exp_f32 v58, v58
    v_exp_f32 v59, v59
    v_pk_mul_f32 v[192:193], v[192:193], v[200:201]
    v_pk_mul_f32 v[194:195], v[194:195], v[202:203]
    v_pk_mul_f32 v[196:197], v[196:197], v[204:205]
    v_pk_mul_f32 v[198:199], v[198:199], v[206:207]
    v_pk_add_f32 v[52:53], v[52:53], 1.0 op_sel_hi:[1,0]
    v_pk_add_f32 v[54:55], v[54:55], 1.0 op_sel_hi:[1,0]
    v_pk_add_f32 v[56:57], v[56:57], 1.0 op_sel_hi:[1,0]
    v_pk_add_f32 v[58:59], v[58:59], 1.0 op_sel_hi:[1,0]
    v_rcp_f32 v52, v52
    v_rcp_f32 v53, v53
    v_rcp_f32 v54, v54
    v_rcp_f32 v55, v55
    v_rcp_f32 v56, v56
    v_rcp_f32 v57, v57
    v_rcp_f32 v58, v58
    v_rcp_f32 v59, v59
    v_pk_mul_f32 v[192:193], v[192:193], v[52:53]
    v_pk_mul_f32 v[194:195], v[194:195], v[54:55]
    v_pk_mul_f32 v[196:197], v[196:197], v[56:57]
    v_pk_mul_f32 v[198:199], v[198:199], v[58:59]
    v_cvt_pk_bf16_f32 v48, v192, v193
    v_cvt_pk_bf16_f32 v49, v194, v195
    v_cvt_pk_bf16_f32 v50, v196, v197
    v_cvt_pk_bf16_f32 v51, v198, v199
    v_pk_mul_f32 v[52:53], v[208:209], s[4:5]
    v_pk_mul_f32 v[54:55], v[210:211], s[4:5]
    v_permlane32_swap_b32 v48, v50
    v_permlane32_swap_b32 v49, v51
    buffer_store_dwordx4 v[48:51], v62, s[32:35], s98 offen offset:1024 sc1
    v_pk_mul_f32 v[56:57], v[212:213], s[4:5]
    v_pk_mul_f32 v[58:59], v[214:215], s[4:5]
    v_exp_f32 v52, v52
    v_exp_f32 v53, v53
    v_exp_f32 v54, v54
    v_exp_f32 v55, v55
    v_exp_f32 v56, v56
    v_exp_f32 v57, v57
    v_exp_f32 v58, v58
    v_exp_f32 v59, v59
    v_pk_mul_f32 v[208:209], v[208:209], v[216:217]
    v_pk_mul_f32 v[210:211], v[210:211], v[218:219]
    v_pk_mul_f32 v[212:213], v[212:213], v[220:221]
    v_pk_mul_f32 v[214:215], v[214:215], v[222:223]
    v_pk_add_f32 v[52:53], v[52:53], 1.0 op_sel_hi:[1,0]
    v_pk_add_f32 v[54:55], v[54:55], 1.0 op_sel_hi:[1,0]
    v_pk_add_f32 v[56:57], v[56:57], 1.0 op_sel_hi:[1,0]
    v_pk_add_f32 v[58:59], v[58:59], 1.0 op_sel_hi:[1,0]
    v_rcp_f32 v52, v52
    v_rcp_f32 v53, v53
    v_rcp_f32 v54, v54
    v_rcp_f32 v55, v55
    v_rcp_f32 v56, v56
    v_rcp_f32 v57, v57
    v_rcp_f32 v58, v58
    v_rcp_f32 v59, v59
    v_pk_mul_f32 v[208:209], v[208:209], v[52:53]
    v_pk_mul_f32 v[210:211], v[210:211], v[54:55]
    v_pk_mul_f32 v[212:213], v[212:213], v[56:57]
    v_pk_mul_f32 v[214:215], v[214:215], v[58:59]
    v_cvt_pk_bf16_f32 v40, v208, v209
    v_cvt_pk_bf16_f32 v41, v210, v211
    v_cvt_pk_bf16_f32 v42, v212, v213
    v_cvt_pk_bf16_f32 v43, v214, v215
    v_pk_mul_f32 v[52:53], v[224:225], s[4:5]
    v_pk_mul_f32 v[54:55], v[226:227], s[4:5]
    v_permlane32_swap_b32 v40, v42
    v_permlane32_swap_b32 v41, v43
    buffer_store_dwordx4 v[40:43], v62, s[32:35], s99 offen offset:1024 sc1
    v_pk_mul_f32 v[56:57], v[228:229], s[4:5]
    v_pk_mul_f32 v[58:59], v[230:231], s[4:5]
    v_exp_f32 v52, v52
    v_exp_f32 v53, v53
    v_exp_f32 v54, v54
    v_exp_f32 v55, v55
    v_exp_f32 v56, v56
    v_exp_f32 v57, v57
    v_exp_f32 v58, v58
    v_exp_f32 v59, v59
    v_pk_mul_f32 v[224:225], v[224:225], v[232:233]
    v_pk_mul_f32 v[226:227], v[226:227], v[234:235]
    v_pk_mul_f32 v[228:229], v[228:229], v[236:237]
    v_pk_mul_f32 v[230:231], v[230:231], v[238:239]
    v_pk_add_f32 v[52:53], v[52:53], 1.0 op_sel_hi:[1,0]
    v_pk_add_f32 v[54:55], v[54:55], 1.0 op_sel_hi:[1,0]
    v_pk_add_f32 v[56:57], v[56:57], 1.0 op_sel_hi:[1,0]
    v_pk_add_f32 v[58:59], v[58:59], 1.0 op_sel_hi:[1,0]
    v_rcp_f32 v52, v52
    v_rcp_f32 v53, v53
    v_rcp_f32 v54, v54
    v_rcp_f32 v55, v55
    v_rcp_f32 v56, v56
    v_rcp_f32 v57, v57
    v_rcp_f32 v58, v58
    v_rcp_f32 v59, v59
    v_pk_mul_f32 v[224:225], v[224:225], v[52:53]
    v_pk_mul_f32 v[226:227], v[226:227], v[54:55]
    v_pk_mul_f32 v[228:229], v[228:229], v[56:57]
    v_pk_mul_f32 v[230:231], v[230:231], v[58:59]
    v_cvt_pk_bf16_f32 v44, v224, v225
    v_cvt_pk_bf16_f32 v45, v226, v227
    v_cvt_pk_bf16_f32 v46, v228, v229
    v_cvt_pk_bf16_f32 v47, v230, v231
    v_pk_mul_f32 v[52:53], v[240:241], s[4:5]
    v_pk_mul_f32 v[54:55], v[242:243], s[4:5]
    v_permlane32_swap_b32 v44, v46
    v_permlane32_swap_b32 v45, v47
    buffer_store_dwordx4 v[44:47], v62, s[32:35], s98 offen offset:2048 sc1
    v_pk_mul_f32 v[56:57], v[244:245], s[4:5]
    v_pk_mul_f32 v[58:59], v[246:247], s[4:5]
    v_exp_f32 v52, v52
    v_exp_f32 v53, v53
    v_exp_f32 v54, v54
    v_exp_f32 v55, v55
    v_exp_f32 v56, v56
    v_exp_f32 v57, v57
    v_exp_f32 v58, v58
    v_exp_f32 v59, v59
    v_pk_mul_f32 v[240:241], v[240:241], v[248:249]
    v_pk_mul_f32 v[242:243], v[242:243], v[250:251]
    v_pk_mul_f32 v[244:245], v[244:245], v[252:253]
    v_pk_mul_f32 v[246:247], v[246:247], v[254:255]
    v_pk_add_f32 v[52:53], v[52:53], 1.0 op_sel_hi:[1,0]
    v_pk_add_f32 v[54:55], v[54:55], 1.0 op_sel_hi:[1,0]
    v_pk_add_f32 v[56:57], v[56:57], 1.0 op_sel_hi:[1,0]
    v_pk_add_f32 v[58:59], v[58:59], 1.0 op_sel_hi:[1,0]
    v_rcp_f32 v52, v52
    v_rcp_f32 v53, v53
    v_rcp_f32 v54, v54
    v_rcp_f32 v55, v55
    v_rcp_f32 v56, v56
    v_rcp_f32 v57, v57
    v_rcp_f32 v58, v58
    v_rcp_f32 v59, v59
    v_pk_mul_f32 v[240:241], v[240:241], v[52:53]
    v_pk_mul_f32 v[242:243], v[242:243], v[54:55]
    v_pk_mul_f32 v[244:245], v[244:245], v[56:57]
    v_pk_mul_f32 v[246:247], v[246:247], v[58:59]
    v_cvt_pk_bf16_f32 v48, v240, v241
    v_cvt_pk_bf16_f32 v49, v242, v243
    v_cvt_pk_bf16_f32 v50, v244, v245
    v_cvt_pk_bf16_f32 v51, v246, v247
    s_nop 0
    v_permlane32_swap_b32 v48, v50
    v_permlane32_swap_b32 v49, v51
    buffer_store_dwordx4 v[48:51], v62, s[32:35], s99 offen offset:2048 sc1
    s_nop 1
L_attn:
    ds_read_b128 a[20:23], v16 offset:4160
    ds_read_b128 a[96:99], v28 offset:8320
    ds_read_b128 a[24:27], v6 offset:4160
    ds_read_b128 a[28:31], v7 offset:4160
    ds_read_b128 a[100:103], v28 offset:10368
    ds_read_b128 a[32:35], v29 offset:8320
    ds_read_b128 a[36:39], v16 offset:8320
    ds_read_b128 a[104:107], v28 offset:12480
    ds_read_b128 a[40:43], v6 offset:8320
    ds_read_b128 a[44:47], v7 offset:8320
    ds_read_b128 a[108:111], v28 offset:14528
    ds_read_b128 a[48:51], v29 offset:12480
    ds_read_b128 a[52:55], v16 offset:12480
    ds_read_b128 a[116:119], v28 offset:18688
    ds_read_b128 a[56:59], v6 offset:12480
    ds_read_b128 a[60:63], v7 offset:12480
    ds_read_b128 a[72:75], v6 offset:16640
    ds_read_b128 a[76:79], v7 offset:16640
    s_add_u32 s57, s55, 0
    s_cmp_ge_u32 s57, 7
    s_cselect_b32 s56, 7, 0
    s_sub_u32 s57, s57, s56
    s_mul_i32 s56, s3, 7
    s_add_u32 s57, s57, s56
    s_lshl_b32 s56, s57, 12
    s_add_u32 s100, s100, 32768
    s_add_u32 m0, s61, 49152
    s_waitcnt vmcnt(8) lgkmcnt(15)
    v_mfma_f32_32x32x16_bf16 v[96:111], a[80:83], a[120:123], 0
    buffer_load_dwordx4 v24, s[24:27], s100 offen sc1 lds
    v_mfma_f32_32x32x16_bf16 v[112:127], a[112:115], a[120:123], 0
    s_add_u32 s12, s46, 8
    s_mul_i32 s12, s12, 144
    s_add_u32 s12, s12, s49
    s_add_u32 s12, s12, 112
    s_lshl_b32 s12, s12, 10
    s_add_u32 s98, s12, 6291456
    s_add_u32 s99, s98, 147456
    s_nop 4
    v_cndmask_b32 v96, v112, v96, s[64:65]
    v_cndmask_b32 v97, v113, v97, s[66:67]
    buffer_load_dwordx4 v25, s[24:27], s100 offen offset:1024 sc1 lds
    v_cndmask_b32 v98, v114, v98, s[68:69]
    v_cndmask_b32 v99, v115, v99, s[70:71]
    v_cndmask_b32 v100, v116, v100, s[72:73]
    v_cndmask_b32 v101, v117, v101, s[74:75]
    v_cndmask_b32 v102, v118, v102, s[76:77]
    v_cndmask_b32 v103, v119, v103, s[78:79]
    v_cndmask_b32 v104, v120, v104, s[80:81]
    v_cndmask_b32 v105, v121, v105, s[82:83]
    v_cndmask_b32 v106, v122, v106, s[84:85]
    v_cndmask_b32 v107, v123, v107, s[86:87]
    v_cndmask_b32 v108, v124, v108, s[88:89]
    v_cndmask_b32 v109, v125, v109, s[90:91]
    v_cndmask_b32 v110, v126, v110, s[92:93]
    v_cndmask_b32 v111, v127, v111, s[94:95]
    v_mfma_f32_32x32x16_bf16 v[128:143], a[84:87], a[120:123], 0
    buffer_load_dwordx4 v26, s[24:27], s100 offen offset:2048 sc1 lds
    v_exp_f32 v96, v96
    v_exp_f32 v97, v97
    v_exp_f32 v98, v98
    v_exp_f32 v99, v99
    v_exp_f32 v100, v100
    buffer_load_dwordx4 v27, s[24:27], s100 offen offset:3072 sc1 lds
    s_add_u32 s101, s55, 2
    s_cmp_ge_u32 s101, 7
    s_cselect_b32 s100, 7, 0
    s_sub_u32 s101, s101, s100
    s_mul_i32 s100, s3, 7
    s_add_u32 s101, s101, s100
    s_lshl_b32 s100, s101, 16
    s_add_u32 m0, s61, 65536
    v_exp_f32 v101, v101
    v_exp_f32 v102, v102
    v_exp_f32 v103, v103
    buffer_load_dwordx4 v24, s[24:27], s100 offen sc1 lds
    v_exp_f32 v104, v104
    v_cvt_pk_bf16_f32 v72, v96, v97
    v_cvt_pk_bf16_f32 v73, v98, v99
    v_cvt_pk_bf16_f32 v74, v100, v101
    v_cvt_pk_bf16_f32 v75, v102, v103
    v_and_b32 v80, v72, v32
    v_and_b32 v81, v73, v33
    v_and_b32 v82, v74, v34
    v_and_b32 v83, v75, v35
    v_bfi_b32 v88, v32, 0, v72
    v_bfi_b32 v89, v33, 0, v73
    v_bfi_b32 v90, v34, 0, v74
    v_bfi_b32 v91, v35, 0, v75
    v_exp_f32 v105, v105
    v_exp_f32 v106, v106
    v_mfma_f32_32x32x16_bf16 v[144:159], a[0:3], v[80:83], 0
    buffer_load_dwordx4 v25, s[24:27], s100 offen offset:1024 sc1 lds
    v_exp_f32 v107, v107
    v_exp_f32 v108, v108
    v_exp_f32 v109, v109
    v_mfma_f32_32x32x16_bf16 v[144:159], a[64:67], v[88:91], v[144:159]
    buffer_load_dwordx4 v26, s[24:27], s100 offen offset:2048 sc1 lds
    v_exp_f32 v110, v110
    v_exp_f32 v111, v111
    v_cvt_pk_bf16_f32 v76, v104, v105
    v_cvt_pk_bf16_f32 v77, v106, v107
    v_cvt_pk_bf16_f32 v78, v108, v109
    v_cvt_pk_bf16_f32 v79, v110, v111
    v_and_b32 v84, v76, v36
    v_and_b32 v85, v77, v37
    v_and_b32 v86, v78, v38
    v_and_b32 v87, v79, v39
    v_bfi_b32 v92, v36, 0, v76
    v_bfi_b32 v93, v37, 0, v77
    v_bfi_b32 v94, v38, 0, v78
    v_bfi_b32 v95, v39, 0, v79
    v_exp_f32 v128, v128
    v_exp_f32 v129, v129
    v_mfma_f32_32x32x16_bf16 v[144:159], a[4:7], v[84:87], v[144:159]
    buffer_load_dwordx4 v27, s[24:27], s100 offen offset:3072 sc1 lds
    s_add_u32 s100, s100, 32768
    s_add_u32 m0, s61, 81920
    v_exp_f32 v130, v130
    v_exp_f32 v131, v131
    v_mfma_f32_32x32x16_bf16 v[144:159], a[68:71], v[92:95], v[144:159]
    buffer_load_dwordx4 v24, s[24:27], s100 offen sc1 lds
    v_exp_f32 v132, v132
    v_mfma_f32_32x32x16_bf16 v[96:111], a[88:91], a[120:123], 0
    v_exp_f32 v133, v133
    v_exp_f32 v134, v134
    v_exp_f32 v135, v135
    v_exp_f32 v136, v136
    v_cvt_pk_bf16_f32 v72, v128, v129
    v_cvt_pk_bf16_f32 v73, v130, v131
    v_cvt_pk_bf16_f32 v74, v132, v133
    v_cvt_pk_bf16_f32 v75, v134, v135
    v_exp_f32 v137, v137
    v_exp_f32 v138, v138
    v_mfma_f32_32x32x16_bf16 v[144:159], a[8:11], v[72:75], v[144:159]
    buffer_load_dwordx4 v25, s[24:27], s100 offen offset:1024 sc1 lds
    buffer_load_dwordx4 v26, s[24:27], s100 offen offset:2048 sc1 lds
    v_exp_f32 v139, v139
    v_exp_f32 v140, v140
    v_exp_f32 v141, v141
    v_exp_f32 v142, v142
    v_exp_f32 v143, v143
    v_cvt_pk_bf16_f32 v76, v136, v137
    v_cvt_pk_bf16_f32 v77, v138, v139
    v_cvt_pk_bf16_f32 v78, v140, v141
    v_cvt_pk_bf16_f32 v79, v142, v143
    v_exp_f32 v96, v96
    v_exp_f32 v97, v97
    v_mfma_f32_32x32x16_bf16 v[144:159], a[12:15], v[76:79], v[144:159]
    buffer_load_dwordx4 v27, s[24:27], s100 offen offset:3072 sc1 lds
    s_add_u32 s101, s55, 3
    s_cmp_ge_u32 s101, 7
    s_cselect_b32 s100, 7, 0
    s_sub_u32 s101, s101, s100
    s_mul_i32 s100, s3, 7
    s_add_u32 s101, s101, s100
    s_lshl_b32 s100, s101, 16
    s_add_u32 m0, s61, 98304
    v_exp_f32 v98, v98
    v_exp_f32 v99, v99
    v_exp_f32 v100, v100
    v_mfma_f32_32x32x16_bf16 v[112:127], a[92:95], a[120:123], 0
    v_exp_f32 v101, v101
    v_exp_f32 v102, v102
    v_exp_f32 v103, v103
    v_exp_f32 v104, v104
    v_cvt_pk_bf16_f32 v72, v96, v97
    v_cvt_pk_bf16_f32 v73, v98, v99
    v_cvt_pk_bf16_f32 v74, v100, v101
    v_cvt_pk_bf16_f32 v75, v102, v103
    v_exp_f32 v105, v105
    v_exp_f32 v106, v106
    v_mfma_f32_32x32x16_bf16 v[144:159], a[16:19], v[72:75], v[144:159]
    v_exp_f32 v107, v107
    v_exp_f32 v108, v108
    v_exp_f32 v109, v109
    v_exp_f32 v110, v110
    v_exp_f32 v111, v111
    v_cvt_pk_bf16_f32 v76, v104, v105
    v_cvt_pk_bf16_f32 v77, v106, v107
    v_cvt_pk_bf16_f32 v78, v108, v109
    v_cvt_pk_bf16_f32 v79, v110, v111
    s_waitcnt vmcnt(12)
    buffer_store_dword v20, v19, s[32:35], 0 offen sc1
    s_lshr_b32 s8, s53, 1
    s_lshl_b32 s8, s8, 2
    s_add_u32 s8, s8, s3
    s_lshl_b32 s8, s8, 1
    s_and_b32 s9, s53, 1
    s_add_u32 s8, s8, s9
    s_lshl_b32 s8, s8, 7
    s_add_u32 s8, s8, 16908288
    v_cmp_gt_u32 vcc, 8, v0
    v_lshl_add_u32 v21, v0, 2, s8
    v_mov_b32 v23, 2146435072
    v_cndmask_b32 v21, v23, v21, vcc
    v_cndmask_b32 v22, 0, 1, vcc
    s_and_b32 s12, s3, 1
    s_lshl_b32 s12, s12, 8
    v_xor_b32 v70, s12, v70
    s_lshl_b32 s13, s53, 9
    s_add_u32 s13, s13, 16777220
    v_exp_f32 v112, v112
    v_exp_f32 v113, v113
    v_mfma_f32_32x32x16_bf16 v[144:159], a[20:23], v[76:79], v[144:159]
    buffer_load_dword v8, v70, s[32:35], s13 offen sc1
    v_exp_f32 v114, v114
    v_exp_f32 v115, v115
    v_exp_f32 v116, v116
    v_mfma_f32_32x32x16_bf16 v[128:143], a[96:99], a[120:123], 0
    v_exp_f32 v117, v117
    v_exp_f32 v118, v118
    v_exp_f32 v119, v119
    v_exp_f32 v120, v120
    v_cvt_pk_bf16_f32 v72, v112, v113
    v_cvt_pk_bf16_f32 v73, v114, v115
    v_cvt_pk_bf16_f32 v74, v116, v117
    v_cvt_pk_bf16_f32 v75, v118, v119
    v_exp_f32 v121, v121
    v_exp_f32 v122, v122
    v_mfma_f32_32x32x16_bf16 v[144:159], a[24:27], v[72:75], v[144:159]
    v_exp_f32 v123, v123
    v_exp_f32 v124, v124
    v_exp_f32 v125, v125
    v_exp_f32 v126, v126
    v_exp_f32 v127, v127
    v_cvt_pk_bf16_f32 v76, v120, v121
    v_cvt_pk_bf16_f32 v77, v122, v123
    v_cvt_pk_bf16_f32 v78, v124, v125
    v_cvt_pk_bf16_f32 v79, v126, v127
    s_waitcnt lgkmcnt(0)
    s_barrier
    v_exp_f32 v128, v128
    v_exp_f32 v129, v129
    v_mfma_f32_32x32x16_bf16 v[144:159], a[28:31], v[76:79], v[144:159]
    ds_read_b64_tr_b16 a[144:145], v64 offset:0
    ds_read_b64_tr_b16 a[146:147], v64 offset:1024
    buffer_load_dwordx4 v24, s[24:27], s100 offen sc1 lds
    buffer_load_dwordx4 v25, s[24:27], s100 offen offset:1024 sc1 lds
    v_exp_f32 v130, v130
    v_exp_f32 v131, v131
    v_exp_f32 v132, v132
    v_mfma_f32_32x32x16_bf16 v[96:111], a[100:103], a[120:123], 0
    ds_read_b64_tr_b16 a[148:149], v65 offset:0
    ds_read_b64_tr_b16 a[150:151], v65 offset:1024
    buffer_load_dwordx4 v26, s[24:27], s100 offen offset:2048 sc1 lds
    v_exp_f32 v133, v133
    v_exp_f32 v134, v134
    v_exp_f32 v135, v135
    v_exp_f32 v136, v136
    v_cvt_pk_bf16_f32 v72, v128, v129
    v_cvt_pk_bf16_f32 v73, v130, v131
    v_cvt_pk_bf16_f32 v74, v132, v133
    v_cvt_pk_bf16_f32 v75, v134, v135
    v_exp_f32 v137, v137
    v_exp_f32 v138, v138
    v_mfma_f32_32x32x16_bf16 v[144:159], a[32:35], v[72:75], v[144:159]
    ds_read_b64_tr_b16 a[152:153], v64 offset:2048
    ds_read_b64_tr_b16 a[154:155], v64 offset:3072
    ds_read_b64_tr_b16 a[156:157], v65 offset:2048
    ds_read_b64_tr_b16 a[158:159], v65 offset:3072
    buffer_load_dwordx4 v27, s[24:27], s100 offen offset:3072 sc1 lds
    s_add_u32 s100, s100, 32768
    s_add_u32 m0, s61, 114688
    v_exp_f32 v139, v139
    v_exp_f32 v140, v140
    v_exp_f32 v141, v141
    v_exp_f32 v142, v142
    v_exp_f32 v143, v143
    v_cvt_pk_bf16_f32 v76, v136, v137
    v_cvt_pk_bf16_f32 v77, v138, v139
    v_cvt_pk_bf16_f32 v78, v140, v141
    v_cvt_pk_bf16_f32 v79, v142, v143
    v_exp_f32 v96, v96
    v_exp_f32 v97, v97
    v_mfma_f32_32x32x16_bf16 v[144:159], a[36:39], v[76:79], v[144:159]
    ds_read_b64_tr_b16 a[160:161], v64 offset:16384
    ds_read_b64_tr_b16 a[162:163], v64 offset:17408
    buffer_load_dwordx4 v24, s[24:27], s100 offen sc1 lds
    buffer_load_dwordx4 v25, s[24:27], s100 offen offset:1024 sc1 lds
    v_exp_f32 v98, v98
    v_exp_f32 v99, v99
    v_exp_f32 v100, v100
    v_mfma_f32_32x32x16_bf16 v[112:127], a[104:107], a[120:123], 0
    ds_read_b64_tr_b16 a[164:165], v65 offset:16384
    ds_read_b64_tr_b16 a[166:167], v65 offset:17408
    buffer_load_dwordx4 v26, s[24:27], s100 offen offset:2048 sc1 lds
    v_exp_f32 v101, v101
    v_exp_f32 v102, v102
    v_exp_f32 v103, v103
    v_exp_f32 v104, v104
    v_cvt_pk_bf16_f32 v72, v96, v97
    v_cvt_pk_bf16_f32 v73, v98, v99
    v_cvt_pk_bf16_f32 v74, v100, v101
    v_cvt_pk_bf16_f32 v75, v102, v103
    v_exp_f32 v105, v105
    v_exp_f32 v106, v106
    v_mfma_f32_32x32x16_bf16 v[144:159], a[40:43], v[72:75], v[144:159]
    ds_read_b64_tr_b16 a[168:169], v64 offset:18432
    ds_read_b64_tr_b16 a[170:171], v64 offset:19456
    ds_read_b64_tr_b16 a[172:173], v65 offset:18432
    ds_read_b64_tr_b16 a[174:175], v65 offset:19456
    buffer_load_dwordx4 v27, s[24:27], s100 offen offset:3072 sc1 lds
    s_add_u32 s101, s55, 4
    s_cmp_ge_u32 s101, 7
    s_cselect_b32 s100, 7, 0
    s_sub_u32 s101, s101, s100
    s_mul_i32 s100, s3, 7
    s_add_u32 s101, s101, s100
    s_lshl_b32 s100, s101, 16
    s_add_u32 m0, s61, 131072
    v_exp_f32 v107, v107
    v_exp_f32 v108, v108
    v_exp_f32 v109, v109
    v_exp_f32 v110, v110
    v_exp_f32 v111, v111
    v_cvt_pk_bf16_f32 v76, v104, v105
    v_cvt_pk_bf16_f32 v77, v106, v107
    v_cvt_pk_bf16_f32 v78, v108, v109
    v_cvt_pk_bf16_f32 v79, v110, v111
    v_exp_f32 v112, v112
    v_exp_f32 v113, v113
    v_mfma_f32_32x32x16_bf16 v[144:159], a[44:47], v[76:79], v[144:159]
    ds_read_b64_tr_b16 a[176:177], v64 offset:32768
    ds_read_b64_tr_b16 a[178:179], v64 offset:33792
    buffer_load_dwordx4 v24, s[24:27], s100 offen sc1 lds
    buffer_load_dwordx4 v25, s[24:27], s100 offen offset:1024 sc1 lds
    v_exp_f32 v114, v114
    v_exp_f32 v115, v115
    v_exp_f32 v116, v116
    v_mfma_f32_32x32x16_bf16 v[128:143], a[108:111], a[120:123], 0
    ds_read_b64_tr_b16 a[180:181], v65 offset:32768
    ds_read_b64_tr_b16 a[182:183], v65 offset:33792
    buffer_load_dwordx4 v26, s[24:27], s100 offen offset:2048 sc1 lds
    v_exp_f32 v117, v117
    v_exp_f32 v118, v118
    v_exp_f32 v119, v119
    v_exp_f32 v120, v120
    v_cvt_pk_bf16_f32 v72, v112, v113
    v_cvt_pk_bf16_f32 v73, v114, v115
    v_cvt_pk_bf16_f32 v74, v116, v117
    v_cvt_pk_bf16_f32 v75, v118, v119
    v_exp_f32 v121, v121
    v_exp_f32 v122, v122
    v_mfma_f32_32x32x16_bf16 v[144:159], a[48:51], v[72:75], v[144:159]
    ds_read_b64_tr_b16 a[184:185], v64 offset:34816
    ds_read_b64_tr_b16 a[186:187], v64 offset:35840
    ds_read_b64_tr_b16 a[188:189], v65 offset:34816
    ds_read_b64_tr_b16 a[190:191], v65 offset:35840
    buffer_load_dwordx4 v27, s[24:27], s100 offen offset:3072 sc1 lds
    s_add_u32 s100, s100, 32768
    s_add_u32 m0, s61, 147456
    v_exp_f32 v123, v123
    v_exp_f32 v124, v124
    v_exp_f32 v125, v125
    v_exp_f32 v126, v126
    v_exp_f32 v127, v127
    v_cvt_pk_bf16_f32 v76, v120, v121
    v_cvt_pk_bf16_f32 v77, v122, v123
    v_cvt_pk_bf16_f32 v78, v124, v125
    v_cvt_pk_bf16_f32 v79, v126, v127
    v_exp_f32 v128, v128
    v_exp_f32 v129, v129
    v_mfma_f32_32x32x16_bf16 v[144:159], a[52:55], v[76:79], v[144:159]
    s_waitcnt vmcnt(22)
    ds_read_b64_tr_b16 a[192:193], v64 offset:49152
    ds_read_b64_tr_b16 a[194:195], v64 offset:50176
    buffer_load_dwordx4 v24, s[24:27], s100 offen sc1 lds
    buffer_load_dwordx4 v25, s[24:27], s100 offen offset:1024 sc1 lds
    v_exp_f32 v130, v130
    v_exp_f32 v131, v131
    v_exp_f32 v132, v132
    v_mfma_f32_32x32x16_bf16 v[96:111], a[84:87], a[124:127], 0
    ds_read_b64_tr_b16 a[196:197], v65 offset:49152
    ds_read_b64_tr_b16 a[198:199], v65 offset:50176
    buffer_load_dwordx4 v26, s[24:27], s100 offen offset:2048 sc1 lds
    v_exp_f32 v133, v133
    v_exp_f32 v134, v134
    v_exp_f32 v135, v135
    v_exp_f32 v136, v136
    v_cvt_pk_bf16_f32 v72, v128, v129
    v_cvt_pk_bf16_f32 v73, v130, v131
    v_cvt_pk_bf16_f32 v74, v132, v133
    v_cvt_pk_bf16_f32 v75, v134, v135
    v_mfma_f32_32x32x16_bf16 v[112:127], a[116:119], a[124:127], 0
    ds_read_b64_tr_b16 a[200:201], v64 offset:51200
    ds_read_b64_tr_b16 a[202:203], v64 offset:52224
    buffer_load_dwordx4 v27, s[24:27], s100 offen offset:3072 sc1 lds
    s_add_u32 s101, s55, 5
    s_cmp_ge_u32 s101, 7
    s_cselect_b32 s100, 7, 0
    s_sub_u32 s101, s101, s100
    s_mul_i32 s100, s3, 7
    s_add_u32 s101, s101, s100
    s_lshl_b32 s100, s101, 16
    s_add_u32 m0, s61, 0
    v_exp_f32 v137, v137
    v_exp_f32 v138, v138
    v_mfma_f32_32x32x16_bf16 v[144:159], a[56:59], v[72:75], v[144:159]
    ds_read_b64_tr_b16 a[204:205], v65 offset:51200
    ds_read_b64_tr_b16 a[206:207], v65 offset:52224
    s_waitcnt lgkmcnt(15)
    buffer_load_dwordx4 v24, s[24:27], s100 offen sc1 lds
    v_exp_f32 v139, v139
    v_exp_f32 v140, v140
    v_exp_f32 v141, v141
    v_exp_f32 v142, v142
    v_exp_f32 v143, v143
    v_cvt_pk_bf16_f32 v76, v136, v137
    v_cvt_pk_bf16_f32 v77, v138, v139
    v_cvt_pk_bf16_f32 v78, v140, v141
    v_cvt_pk_bf16_f32 v79, v142, v143
    v_cndmask_b32 v96, v112, v96, s[64:65]
    v_cndmask_b32 v97, v113, v97, s[66:67]
    v_mfma_f32_32x32x16_bf16 v[144:159], a[60:63], v[76:79], v[144:159]
    s_waitcnt vmcnt(23)
    ds_read_b64_tr_b16 a[208:209], v66 offset:0
    ds_read_b64_tr_b16 a[210:211], v66 offset:1024
    buffer_load_dwordx4 v25, s[24:27], s100 offen offset:1024 sc1 lds
    buffer_load_dwordx4 v26, s[24:27], s100 offen offset:2048 sc1 lds
    v_cndmask_b32 v98, v114, v98, s[68:69]
    v_cndmask_b32 v99, v115, v99, s[70:71]
    v_cndmask_b32 v100, v116, v100, s[72:73]
    v_cndmask_b32 v101, v117, v101, s[74:75]
    v_cndmask_b32 v102, v118, v102, s[76:77]
    v_cndmask_b32 v103, v119, v103, s[78:79]
    v_cndmask_b32 v104, v120, v104, s[80:81]
    v_cndmask_b32 v105, v121, v105, s[82:83]
    v_cndmask_b32 v106, v122, v106, s[84:85]
    v_cndmask_b32 v107, v123, v107, s[86:87]
    v_cndmask_b32 v108, v124, v108, s[88:89]
    v_cndmask_b32 v109, v125, v109, s[90:91]
    v_cndmask_b32 v110, v126, v110, s[92:93]
    v_cndmask_b32 v111, v127, v111, s[94:95]
    v_mfma_f32_32x32x16_bf16 v[128:143], a[88:91], a[124:127], 0
    ds_read_b64_tr_b16 a[212:213], v67 offset:0
    ds_read_b64_tr_b16 a[214:215], v67 offset:1024
    ds_read_b64_tr_b16 a[216:217], v66 offset:2048
    ds_read_b64_tr_b16 a[218:219], v66 offset:3072
    ds_read_b64_tr_b16 a[220:221], v67 offset:2048
    ds_read_b64_tr_b16 a[222:223], v67 offset:3072
    buffer_load_dwordx4 v27, s[24:27], s100 offen offset:3072 sc1 lds
    s_add_u32 s100, s100, 32768
    s_add_u32 m0, s61, 16384
    v_exp_f32 v96, v96
    buffer_load_dwordx4 v24, s[24:27], s100 offen sc1 lds
    v_exp_f32 v97, v97
    v_exp_f32 v98, v98
    v_exp_f32 v99, v99
    v_exp_f32 v100, v100
    buffer_load_dwordx4 v25, s[24:27], s100 offen offset:1024 sc1 lds
    v_exp_f32 v101, v101
    v_exp_f32 v102, v102
    v_exp_f32 v103, v103
    v_exp_f32 v104, v104
    v_cvt_pk_bf16_f32 v72, v96, v97
    v_cvt_pk_bf16_f32 v73, v98, v99
    v_cvt_pk_bf16_f32 v74, v100, v101
    v_cvt_pk_bf16_f32 v75, v102, v103
    v_and_b32 v80, v72, v32
    v_and_b32 v81, v73, v33
    v_and_b32 v82, v74, v34
    v_and_b32 v83, v75, v35
    v_bfi_b32 v88, v32, 0, v72
    v_bfi_b32 v89, v33, 0, v73
    v_bfi_b32 v90, v34, 0, v74
    v_bfi_b32 v91, v35, 0, v75
    v_exp_f32 v105, v105
    v_exp_f32 v106, v106
    v_mfma_f32_32x32x16_bf16 v[160:175], a[8:11], v[80:83], 0
    buffer_load_dwordx4 v26, s[24:27], s100 offen offset:2048 sc1 lds
    v_exp_f32 v107, v107
    v_exp_f32 v108, v108
    v_exp_f32 v109, v109
    v_mfma_f32_32x32x16_bf16 v[160:175], a[72:75], v[88:91], v[160:175]
    buffer_load_dwordx4 v27, s[24:27], s100 offen offset:3072 sc1 lds
    s_add_u32 s101, s55, 6
    s_cmp_ge_u32 s101, 7
    s_cselect_b32 s100, 7, 0
    s_sub_u32 s101, s101, s100
    s_mul_i32 s100, s3, 7
    s_add_u32 s101, s101, s100
    s_lshl_b32 s100, s101, 16
    s_add_u32 m0, s61, 32768
    v_exp_f32 v110, v110
    s_waitcnt lgkmcnt(15)
    buffer_load_dwordx4 v24, s[24:27], s100 offen sc1 lds
    v_exp_f32 v111, v111
    v_cvt_pk_bf16_f32 v76, v104, v105
    v_cvt_pk_bf16_f32 v77, v106, v107
    v_cvt_pk_bf16_f32 v78, v108, v109
    v_cvt_pk_bf16_f32 v79, v110, v111
    v_and_b32 v84, v76, v36
    v_and_b32 v85, v77, v37
    v_and_b32 v86, v78, v38
    v_and_b32 v87, v79, v39
    v_mov_b32 v31, v30
    s_waitcnt vmcnt(25)
    v_mov_b32 v9, v8
    s_nop 0
    v_permlane32_swap_b32 v30, v31
    v_permlane32_swap_b32 v8, v9
    v_bfi_b32 v92, v36, 0, v76
    v_bfi_b32 v93, v37, 0, v77
    v_bfi_b32 v94, v38, 0, v78
    v_bfi_b32 v95, v39, 0, v79
    v_exp_f32 v128, v128
    v_exp_f32 v129, v129
    v_mfma_f32_32x32x16_bf16 v[160:175], a[12:15], v[84:87], v[160:175]
    buffer_load_dword v23, v21, s[32:35], 0 offen sc1
    ds_read_b64_tr_b16 a[224:225], v66 offset:16384
    ds_read_b64_tr_b16 a[226:227], v66 offset:17408
    buffer_load_dwordx4 v25, s[24:27], s100 offen offset:1024 sc1 lds
    v_exp_f32 v130, v130
    v_exp_f32 v131, v131
    v_mfma_f32_32x32x16_bf16 v[160:175], a[76:79], v[92:95], v[160:175]
    ds_read_b64_tr_b16 a[228:229], v67 offset:16384
    ds_read_b64_tr_b16 a[230:231], v67 offset:17408
    v_subrev_u32 v56, 0x2b800000, v152
    v_cmp_lt_u32 vcc, 0x28000000, v56
    v_rcp_f32 v56, v152
    s_nop 3
    s_cbranch_vccnz L_fb_201
L_fbback_202:
    v_mul_f32 v56, v56, v30
    v_pk_mul_f32 v[144:145], v[144:145], v[56:57] op_sel_hi:[1,0]
    v_pk_mul_f32 v[146:147], v[146:147], v[56:57] op_sel_hi:[1,0]
    v_pk_mul_f32 v[148:149], v[148:149], v[56:57] op_sel_hi:[1,0]
    v_pk_mul_f32 v[150:151], v[150:151], v[56:57] op_sel_hi:[1,0]
    v_cvt_pk_bf16_f32 v144, v144, v145
    v_cvt_pk_bf16_f32 v145, v146, v147
    v_cvt_pk_bf16_f32 v146, v148, v149
    v_cvt_pk_bf16_f32 v147, v150, v151
    v_exp_f32 v132, v132
    v_mfma_f32_32x32x16_bf16 v[96:111], a[92:95], a[124:127], 0
    buffer_store_dwordx4 v[144:147], v1, s[32:35], s98 offen sc1
    v_exp_f32 v133, v133
    v_exp_f32 v134, v134
    v_exp_f32 v135, v135
    v_exp_f32 v136, v136
    v_cvt_pk_bf16_f32 v72, v128, v129
    v_cvt_pk_bf16_f32 v73, v130, v131
    v_cvt_pk_bf16_f32 v74, v132, v133
    v_cvt_pk_bf16_f32 v75, v134, v135
    v_exp_f32 v137, v137
    v_exp_f32 v138, v138
    v_mfma_f32_32x32x16_bf16 v[160:175], a[16:19], v[72:75], v[160:175]
    ds_read_b64_tr_b16 a[232:233], v66 offset:18432
    ds_read_b64_tr_b16 a[234:235], v66 offset:19456
    ds_read_b64_tr_b16 a[236:237], v67 offset:18432
    ds_read_b64_tr_b16 a[238:239], v67 offset:19456
    v_exp_f32 v139, v139
    v_exp_f32 v140, v140
    v_exp_f32 v141, v141
    v_exp_f32 v142, v142
    v_exp_f32 v143, v143
    v_cvt_pk_bf16_f32 v76, v136, v137
    v_cvt_pk_bf16_f32 v77, v138, v139
    v_cvt_pk_bf16_f32 v78, v140, v141
    v_cvt_pk_bf16_f32 v79, v142, v143
    v_exp_f32 v96, v96
    v_exp_f32 v97, v97
    v_mfma_f32_32x32x16_bf16 v[160:175], a[20:23], v[76:79], v[160:175]
    s_waitcnt vmcnt(24)
    ds_read_b64_tr_b16 a[240:241], v66 offset:32768
    ds_read_b64_tr_b16 a[242:243], v66 offset:33792
    buffer_load_dwordx4 v26, s[24:27], s100 offen offset:2048 sc1 lds
    v_exp_f32 v98, v98
    v_exp_f32 v99, v99
    v_exp_f32 v100, v100
    v_mfma_f32_32x32x16_bf16 v[112:127], a[96:99], a[124:127], 0
    ds_read_b64_tr_b16 a[244:245], v67 offset:32768
    ds_read_b64_tr_b16 a[246:247], v67 offset:33792
    buffer_load_dwordx4 v27, s[24:27], s100 offen offset:3072 sc1 lds
    s_add_u32 s100, s100, 32768
    s_add_u32 m0, s61, 49152
    v_exp_f32 v101, v101
    v_exp_f32 v102, v102
    v_exp_f32 v103, v103
    v_exp_f32 v104, v104
    v_cvt_pk_bf16_f32 v72, v96, v97
    v_cvt_pk_bf16_f32 v73, v98, v99
    v_cvt_pk_bf16_f32 v74, v100, v101
    v_cvt_pk_bf16_f32 v75, v102, v103
    v_exp_f32 v105, v105
    v_exp_f32 v106, v106
    v_mfma_f32_32x32x16_bf16 v[160:175], a[24:27], v[72:75], v[160:175]
    ds_read_b64_tr_b16 a[248:249], v66 offset:34816
    ds_read_b64_tr_b16 a[250:251], v66 offset:35840
    ds_read_b64_tr_b16 a[252:253], v67 offset:34816
    ds_read_b64_tr_b16 a[254:255], v67 offset:35840
    s_waitcnt lgkmcnt(15)
    buffer_load_dwordx4 v24, s[24:27], s100 offen sc1 lds
    v_exp_f32 v107, v107
    v_exp_f32 v108, v108
    v_exp_f32 v109, v109
    v_exp_f32 v110, v110
    v_exp_f32 v111, v111
    v_cvt_pk_bf16_f32 v76, v104, v105
    v_cvt_pk_bf16_f32 v77, v106, v107
    v_cvt_pk_bf16_f32 v78, v108, v109
    v_cvt_pk_bf16_f32 v79, v110, v111
    v_exp_f32 v112, v112
    v_exp_f32 v113, v113
    v_mfma_f32_32x32x16_bf16 v[160:175], a[28:31], v[76:79], v[160:175]
    buffer_load_dwordx4 v25, s[24:27], s100 offen offset:1024 sc1 lds
    buffer_load_dwordx4 v26, s[24:27], s100 offen offset:2048 sc1 lds
    v_exp_f32 v114, v114
    v_exp_f32 v115, v115
    v_exp_f32 v116, v116
    v_mfma_f32_32x32x16_bf16 v[128:143], a[100:103], a[124:127], 0
    v_exp_f32 v117, v117
    v_exp_f32 v118, v118
    v_exp_f32 v119, v119
    v_exp_f32 v120, v120
    v_cvt_pk_bf16_f32 v72, v112, v113
    v_cvt_pk_bf16_f32 v73, v114, v115
    v_cvt_pk_bf16_f32 v74, v116, v117
    v_cvt_pk_bf16_f32 v75, v118, v119
    v_exp_f32 v121, v121
    v_exp_f32 v122, v122
    v_mfma_f32_32x32x16_bf16 v[160:175], a[32:35], v[72:75], v[160:175]
    buffer_load_dwordx4 v27, s[24:27], s100 offen offset:3072 sc1 lds
    s_add_u32 s101, s54, 0
    s_and_b32 s101, s101, 1
    s_lshl_b32 s100, s3, 1
    s_add_u32 s101, s101, s100
    s_lshl_b32 s100, s101, 16
    s_add_u32 m0, s61, 65536
    v_exp_f32 v123, v123
    v_exp_f32 v124, v124
    v_exp_f32 v125, v125
    v_exp_f32 v126, v126
    v_exp_f32 v127, v127
    v_cvt_pk_bf16_f32 v76, v120, v121
    v_cvt_pk_bf16_f32 v77, v122, v123
    v_cvt_pk_bf16_f32 v78, v124, v125
    v_cvt_pk_bf16_f32 v79, v126, v127
    v_exp_f32 v128, v128
    v_exp_f32 v129, v129
    v_mfma_f32_32x32x16_bf16 v[160:175], a[36:39], v[76:79], v[160:175]
    buffer_load_dwordx4 v24, s[28:31], s100 offen sc1 lds
    buffer_load_dwordx4 v25, s[28:31], s100 offen offset:1024 sc1 lds
    v_exp_f32 v130, v130
    v_exp_f32 v131, v131
    v_exp_f32 v132, v132
    v_mfma_f32_32x32x16_bf16 v[96:111], a[104:107], a[124:127], 0
    v_exp_f32 v133, v133
    v_exp_f32 v134, v134
    v_exp_f32 v135, v135
    v_exp_f32 v136, v136
    v_cvt_pk_bf16_f32 v72, v128, v129
    v_cvt_pk_bf16_f32 v73, v130, v131
    v_cvt_pk_bf16_f32 v74, v132, v133
    v_cvt_pk_bf16_f32 v75, v134, v135
    v_exp_f32 v137, v137
    v_exp_f32 v138, v138
    v_mfma_f32_32x32x16_bf16 v[160:175], a[40:43], v[72:75], v[160:175]
    buffer_load_dwordx4 v26, s[28:31], s100 offen offset:2048 sc1 lds
    buffer_load_dwordx4 v27, s[28:31], s100 offen offset:3072 sc1 lds
    s_add_u32 s100, s100, 32768
    s_add_u32 m0, s61, 81920
    v_exp_f32 v139, v139
    v_exp_f32 v140, v140
    v_exp_f32 v141, v141
    v_exp_f32 v142, v142
    v_exp_f32 v143, v143
    v_cvt_pk_bf16_f32 v76, v136, v137
    v_cvt_pk_bf16_f32 v77, v138, v139
    v_cvt_pk_bf16_f32 v78, v140, v141
    v_cvt_pk_bf16_f32 v79, v142, v143
    s_waitcnt vmcnt(12)
    v_cmp_lt_u32 vcc, v23, v22
    s_nop 4
    s_cbranch_vccnz L_spin_203
L_back_204:
    v_exp_f32 v96, v96
    v_exp_f32 v97, v97
    v_mfma_f32_32x32x16_bf16 v[160:175], a[44:47], v[76:79], v[160:175]
    buffer_load_dwordx4 v[192:195], v2, s[32:35], s56 offen sc1
    buffer_load_dwordx4 v[196:199], v3, s[32:35], s56 offen sc1
    v_exp_f32 v98, v98
    v_exp_f32 v99, v99
    v_exp_f32 v100, v100
    v_mfma_f32_32x32x16_bf16 v[112:127], a[108:111], a[124:127], 0
    v_exp_f32 v101, v101
    v_exp_f32 v102, v102
    v_exp_f32 v103, v103
    v_exp_f32 v104, v104
    v_cvt_pk_bf16_f32 v72, v96, v97
    v_cvt_pk_bf16_f32 v73, v98, v99
    v_cvt_pk_bf16_f32 v74, v100, v101
    v_cvt_pk_bf16_f32 v75, v102, v103
    v_exp_f32 v105, v105
    v_exp_f32 v106, v106
    v_mfma_f32_32x32x16_bf16 v[160:175], a[48:51], v[72:75], v[160:175]
    buffer_load_dwordx4 v[200:203], v2, s[32:35], s56 offen offset:1024 sc1
    buffer_load_dwordx4 v[204:207], v3, s[32:35], s56 offen offset:1024 sc1
    v_exp_f32 v107, v107
    v_exp_f32 v108, v108
    v_exp_f32 v109, v109
    v_exp_f32 v110, v110
    v_exp_f32 v111, v111
    v_cvt_pk_bf16_f32 v76, v104, v105
    v_cvt_pk_bf16_f32 v77, v106, v107
    v_cvt_pk_bf16_f32 v78, v108, v109
    v_cvt_pk_bf16_f32 v79, v110, v111
    v_exp_f32 v112, v112
    v_exp_f32 v113, v113
    v_mfma_f32_32x32x16_bf16 v[160:175], a[52:55], v[76:79], v[160:175]
    buffer_load_dwordx4 v[208:211], v2, s[32:35], s56 offen offset:2048 sc1
    v_exp_f32 v114, v114
    v_exp_f32 v115, v115
    v_exp_f32 v116, v116
    v_mfma_f32_32x32x16_bf16 v[128:143], a[112:115], a[124:127], 0
    buffer_load_dwordx4 v[212:215], v3, s[32:35], s56 offen offset:2048 sc1
    v_exp_f32 v117, v117
    v_exp_f32 v118, v118
    v_exp_f32 v119, v119
    v_exp_f32 v120, v120
    v_cvt_pk_bf16_f32 v72, v112, v113
    v_cvt_pk_bf16_f32 v73, v114, v115
    v_cvt_pk_bf16_f32 v74, v116, v117
    v_cvt_pk_bf16_f32 v75, v118, v119
    v_exp_f32 v121, v121
    v_exp_f32 v122, v122
    v_mfma_f32_32x32x16_bf16 v[160:175], a[56:59], v[72:75], v[160:175]
    buffer_load_dwordx4 v[216:219], v2, s[32:35], s56 offen offset:3072 sc1
    v_exp_f32 v123, v123
    v_exp_f32 v124, v124
    v_exp_f32 v125, v125
    v_exp_f32 v126, v126
    v_exp_f32 v127, v127
    v_cvt_pk_bf16_f32 v76, v120, v121
    v_cvt_pk_bf16_f32 v77, v122, v123
    v_cvt_pk_bf16_f32 v78, v124, v125
    v_cvt_pk_bf16_f32 v79, v126, v127
    v_exp_f32 v128, v128
    v_exp_f32 v129, v129
    v_mfma_f32_32x32x16_bf16 v[160:175], a[60:63], v[76:79], v[160:175]
    buffer_load_dwordx4 v[220:223], v3, s[32:35], s56 offen offset:3072 sc1
    s_waitcnt lgkmcnt(8)
    buffer_load_dwordx4 v24, s[28:31], s100 offen sc1 lds
    s_add_u32 s57, s55, 1
    s_cmp_ge_u32 s57, 7
    s_cselect_b32 s56, 7, 0
    s_sub_u32 s57, s57, s56
    s_mul_i32 s56, s3, 7
    s_add_u32 s57, s57, s56
    s_lshl_b32 s56, s57, 12
    v_exp_f32 v130, v130
    v_exp_f32 v131, v131
    v_exp_f32 v132, v132
    v_exp_f32 v133, v133
    v_exp_f32 v134, v134
    v_exp_f32 v135, v135
    v_exp_f32 v136, v136
    v_cvt_pk_bf16_f32 v72, v128, v129
    v_cvt_pk_bf16_f32 v73, v130, v131
    v_cvt_pk_bf16_f32 v74, v132, v133
    v_cvt_pk_bf16_f32 v75, v134, v135
    v_exp_f32 v137, v137
    v_exp_f32 v138, v138
    v_mfma_f32_32x32x16_bf16 v[160:175], a[64:67], v[72:75], v[160:175]
    buffer_load_dwordx4 v[224:227], v2, s[32:35], s56 offen sc1
    buffer_load_dwordx4 v[228:231], v3, s[32:35], s56 offen sc1
    v_exp_f32 v139, v139
    v_exp_f32 v140, v140
    v_exp_f32 v141, v141
    v_exp_f32 v142, v142
    v_exp_f32 v143, v143
    v_cvt_pk_bf16_f32 v76, v136, v137
    v_cvt_pk_bf16_f32 v77, v138, v139
    v_cvt_pk_bf16_f32 v78, v140, v141
    v_cvt_pk_bf16_f32 v79, v142, v143
    s_nop 1
    v_mfma_f32_32x32x16_bf16 v[160:175], a[68:71], v[76:79], v[160:175]
    buffer_load_dwordx4 v[232:235], v2, s[32:35], s56 offen offset:1024 sc1
    s_waitcnt vmcnt(11)
    v_mfma_f32_32x32x16_bf16 v[96:111], a[144:147], v[192:195], 0
    s_waitcnt vmcnt(10)
    v_mfma_f32_32x32x16_bf16 v[112:127], a[144:147], v[196:199], 0
    buffer_load_dwordx4 v[236:239], v3, s[32:35], s56 offen offset:1024 sc1
    s_nop 5
    v_subrev_u32 v56, 0x2b800000, v168
    v_mfma_f32_32x32x16_bf16 v[128:143], a[148:151], v[192:195], 0
    buffer_load_dwordx4 v[240:243], v2, s[32:35], s56 offen offset:2048 sc1
    buffer_load_dwordx4 v[244:247], v3, s[32:35], s56 offen offset:2048 sc1
    buffer_load_dwordx4 v[248:251], v2, s[32:35], s56 offen offset:3072 sc1
    buffer_load_dwordx4 v[252:255], v3, s[32:35], s56 offen offset:3072 sc1
    s_add_u32 s57, s55, 2
    s_cmp_ge_u32 s57, 7
    s_cselect_b32 s56, 7, 0
    s_sub_u32 s57, s57, s56
    s_mul_i32 s56, s3, 7
    s_add_u32 s57, s57, s56
    s_lshl_b32 s56, s57, 12
    v_mfma_f32_32x32x16_bf16 v[144:159], a[148:151], v[196:199], 0
    buffer_load_dwordx4 v[192:195], v2, s[32:35], s56 offen sc1
    s_waitcnt vmcnt(15)
    v_mfma_f32_32x32x16_bf16 v[96:111], a[152:155], v[200:203], v[96:111]
    v_cmp_lt_u32 vcc, 0x28000000, v56
    v_rcp_f32 v56, v168
    s_nop 3
    s_cbranch_vccnz L_fb_205
L_fbback_206:
    s_waitcnt vmcnt(14)
    v_mfma_f32_32x32x16_bf16 v[112:127], a[152:155], v[204:207], v[112:127]
    buffer_load_dwordx4 v[196:199], v3, s[32:35], s56 offen sc1
    v_mul_f32 v56, v56, v31
    v_pk_mul_f32 v[160:161], v[160:161], v[56:57] op_sel_hi:[1,0]
    v_pk_mul_f32 v[162:163], v[162:163], v[56:57] op_sel_hi:[1,0]
    v_pk_mul_f32 v[164:165], v[164:165], v[56:57] op_sel_hi:[1,0]
    v_pk_mul_f32 v[166:167], v[166:167], v[56:57] op_sel_hi:[1,0]
    v_cvt_pk_bf16_f32 v160, v160, v161
    v_cvt_pk_bf16_f32 v161, v162, v163
    v_cvt_pk_bf16_f32 v162, v164, v165
    v_cvt_pk_bf16_f32 v163, v166, v167
    v_mfma_f32_32x32x16_bf16 v[128:143], a[156:159], v[200:203], v[128:143]
    buffer_store_dwordx4 v[160:163], v1, s[32:35], s99 offen sc1
    s_mov_b32 s10, 65536
    v_add_u32 v21, 65536, v21
    v_mfma_f32_32x32x16_bf16 v[144:159], a[156:159], v[204:207], v[144:159]
    buffer_load_dwordx4 v[200:203], v2, s[32:35], s56 offen offset:1024 sc1
    s_waitcnt vmcnt(16)
    v_mfma_f32_32x32x16_bf16 v[96:111], a[160:163], v[208:211], v[96:111]
    s_waitcnt vmcnt(15)
    v_mfma_f32_32x32x16_bf16 v[112:127], a[160:163], v[212:215], v[112:127]
    buffer_load_dwordx4 v[204:207], v3, s[32:35], s56 offen offset:1024 sc1
    v_mfma_f32_32x32x16_bf16 v[128:143], a[164:167], v[208:211], v[128:143]
    v_mfma_f32_32x32x16_bf16 v[144:159], a[164:167], v[212:215], v[144:159]
    buffer_load_dwordx4 v[208:211], v2, s[32:35], s56 offen offset:2048 sc1
    s_waitcnt vmcnt(16)
    v_mfma_f32_32x32x16_bf16 v[96:111], a[168:171], v[216:219], v[96:111]
    s_waitcnt vmcnt(15)
    v_mfma_f32_32x32x16_bf16 v[112:127], a[168:171], v[220:223], v[112:127]
    buffer_load_dwordx4 v[212:215], v3, s[32:35], s56 offen offset:2048 sc1
    v_mfma_f32_32x32x16_bf16 v[128:143], a[172:175], v[216:219], v[128:143]
    v_mfma_f32_32x32x16_bf16 v[144:159], a[172:175], v[220:223], v[144:159]
    buffer_load_dwordx4 v[216:219], v2, s[32:35], s56 offen offset:3072 sc1
    s_waitcnt vmcnt(15)
    v_mfma_f32_32x32x16_bf16 v[96:111], a[176:179], v[224:227], v[96:111]
    s_waitcnt vmcnt(14)
    v_mfma_f32_32x32x16_bf16 v[112:127], a[176:179], v[228:231], v[112:127]
    buffer_load_dwordx4 v[220:223], v3, s[32:35], s56 offen offset:3072 sc1
    s_add_u32 s57, s55, 3
    s_cmp_ge_u32 s57, 7
    s_cselect_b32 s56, 7, 0
    s_sub_u32 s57, s57, s56
    v_mfma_f32_32x32x16_bf16 v[128:143], a[180:183], v[224:227], v[128:143]
    s_mul_i32 s56, s3, 7
    s_add_u32 s57, s57, s56
    s_lshl_b32 s56, s57, 12
    v_mfma_f32_32x32x16_bf16 v[144:159], a[180:183], v[228:231], v[144:159]
    buffer_load_dwordx4 v[224:227], v2, s[32:35], s56 offen sc1
    s_waitcnt vmcnt(15)
    v_mfma_f32_32x32x16_bf16 v[96:111], a[184:187], v[232:235], v[96:111]
    s_waitcnt vmcnt(14)
    v_mfma_f32_32x32x16_bf16 v[112:127], a[184:187], v[236:239], v[112:127]
    buffer_load_dwordx4 v[228:231], v3, s[32:35], s56 offen sc1
    v_mfma_f32_32x32x16_bf16 v[128:143], a[188:191], v[232:235], v[128:143]
    v_mfma_f32_32x32x16_bf16 v[144:159], a[188:191], v[236:239], v[144:159]
    buffer_load_dwordx4 v[232:235], v2, s[32:35], s56 offen offset:1024 sc1
    s_waitcnt vmcnt(15)
    v_mfma_f32_32x32x16_bf16 v[96:111], a[192:195], v[240:243], v[96:111]
    s_waitcnt vmcnt(14)
    v_mfma_f32_32x32x16_bf16 v[112:127], a[192:195], v[244:247], v[112:127]
    buffer_load_dwordx4 v[236:239], v3, s[32:35], s56 offen offset:1024 sc1
    v_mfma_f32_32x32x16_bf16 v[128:143], a[196:199], v[240:243], v[128:143]
    v_mfma_f32_32x32x16_bf16 v[144:159], a[196:199], v[244:247], v[144:159]
    buffer_load_dwordx4 v[240:243], v2, s[32:35], s56 offen offset:2048 sc1
    s_waitcnt vmcnt(15)
    v_mfma_f32_32x32x16_bf16 v[96:111], a[200:203], v[248:251], v[96:111]
    buffer_load_dwordx4 v25, s[28:31], s100 offen offset:1024 sc1 lds
    s_waitcnt vmcnt(15)
    v_mfma_f32_32x32x16_bf16 v[112:127], a[200:203], v[252:255], v[112:127]
    buffer_load_dwordx4 v[244:247], v3, s[32:35], s56 offen offset:2048 sc1
    v_mfma_f32_32x32x16_bf16 v[128:143], a[204:207], v[248:251], v[128:143]
    v_mfma_f32_32x32x16_bf16 v[144:159], a[204:207], v[252:255], v[144:159]
    buffer_load_dwordx4 v[248:251], v2, s[32:35], s56 offen offset:3072 sc1
    s_waitcnt vmcnt(16)
    v_mfma_f32_32x32x16_bf16 v[96:111], a[208:211], v[192:195], v[96:111]
    s_waitcnt vmcnt(15)
    v_mfma_f32_32x32x16_bf16 v[112:127], a[208:211], v[196:199], v[112:127]
    buffer_load_dwordx4 v[252:255], v3, s[32:35], s56 offen offset:3072 sc1
    s_add_u32 s57, s55, 4
    s_cmp_ge_u32 s57, 7
    s_cselect_b32 s56, 7, 0
    s_sub_u32 s57, s57, s56
    v_mfma_f32_32x32x16_bf16 v[128:143], a[212:215], v[192:195], v[128:143]
    s_mul_i32 s56, s3, 7
    s_add_u32 s57, s57, s56
    s_lshl_b32 s56, s57, 12
    v_mfma_f32_32x32x16_bf16 v[144:159], a[212:215], v[196:199], v[144:159]
    s_waitcnt vmcnt(15)
    buffer_store_dword v20, v19, s[32:35], s10 offen sc1
    buffer_load_dwordx4 v[192:195], v2, s[32:35], s56 offen sc1
    s_waitcnt vmcnt(16)
    v_mfma_f32_32x32x16_bf16 v[96:111], a[216:219], v[200:203], v[96:111]
    v_add_u32 v4, s61, v1
    s_xor_b32 s12, s3, 1
    s_lshl_b32 s12, s12, 12
    s_add_u32 s12, s12, 0
    v_add_u32 v5, s12, v1
    s_xor_b32 s12, s3, 2
    s_waitcnt vmcnt(15)
    v_mfma_f32_32x32x16_bf16 v[112:127], a[216:219], v[204:207], v[112:127]
    buffer_load_dwordx4 v[196:199], v3, s[32:35], s56 offen sc1
    s_lshl_b32 s12, s12, 12
    s_add_u32 s12, s12, 16384
    v_add_u32 v6, s12, v1
    s_xor_b32 s12, s3, 3
    v_mfma_f32_32x32x16_bf16 v[128:143], a[220:223], v[200:203], v[128:143]
    s_lshl_b32 s12, s12, 12
    s_add_u32 s12, s12, 32768
    v_add_u32 v7, s12, v1
    s_lshl_b32 s12, s53, 1
    s_and_b32 s13, s3, 1
    s_add_u32 s12, s12, s13
    v_mfma_f32_32x32x16_bf16 v[144:159], a[220:223], v[204:207], v[144:159]
    buffer_load_dwordx4 v[200:203], v2, s[32:35], s56 offen offset:1024 sc1
    s_lshl_b32 s12, s12, 15
    s_lshl_b32 s13, s54, 7
    s_add_u32 s12, s12, s13
    s_waitcnt vmcnt(16)
    v_mfma_f32_32x32x16_bf16 v[96:111], a[224:227], v[208:211], v[96:111]
    s_lshr_b32 s13, s3, 1
    s_lshl_b32 s13, s13, 6
    s_add_u32 s58, s12, s13
    v_and_b32 v10, 31, v0
    v_lshlrev_b32 v10, 10, v10
    v_lshrrev_b32 v70, 5, v0
    s_waitcnt vmcnt(15)
    v_mfma_f32_32x32x16_bf16 v[112:127], a[224:227], v[212:215], v[112:127]
    buffer_load_dwordx4 v[204:207], v3, s[32:35], s56 offen offset:1024 sc1
    v_lshl_add_u32 v10, v70, 4, v10
    s_lshr_b32 s12, s3, 1
    s_lshl_b32 s12, s12, 2
    v_add_u32 v11, s12, v70
    v_mfma_f32_32x32x16_bf16 v[128:143], a[228:231], v[208:211], v[128:143]
    v_and_b32 v13, 7, v0
    v_xor_b32 v11, v11, v13
    v_and_b32 v12, 31, v0
    s_and_b32 s12, s3, 1
    s_lshl_b32 s12, s12, 12
    s_add_u32 s12, s12, 49152
    v_mfma_f32_32x32x16_bf16 v[144:159], a[228:231], v[212:215], v[144:159]
    buffer_load_dwordx4 v[208:211], v2, s[32:35], s56 offen offset:2048 sc1
    v_lshl_add_u32 v12, v12, 7, s12
    v_lshl_add_u32 v11, v11, 4, v12
    v_xor_b32 v12, 32, v11
    s_waitcnt vmcnt(16)
    v_mfma_f32_32x32x16_bf16 v[96:111], a[232:235], v[216:219], v[96:111]
    v_lshrrev_b32 v70, 3, v0
    v_lshlrev_b32 v10, 10, v70
    v_lshl_add_u32 v10, v13, 4, v10
    v_xor_b32 v13, v13, v70
    v_lshlrev_b32 v13, 4, v13
    v_lshl_add_u32 v13, v70, 7, v13
    s_waitcnt vmcnt(15)
    v_mfma_f32_32x32x16_bf16 v[112:127], a[232:235], v[220:223], v[112:127]
    buffer_load_dwordx4 v[212:215], v3, s[32:35], s56 offen offset:2048 sc1
    s_add_u32 s12, s60, 49152
    v_add_u32 v13, s12, v13
    s_lshl_b32 s12, s53, 2
    s_add_u32 s12, s12, s3
    v_mfma_f32_32x32x16_bf16 v[128:143], a[236:239], v[216:219], v[128:143]
    s_lshl_b32 s12, s12, 14
    s_lshl_b32 s13, s54, 7
    s_add_u32 s58, s12, s13
    s_add_u32 s59, s58, 8192
    v_mfma_f32_32x32x16_bf16 v[144:159], a[236:239], v[220:223], v[144:159]
    buffer_load_dwordx4 v[216:219], v2, s[32:35], s56 offen offset:3072 sc1
    s_waitcnt vmcnt(16) lgkmcnt(0)
    v_mfma_f32_32x32x16_bf16 v[96:111], a[240:243], v[224:227], v[96:111]
    s_waitcnt vmcnt(15)
    v_mfma_f32_32x32x16_bf16 v[112:127], a[240:243], v[228:231], v[112:127]
    buffer_load_dwordx4 v[220:223], v3, s[32:35], s56 offen offset:3072 sc1
    s_add_u32 s57, s55, 5
    s_cmp_ge_u32 s57, 7
    s_cselect_b32 s56, 7, 0
    s_sub_u32 s57, s57, s56
    v_mfma_f32_32x32x16_bf16 v[128:143], a[244:247], v[224:227], v[128:143]
    buffer_load_dwordx4 v26, s[28:31], s100 offen offset:2048 sc1 lds
    s_mul_i32 s56, s3, 7
    s_add_u32 s57, s57, s56
    s_lshl_b32 s56, s57, 12
    v_mfma_f32_32x32x16_bf16 v[144:159], a[244:247], v[228:231], v[144:159]
    ds_read_b64_tr_b16 a[128:129], v66 offset:49152
    ds_read_b64_tr_b16 a[130:131], v66 offset:50176
    buffer_load_dwordx4 v[224:227], v2, s[32:35], s56 offen sc1
    s_waitcnt vmcnt(17)
    v_mfma_f32_32x32x16_bf16 v[96:111], a[248:251], v[232:235], v[96:111]
    ds_read_b64_tr_b16 a[132:133], v67 offset:49152
    ds_read_b64_tr_b16 a[134:135], v67 offset:50176
    s_waitcnt vmcnt(16)
    v_mfma_f32_32x32x16_bf16 v[112:127], a[248:251], v[236:239], v[112:127]
    buffer_load_dwordx4 v[228:231], v3, s[32:35], s56 offen sc1
    v_mfma_f32_32x32x16_bf16 v[128:143], a[252:255], v[232:235], v[128:143]
    v_mfma_f32_32x32x16_bf16 v[144:159], a[252:255], v[236:239], v[144:159]
    ds_read_b64_tr_b16 a[136:137], v66 offset:51200
    ds_read_b64_tr_b16 a[138:139], v66 offset:52224
    buffer_load_dwordx4 v[232:235], v2, s[32:35], s56 offen offset:1024 sc1
    s_waitcnt vmcnt(17) lgkmcnt(2)
    v_mfma_f32_32x32x16_bf16 v[96:111], a[128:131], v[240:243], v[96:111]
    ds_read_b64_tr_b16 a[140:141], v67 offset:51200
    ds_read_b64_tr_b16 a[142:143], v67 offset:52224
    s_waitcnt vmcnt(15)
    v_mfma_f32_32x32x16_bf16 v[112:127], a[128:131], v[244:247], v[112:127]
    buffer_load_dwordx4 v[236:239], v3, s[32:35], s56 offen offset:1024 sc1
    v_mfma_f32_32x32x16_bf16 v[128:143], a[132:135], v[240:243], v[128:143]
    v_mfma_f32_32x32x16_bf16 v[144:159], a[132:135], v[244:247], v[144:159]
    ds_read_b64_tr_b16 a[128:129], v68 offset:0
    ds_read_b64_tr_b16 a[130:131], v68 offset:1024
    buffer_load_dwordx4 v[240:243], v2, s[32:35], s56 offen offset:2048 sc1
    s_waitcnt vmcnt(16) lgkmcnt(2)
    v_mfma_f32_32x32x16_bf16 v[96:111], a[136:139], v[248:251], v[96:111]
    ds_read_b64_tr_b16 a[132:133], v69 offset:0
    ds_read_b64_tr_b16 a[134:135], v69 offset:1024
    s_waitcnt vmcnt(15)
    v_mfma_f32_32x32x16_bf16 v[112:127], a[136:139], v[252:255], v[112:127]
    buffer_load_dwordx4 v[244:247], v3, s[32:35], s56 offen offset:2048 sc1
    v_mfma_f32_32x32x16_bf16 v[128:143], a[140:143], v[248:251], v[128:143]
    v_mfma_f32_32x32x16_bf16 v[144:159], a[140:143], v[252:255], v[144:159]
    ds_read_b64_tr_b16 a[136:137], v68 offset:2048
    ds_read_b64_tr_b16 a[138:139], v68 offset:3072
    buffer_load_dwordx4 v[248:251], v2, s[32:35], s56 offen offset:3072 sc1
    s_waitcnt vmcnt(15) lgkmcnt(2)
    v_mfma_f32_32x32x16_bf16 v[96:111], a[128:131], v[192:195], v[96:111]
    ds_read_b64_tr_b16 a[140:141], v69 offset:2048
    ds_read_b64_tr_b16 a[142:143], v69 offset:3072
    buffer_load_dwordx4 v27, s[28:31], s100 offen offset:3072 sc1 lds
    s_add_u32 s101, s54, 1
    s_and_b32 s101, s101, 1
    s_lshl_b32 s100, s3, 1
    s_add_u32 s101, s101, s100
    s_lshl_b32 s100, s101, 16
    s_add_u32 m0, s61, 98304
    s_nop 0
    buffer_load_dwordx4 v24, s[28:31], s100 offen sc1 lds
    buffer_load_dwordx4 v25, s[28:31], s100 offen offset:1024 sc1 lds
    buffer_load_dwordx4 v26, s[28:31], s100 offen offset:2048 sc1 lds
    buffer_load_dwordx4 v27, s[28:31], s100 offen offset:3072 sc1 lds
    s_add_u32 s100, s100, 32768
    s_add_u32 m0, s61, 114688
    s_nop 0
    buffer_load_dwordx4 v24, s[28:31], s100 offen sc1 lds
    s_waitcnt vmcnt(20)
    v_mfma_f32_32x32x16_bf16 v[112:127], a[128:131], v[196:199], v[112:127]
    buffer_load_dwordx4 v[252:255], v3, s[32:35], s56 offen offset:3072 sc1
    s_add_u32 s57, s55, 6
    s_cmp_ge_u32 s57, 7
    s_cselect_b32 s56, 7, 0
    s_sub_u32 s57, s57, s56
    v_mfma_f32_32x32x16_bf16 v[128:143], a[132:135], v[192:195], v[128:143]
    buffer_load_dwordx4 v25, s[28:31], s100 offen offset:1024 sc1 lds
    s_mul_i32 s56, s3, 7
    s_add_u32 s57, s57, s56
    s_lshl_b32 s56, s57, 12
    v_mfma_f32_32x32x16_bf16 v[144:159], a[132:135], v[196:199], v[144:159]
    ds_read_b64_tr_b16 a[128:129], v68 offset:16384
    ds_read_b64_tr_b16 a[130:131], v68 offset:17408
    buffer_load_dword v23, v21, s[32:35], 0 offen sc1
    buffer_load_dwordx4 v[192:195], v2, s[32:35], s56 offen sc1
    s_waitcnt vmcnt(23) lgkmcnt(2)
    v_mfma_f32_32x32x16_bf16 v[96:111], a[136:139], v[200:203], v[96:111]
    ds_read_b64_tr_b16 a[132:133], v69 offset:16384
    ds_read_b64_tr_b16 a[134:135], v69 offset:17408
    buffer_load_dwordx4 v26, s[28:31], s100 offen offset:2048 sc1 lds
    s_waitcnt vmcnt(23)
    v_mfma_f32_32x32x16_bf16 v[112:127], a[136:139], v[204:207], v[112:127]
    buffer_load_dwordx4 v[196:199], v3, s[32:35], s56 offen sc1
    v_mfma_f32_32x32x16_bf16 v[128:143], a[140:143], v[200:203], v[128:143]
    buffer_load_dwordx4 v27, s[28:31], s100 offen offset:3072 sc1 lds
    v_mfma_f32_32x32x16_bf16 v[144:159], a[140:143], v[204:207], v[144:159]
    ds_read_b64_tr_b16 a[136:137], v68 offset:18432
    ds_read_b64_tr_b16 a[138:139], v68 offset:19456
    buffer_load_dwordx4 v[200:203], v2, s[32:35], s56 offen offset:1024 sc1
    s_waitcnt vmcnt(25) lgkmcnt(2)
    v_mfma_f32_32x32x16_bf16 v[96:111], a[128:131], v[208:211], v[96:111]
    ds_read_b64_tr_b16 a[140:141], v69 offset:18432
    ds_read_b64_tr_b16 a[142:143], v69 offset:19456
    s_waitcnt vmcnt(24)
    v_mfma_f32_32x32x16_bf16 v[112:127], a[128:131], v[212:215], v[112:127]
    buffer_load_dwordx4 v[204:207], v3, s[32:35], s56 offen offset:1024 sc1
    v_mfma_f32_32x32x16_bf16 v[128:143], a[132:135], v[208:211], v[128:143]
    v_mfma_f32_32x32x16_bf16 v[144:159], a[132:135], v[212:215], v[144:159]
    ds_read_b64_tr_b16 a[128:129], v64 offset:0
    ds_read_b64_tr_b16 a[130:131], v64 offset:1024
    buffer_load_dwordx4 v[208:211], v2, s[32:35], s56 offen offset:2048 sc1
    s_waitcnt vmcnt(25) lgkmcnt(2)
    v_mfma_f32_32x32x16_bf16 v[96:111], a[136:139], v[216:219], v[96:111]
    ds_read_b64_tr_b16 a[132:133], v65 offset:0
    ds_read_b64_tr_b16 a[134:135], v65 offset:1024
    s_waitcnt vmcnt(24)
    v_mfma_f32_32x32x16_bf16 v[112:127], a[136:139], v[220:223], v[112:127]
    buffer_load_dwordx4 v[212:215], v3, s[32:35], s56 offen offset:2048 sc1
    v_mfma_f32_32x32x16_bf16 v[128:143], a[140:143], v[216:219], v[128:143]
    v_mfma_f32_32x32x16_bf16 v[144:159], a[140:143], v[220:223], v[144:159]
    ds_read_b64_tr_b16 a[136:137], v64 offset:2048
    ds_read_b64_tr_b16 a[138:139], v64 offset:3072
    buffer_load_dwordx4 v[216:219], v2, s[32:35], s56 offen offset:3072 sc1
    s_waitcnt vmcnt(24) lgkmcnt(2)
    v_mfma_f32_32x32x16_bf16 v[96:111], a[128:131], v[224:227], v[96:111]
    ds_read_b64_tr_b16 a[140:141], v65 offset:2048
    ds_read_b64_tr_b16 a[142:143], v65 offset:3072
    s_waitcnt vmcnt(23)
    v_mfma_f32_32x32x16_bf16 v[112:127], a[128:131], v[228:231], v[112:127]
    buffer_load_dwordx4 v[220:223], v3, s[32:35], s56 offen offset:3072 sc1
    s_add_u32 s57, s54, 0
    s_and_b32 s57, s57, 1
    s_lshl_b32 s56, s3, 1
    s_add_u32 s57, s57, s56
    v_mfma_f32_32x32x16_bf16 v[128:143], a[132:135], v[224:227], v[128:143]
    s_lshl_b32 s56, s57, 12
    s_add_u32 s56, s56, 114688
    s_xor_b32 s57, s56, 4096
    v_mfma_f32_32x32x16_bf16 v[144:159], a[132:135], v[228:231], v[144:159]
    ds_read_b64_tr_b16 a[128:129], v64 offset:16384
    ds_read_b64_tr_b16 a[130:131], v64 offset:17408
    s_waitcnt vmcnt(23) lgkmcnt(2)
    v_mfma_f32_32x32x16_bf16 v[96:111], a[136:139], v[232:235], v[96:111]
    ds_read_b64_tr_b16 a[132:133], v65 offset:16384
    ds_read_b64_tr_b16 a[134:135], v65 offset:17408
    s_waitcnt vmcnt(22)
    v_mfma_f32_32x32x16_bf16 v[112:127], a[136:139], v[236:239], v[112:127]
    v_mfma_f32_32x32x16_bf16 v[128:143], a[140:143], v[232:235], v[128:143]
    v_mfma_f32_32x32x16_bf16 v[144:159], a[140:143], v[236:239], v[144:159]
    ds_read_b64_tr_b16 a[136:137], v64 offset:18432
    ds_read_b64_tr_b16 a[138:139], v64 offset:19456
    s_waitcnt vmcnt(10)
    v_cmp_lt_u32 vcc, v23, v22
    s_nop 4
    s_cbranch_vccnz L_spin_207
L_back_208:
    s_waitcnt lgkmcnt(2)
    v_mfma_f32_32x32x16_bf16 v[96:111], a[128:131], v[240:243], v[96:111]
    ds_read_b64_tr_b16 a[140:141], v65 offset:18432
    ds_read_b64_tr_b16 a[142:143], v65 offset:19456
    buffer_load_dwordx4 a[4:7], v3, s[32:35], s56 offen sc1
    buffer_load_dwordx4 a[12:15], v3, s[32:35], s56 offen offset:1024 sc1
    v_mfma_f32_32x32x16_bf16 v[112:127], a[128:131], v[244:247], v[112:127]
    v_mfma_f32_32x32x16_bf16 v[128:143], a[132:135], v[240:243], v[128:143]
    buffer_load_dwordx4 a[20:23], v3, s[32:35], s56 offen offset:2048 sc1
    v_mfma_f32_32x32x16_bf16 v[144:159], a[132:135], v[244:247], v[144:159]
    ds_read_b64_tr_b16 a[128:129], v64 offset:32768
    ds_read_b64_tr_b16 a[130:131], v64 offset:33792
    s_waitcnt lgkmcnt(2)
    v_mfma_f32_32x32x16_bf16 v[96:111], a[136:139], v[248:251], v[96:111]
    ds_read_b64_tr_b16 a[132:133], v65 offset:32768
    ds_read_b64_tr_b16 a[134:135], v65 offset:33792
    buffer_load_dwordx4 a[28:31], v3, s[32:35], s56 offen offset:3072 sc1
    v_mfma_f32_32x32x16_bf16 v[112:127], a[136:139], v[252:255], v[112:127]
    v_mfma_f32_32x32x16_bf16 v[128:143], a[140:143], v[248:251], v[128:143]
    buffer_load_dwordx4 a[36:39], v3, s[32:35], s57 offen sc1
    v_mfma_f32_32x32x16_bf16 v[144:159], a[140:143], v[252:255], v[144:159]
    ds_read_b64_tr_b16 a[136:137], v64 offset:34816
    ds_read_b64_tr_b16 a[138:139], v64 offset:35840
    s_waitcnt vmcnt(14) lgkmcnt(2)
    v_mfma_f32_32x32x16_bf16 v[96:111], a[128:131], v[192:195], v[96:111]
    ds_read_b64_tr_b16 a[140:141], v65 offset:34816
    ds_read_b64_tr_b16 a[142:143], v65 offset:35840
    buffer_load_dwordx4 a[44:47], v3, s[32:35], s57 offen offset:1024 sc1
    s_waitcnt vmcnt(13)
    v_mfma_f32_32x32x16_bf16 v[112:127], a[128:131], v[196:199], v[112:127]
    buffer_load_dwordx4 a[52:55], v3, s[32:35], s57 offen offset:2048 sc1
    v_mfma_f32_32x32x16_bf16 v[128:143], a[132:135], v[192:195], v[128:143]
    buffer_load_dwordx4 a[60:63], v3, s[32:35], s57 offen offset:3072 sc1
    v_mfma_f32_32x32x16_bf16 v[144:159], a[132:135], v[196:199], v[144:159]
    ds_read_b64_tr_b16 a[128:129], v64 offset:49152
    ds_read_b64_tr_b16 a[130:131], v64 offset:50176
    buffer_load_dwordx4 a[0:3], v2, s[32:35], s56 offen sc1
    s_waitcnt vmcnt(14) lgkmcnt(2)
    v_mfma_f32_32x32x16_bf16 v[96:111], a[136:139], v[200:203], v[96:111]
    ds_read_b64_tr_b16 a[132:133], v65 offset:49152
    ds_read_b64_tr_b16 a[134:135], v65 offset:50176
    buffer_load_dwordx4 a[8:11], v2, s[32:35], s56 offen offset:1024 sc1
    ds_read_b64_tr_b16 a[144:145], v66 offset:0
    s_waitcnt vmcnt(14)
    v_mfma_f32_32x32x16_bf16 v[112:127], a[136:139], v[204:207], v[112:127]
    buffer_load_dwordx4 a[16:19], v2, s[32:35], s56 offen offset:2048 sc1
    ds_read_b64_tr_b16 a[146:147], v66 offset:1024
    ds_read_b64_tr_b16 a[148:149], v67 offset:0
    ds_read_b64_tr_b16 a[150:151], v67 offset:1024
    ds_read_b64_tr_b16 a[152:153], v66 offset:2048
    v_mfma_f32_32x32x16_bf16 v[128:143], a[140:143], v[200:203], v[128:143]
    buffer_load_dwordx4 a[24:27], v2, s[32:35], s56 offen offset:3072 sc1
    ds_read_b64_tr_b16 a[154:155], v66 offset:3072
    ds_read_b64_tr_b16 a[156:157], v67 offset:2048
    ds_read_b64_tr_b16 a[158:159], v67 offset:3072
    v_mfma_f32_32x32x16_bf16 v[144:159], a[140:143], v[204:207], v[144:159]
    ds_read_b64_tr_b16 a[136:137], v64 offset:51200
    ds_read_b64_tr_b16 a[138:139], v64 offset:52224
    buffer_load_dwordx4 a[32:35], v2, s[32:35], s57 offen sc1
    s_waitcnt vmcnt(16) lgkmcnt(2)
    v_mfma_f32_32x32x16_bf16 v[96:111], a[128:131], v[208:211], v[96:111]
    ds_read_b64_tr_b16 a[140:141], v65 offset:51200
    ds_read_b64_tr_b16 a[142:143], v65 offset:52224
    buffer_load_dwordx4 a[40:43], v2, s[32:35], s57 offen offset:1024 sc1
    ds_read_b64_tr_b16 a[160:161], v66 offset:16384
    s_waitcnt vmcnt(16)
    v_mfma_f32_32x32x16_bf16 v[112:127], a[128:131], v[212:215], v[112:127]
    buffer_load_dwordx4 a[48:51], v2, s[32:35], s57 offen offset:2048 sc1
    ds_read_b64_tr_b16 a[162:163], v66 offset:17408
    ds_read_b64_tr_b16 a[164:165], v67 offset:16384
    ds_read_b64_tr_b16 a[166:167], v67 offset:17408
    ds_read_b64_tr_b16 a[168:169], v66 offset:18432
    v_mfma_f32_32x32x16_bf16 v[128:143], a[132:135], v[208:211], v[128:143]
    buffer_load_dwordx4 a[56:59], v2, s[32:35], s57 offen offset:3072 sc1
    ds_read_b64_tr_b16 a[170:171], v66 offset:19456
    ds_read_b64_tr_b16 a[172:173], v67 offset:18432
    ds_read_b64_tr_b16 a[174:175], v67 offset:19456
    v_mfma_f32_32x32x16_bf16 v[144:159], a[132:135], v[212:215], v[144:159]
    ds_read_b64_tr_b16 a[176:177], v66 offset:32768
    ds_read_b64_tr_b16 a[178:179], v66 offset:33792
    ds_read_b64_tr_b16 a[180:181], v67 offset:32768
    ds_read_b64_tr_b16 a[182:183], v67 offset:33792
    s_waitcnt vmcnt(17) lgkmcnt(4)
    v_mfma_f32_32x32x16_bf16 v[96:111], a[136:139], v[216:219], v[96:111]
    ds_read_b64_tr_b16 a[184:185], v66 offset:34816
    ds_read_b64_tr_b16 a[186:187], v66 offset:35840
    ds_read_b64_tr_b16 a[188:189], v67 offset:34816
    ds_read_b64_tr_b16 a[190:191], v67 offset:35840
    ds_read_b64_tr_b16 a[192:193], v66 offset:49152
    s_waitcnt vmcnt(16)
    v_mfma_f32_32x32x16_bf16 v[112:127], a[136:139], v[220:223], v[112:127]
    ds_read_b64_tr_b16 a[194:195], v66 offset:50176
    ds_read_b64_tr_b16 a[196:197], v67 offset:49152
    ds_read_b64_tr_b16 a[198:199], v67 offset:50176
    ds_read_b64_tr_b16 a[200:201], v66 offset:51200
    ds_read_b64_tr_b16 a[202:203], v66 offset:52224
    ds_read_b64_tr_b16 a[204:205], v67 offset:51200
    v_mfma_f32_32x32x16_bf16 v[128:143], a[140:143], v[216:219], v[128:143]
    ds_read_b64_tr_b16 a[206:207], v67 offset:52224
    v_mfma_f32_32x32x16_bf16 v[144:159], a[140:143], v[220:223], v[144:159]
    s_waitcnt vmcnt(15)
    v_mfma_f32_32x32x16_bf16 v[176:191], a[148:151], a[4:7], 0
    s_waitcnt vmcnt(14)
    v_mfma_f32_32x32x16_bf16 v[176:191], a[156:159], a[12:15], v[176:191]
    s_waitcnt vmcnt(13)
    v_mfma_f32_32x32x16_bf16 v[176:191], a[164:167], a[20:23], v[176:191]
    s_waitcnt vmcnt(12)
    v_mfma_f32_32x32x16_bf16 v[176:191], a[172:175], a[28:31], v[176:191]
    s_waitcnt vmcnt(11) lgkmcnt(0)
    v_mfma_f32_32x32x16_bf16 v[176:191], a[180:183], a[36:39], v[176:191]
    s_waitcnt vmcnt(10)
    v_mfma_f32_32x32x16_bf16 v[176:191], a[188:191], a[44:47], v[176:191]
    s_waitcnt vmcnt(9)
    v_mfma_f32_32x32x16_bf16 v[176:191], a[196:199], a[52:55], v[176:191]
    s_waitcnt vmcnt(8)
    v_mfma_f32_32x32x16_bf16 v[176:191], a[204:207], a[60:63], v[176:191]
    v_mfma_f32_32x32x16_bf16 v[160:175], a[144:147], a[4:7], 0
    v_mfma_f32_32x32x16_bf16 v[160:175], a[152:155], a[12:15], v[160:175]
    v_mfma_f32_32x32x16_bf16 v[160:175], a[160:163], a[20:23], v[160:175]
    s_nop 8
    v_fma_f32 v144, v144, v9, v176
    v_fma_f32 v145, v145, v9, v177
    v_fma_f32 v146, v146, v9, v178
    v_fma_f32 v147, v147, v9, v179
    v_fma_f32 v148, v148, v9, v180
    v_fma_f32 v149, v149, v9, v181
    v_mfma_f32_32x32x16_bf16 v[160:175], a[168:171], a[28:31], v[160:175]
    v_fma_f32 v150, v150, v9, v182
    v_fma_f32 v151, v151, v9, v183
    v_fma_f32 v152, v152, v9, v184
    v_fma_f32 v153, v153, v9, v185
    v_fma_f32 v154, v154, v9, v186
    v_fma_f32 v155, v155, v9, v187
    v_mfma_f32_32x32x16_bf16 v[160:175], a[176:179], a[36:39], v[160:175]
    v_fma_f32 v156, v156, v9, v188
    v_fma_f32 v157, v157, v9, v189
    v_fma_f32 v158, v158, v9, v190
    v_fma_f32 v159, v159, v9, v191
    v_mfma_f32_32x32x16_bf16 v[160:175], a[184:187], a[44:47], v[160:175]
    ds_write_b128 v4, v[144:147] offset:32768
    v_mfma_f32_32x32x16_bf16 v[160:175], a[192:195], a[52:55], v[160:175]
    ds_write_b128 v4, v[148:151] offset:33792
    v_mfma_f32_32x32x16_bf16 v[160:175], a[200:203], a[60:63], v[160:175]
    ds_write_b128 v4, v[152:155] offset:34816
    s_waitcnt vmcnt(7)
    v_mfma_f32_32x32x16_bf16 v[176:191], a[148:151], a[0:3], 0
    ds_write_b128 v4, v[156:159] offset:35840
    s_waitcnt vmcnt(6)
    v_mfma_f32_32x32x16_bf16 v[176:191], a[156:159], a[8:11], v[176:191]
    s_waitcnt vmcnt(5)
    v_mfma_f32_32x32x16_bf16 v[176:191], a[164:167], a[16:19], v[176:191]
    s_nop 3
    v_fma_f32 v112, v112, v9, v160
    v_fma_f32 v113, v113, v9, v161
    v_fma_f32 v114, v114, v9, v162
    v_fma_f32 v115, v115, v9, v163
    v_fma_f32 v116, v116, v9, v164
    v_fma_f32 v117, v117, v9, v165
    s_waitcnt vmcnt(4)
    v_mfma_f32_32x32x16_bf16 v[176:191], a[172:175], a[24:27], v[176:191]
    v_fma_f32 v118, v118, v9, v166
    v_fma_f32 v119, v119, v9, v167
    v_fma_f32 v120, v120, v9, v168
    v_fma_f32 v121, v121, v9, v169
    v_fma_f32 v122, v122, v9, v170
    v_fma_f32 v123, v123, v9, v171
    s_waitcnt vmcnt(3)
    v_mfma_f32_32x32x16_bf16 v[176:191], a[180:183], a[32:35], v[176:191]
    v_fma_f32 v124, v124, v9, v172
    v_fma_f32 v125, v125, v9, v173
    v_fma_f32 v126, v126, v9, v174
    v_fma_f32 v127, v127, v9, v175
    s_waitcnt vmcnt(2)
    v_mfma_f32_32x32x16_bf16 v[176:191], a[188:191], a[40:43], v[176:191]
    ds_write_b128 v4, v[112:115] offset:0
    s_waitcnt vmcnt(1)
    v_mfma_f32_32x32x16_bf16 v[176:191], a[196:199], a[48:51], v[176:191]
    ds_write_b128 v4, v[116:119] offset:1024
    s_waitcnt vmcnt(0)
    v_mfma_f32_32x32x16_bf16 v[176:191], a[204:207], a[56:59], v[176:191]
    ds_write_b128 v4, v[120:123] offset:2048
    v_mfma_f32_32x32x16_bf16 v[160:175], a[144:147], a[0:3], 0
    ds_write_b128 v4, v[124:127] offset:3072
    v_mfma_f32_32x32x16_bf16 v[160:175], a[152:155], a[8:11], v[160:175]
    v_mfma_f32_32x32x16_bf16 v[160:175], a[160:163], a[16:19], v[160:175]
    s_nop 6
    v_fma_f32 v128, v128, v8, v176
    v_fma_f32 v129, v129, v8, v177
    v_fma_f32 v130, v130, v8, v178
    v_fma_f32 v131, v131, v8, v179
    v_fma_f32 v132, v132, v8, v180
    v_fma_f32 v133, v133, v8, v181
    v_mfma_f32_32x32x16_bf16 v[160:175], a[168:171], a[24:27], v[160:175]
    v_fma_f32 v134, v134, v8, v182
    v_fma_f32 v135, v135, v8, v183
    v_fma_f32 v136, v136, v8, v184
    v_fma_f32 v137, v137, v8, v185
    v_fma_f32 v138, v138, v8, v186
    v_fma_f32 v139, v139, v8, v187
    v_mfma_f32_32x32x16_bf16 v[160:175], a[176:179], a[32:35], v[160:175]
    v_fma_f32 v140, v140, v8, v188
    v_fma_f32 v141, v141, v8, v189
    v_fma_f32 v142, v142, v8, v190
    v_fma_f32 v143, v143, v8, v191
    v_mfma_f32_32x32x16_bf16 v[160:175], a[184:187], a[40:43], v[160:175]
    ds_write_b128 v4, v[128:131] offset:16384
    v_mfma_f32_32x32x16_bf16 v[160:175], a[192:195], a[48:51], v[160:175]
    ds_write_b128 v4, v[132:135] offset:17408
    v_mfma_f32_32x32x16_bf16 v[160:175], a[200:203], a[56:59], v[160:175]
    ds_write_b128 v4, v[136:139] offset:18432
    ds_write_b128 v4, v[140:143] offset:19456
    s_waitcnt lgkmcnt(0)
    s_barrier
    ds_read_b128 v[192:195], v5 offset:0
    ds_read_b128 v[196:199], v5 offset:1024
    ds_read_b128 v[200:203], v5 offset:2048
    ds_read_b128 v[204:207], v5 offset:3072
    ds_read_b128 v[208:211], v6 offset:0
    ds_read_b128 v[212:215], v6 offset:1024
    ds_read_b128 v[216:219], v6 offset:2048
    ds_read_b128 v[220:223], v6 offset:3072
    ds_read_b128 v[224:227], v7 offset:0
    ds_read_b128 v[228:231], v7 offset:1024
    ds_read_b128 v[232:235], v7 offset:2048
    ds_read_b128 v[236:239], v7 offset:3072
    v_pk_fma_f32 v[96:97], v[96:97], v[8:9], v[160:161] op_sel_hi:[1,0,1]
    v_pk_fma_f32 v[98:99], v[98:99], v[8:9], v[162:163] op_sel_hi:[1,0,1]
    v_pk_fma_f32 v[100:101], v[100:101], v[8:9], v[164:165] op_sel_hi:[1,0,1]
    v_pk_fma_f32 v[102:103], v[102:103], v[8:9], v[166:167] op_sel_hi:[1,0,1]
    v_pk_fma_f32 v[104:105], v[104:105], v[8:9], v[168:169] op_sel_hi:[1,0,1]
    v_pk_fma_f32 v[106:107], v[106:107], v[8:9], v[170:171] op_sel_hi:[1,0,1]
    v_pk_fma_f32 v[108:109], v[108:109], v[8:9], v[172:173] op_sel_hi:[1,0,1]
    v_pk_fma_f32 v[110:111], v[110:111], v[8:9], v[174:175] op_sel_hi:[1,0,1]
    s_waitcnt lgkmcnt(11)
    v_pk_add_f32 v[96:97], v[96:97], v[192:193]
    v_pk_add_f32 v[98:99], v[98:99], v[194:195]
    s_waitcnt lgkmcnt(10)
    v_pk_add_f32 v[100:101], v[100:101], v[196:197]
    v_pk_add_f32 v[102:103], v[102:103], v[198:199]
    s_waitcnt lgkmcnt(9)
    v_pk_add_f32 v[104:105], v[104:105], v[200:201]
    v_pk_add_f32 v[106:107], v[106:107], v[202:203]
    s_waitcnt lgkmcnt(8)
    v_pk_add_f32 v[108:109], v[108:109], v[204:205]
    v_pk_add_f32 v[110:111], v[110:111], v[206:207]
    s_waitcnt lgkmcnt(7)
    v_pk_add_f32 v[96:97], v[96:97], v[208:209]
    v_pk_add_f32 v[98:99], v[98:99], v[210:211]
    s_waitcnt lgkmcnt(6)
    v_pk_add_f32 v[100:101], v[100:101], v[212:213]
    v_pk_add_f32 v[102:103], v[102:103], v[214:215]
    s_waitcnt lgkmcnt(5)
    v_pk_add_f32 v[104:105], v[104:105], v[216:217]
    v_pk_add_f32 v[106:107], v[106:107], v[218:219]
    s_waitcnt lgkmcnt(4)
    v_pk_add_f32 v[108:109], v[108:109], v[220:221]
    v_pk_add_f32 v[110:111], v[110:111], v[222:223]
    s_waitcnt lgkmcnt(3)
    v_pk_add_f32 v[96:97], v[96:97], v[224:225]
    v_pk_add_f32 v[98:99], v[98:99], v[226:227]
    s_waitcnt lgkmcnt(2)
    v_pk_add_f32 v[100:101], v[100:101], v[228:229]
    v_pk_add_f32 v[102:103], v[102:103], v[230:231]
    s_waitcnt lgkmcnt(1)
    v_pk_add_f32 v[104:105], v[104:105], v[232:233]
    v_pk_add_f32 v[106:107], v[106:107], v[234:235]
    s_waitcnt lgkmcnt(0)
    v_pk_add_f32 v[108:109], v[108:109], v[236:237]
    v_pk_add_f32 v[110:111], v[110:111], v[238:239]
    v_cvt_pk_bf16_f32 v40, v96, v97
    v_cvt_pk_bf16_f32 v41, v98, v99
    v_cvt_pk_bf16_f32 v42, v100, v101
    v_cvt_pk_bf16_f32 v43, v102, v103
    v_cvt_pk_bf16_f32 v44, v104, v105
    v_cvt_pk_bf16_f32 v45, v106, v107
    v_cvt_pk_bf16_f32 v46, v108, v109
    v_cvt_pk_bf16_f32 v47, v110, v111
    v_permlane32_swap_b32 v40, v42
    v_permlane32_swap_b32 v41, v43
    ds_write_b128 v11, v[40:43]
    v_permlane32_swap_b32 v44, v46
    v_permlane32_swap_b32 v45, v47
    ds_write_b128 v12, v[44:47]
    s_waitcnt lgkmcnt(0)
    s_barrier
    ds_read_b128 v[48:51], v13 offset:0
    ds_read_b128 v[52:55], v13 offset:1024
    s_waitcnt lgkmcnt(1)
    buffer_store_dwordx4 v[48:51], v10, s[36:39], s58 offen
    s_waitcnt lgkmcnt(0)
    buffer_store_dwordx4 v[52:55], v10, s[36:39], s59 offen
L_end:
    s_endpgm
L_warm_end:
L_spin_1:
    s_sleep 4
    buffer_load_dword v23, v21, s[40:43], 0 offen sc1
    s_add_u32 s63, s63, 1
    s_cmp_gt_u32 s63, 2097152
    s_waitcnt vmcnt(0)
    s_cbranch_scc1 L_back_2
    v_cmp_lt_u32 vcc, v23, v22
    s_nop 4
    s_cbranch_vccnz L_spin_1
    s_branch L_back_2
L_spin_3:
    s_sleep 4
    buffer_load_dword v23, v4, s[32:35], 0 offen sc1
    s_add_u32 s63, s63, 1
    s_cmp_gt_u32 s63, 2097152
    s_waitcnt vmcnt(0)
    s_cbranch_scc1 L_back_4
    v_cmp_lt_u32 vcc, v23, v5
    s_nop 4
    s_cbranch_vccnz L_spin_3
    s_branch L_back_4
L_spin_5:
    s_sleep 4
    buffer_load_dword v23, v11, s[32:35], 0 offen sc1
    s_add_u32 s63, s63, 1
    s_cmp_gt_u32 s63, 2097152
    s_waitcnt vmcnt(0)
    s_cbranch_scc1 L_back_6
    v_cmp_lt_u32 vcc, v23, v12
    s_nop 4
    s_cbranch_vccnz L_spin_5
    s_branch L_back_6
L_spin_501:
    s_sleep 4
    buffer_load_dword v23, v21, s[40:43], 0 offen sc1
    s_add_u32 s63, s63, 1
    s_cmp_gt_u32 s63, 2097152
    s_waitcnt vmcnt(0)
    s_cbranch_scc1 L_back_502
    v_cmp_lt_u32 vcc, v23, v22
    s_nop 4
    s_cbranch_vccnz L_spin_501
    s_branch L_back_502
L_spin_503:
    s_sleep 4
    buffer_load_dword v23, v4, s[32:35], 0 offen sc1
    s_add_u32 s63, s63, 1
    s_cmp_gt_u32 s63, 2097152
    s_waitcnt vmcnt(0)
    s_cbranch_scc1 L_back_504
    v_cmp_lt_u32 vcc, v23, v5
    s_nop 4
    s_cbranch_vccnz L_spin_503
    s_branch L_back_504
L_spin_505:
    s_sleep 4
    buffer_load_dword v23, v11, s[32:35], 0 offen sc1
    s_add_u32 s63, s63, 1
    s_cmp_gt_u32 s63, 2097152
    s_waitcnt vmcnt(0)
    s_cbranch_scc1 L_back_506
    v_cmp_lt_u32 vcc, v23, v12
    s_nop 4
    s_cbranch_vccnz L_spin_505
    s_branch L_back_506
L_spin_203:
    s_sleep 4
    buffer_load_dword v23, v21, s[32:35], 0 offen sc1
    s_add_u32 s63, s63, 1
    s_cmp_gt_u32 s63, 2097152
    s_waitcnt vmcnt(0)
    s_cbranch_scc1 L_back_204
    v_cmp_lt_u32 vcc, v23, v22
    s_nop 4
    s_cbranch_vccnz L_spin_203
    s_branch L_back_204
L_spin_207:
    s_sleep 4
    buffer_load_dword v23, v21, s[32:35], 0 offen sc1
    s_add_u32 s63, s63, 1
    s_cmp_gt_u32 s63, 2097152
    s_waitcnt vmcnt(0)
    s_cbranch_scc1 L_back_208
    v_cmp_lt_u32 vcc, v23, v22
    s_nop 4
    s_cbranch_vccnz L_spin_207
    s_branch L_back_208
L_fb_201:
    s_waitcnt vmcnt(0) lgkmcnt(0)
    s_nop 15
    v_mov_b32 v192, 0xf149f2ca
    v_mov_b32 v193, 0xf149f2ca
    v_mov_b32 v194, 0xf149f2ca
    v_mov_b32 v195, 0xf149f2ca
    v_mov_b32 v196, 0xf149f2ca
    v_mov_b32 v197, 0xf149f2ca
    v_mov_b32 v198, 0xf149f2ca
    v_mov_b32 v199, 0xf149f2ca
    v_mov_b32 v200, 0xf149f2ca
    v_mov_b32 v201, 0xf149f2ca
    v_mov_b32 v202, 0xf149f2ca
    v_mov_b32 v203, 0xf149f2ca
    v_mov_b32 v204, 0xf149f2ca
    v_mov_b32 v205, 0xf149f2ca
    v_mov_b32 v206, 0xf149f2ca
    v_mov_b32 v207, 0xf149f2ca
    s_nop 1
    s_cmp_ge_i32 s46, 0
    s_cbranch_scc0 L_fs_1001
    v_mfma_f32_32x32x16_bf16 v[192:207], a[80:83], a[120:123], 0
    s_nop 11
L_fs_1001:
    v_mfma_f32_32x32x16_bf16 v[208:223], a[112:115], a[120:123], 0
    s_nop 11
    v_cndmask_b32 v208, v208, v192, s[64:65]
    v_cndmask_b32 v209, v209, v193, s[66:67]
    v_cndmask_b32 v210, v210, v194, s[68:69]
    v_cndmask_b32 v211, v211, v195, s[70:71]
    v_cndmask_b32 v212, v212, v196, s[72:73]
    v_cndmask_b32 v213, v213, v197, s[74:75]
    v_cndmask_b32 v214, v214, v198, s[76:77]
    v_cndmask_b32 v215, v215, v199, s[78:79]
    v_cndmask_b32 v216, v216, v200, s[80:81]
    v_cndmask_b32 v217, v217, v201, s[82:83]
    v_cndmask_b32 v218, v218, v202, s[84:85]
    v_cndmask_b32 v219, v219, v203, s[86:87]
    v_cndmask_b32 v220, v220, v204, s[88:89]
    v_cndmask_b32 v221, v221, v205, s[90:91]
    v_cndmask_b32 v222, v222, v206, s[92:93]
    v_cndmask_b32 v223, v223, v207, s[94:95]
    v_max_f32 v60, v208, v209
    v_max3_f32 v60, v60, v210, v211
    v_max3_f32 v60, v60, v212, v213
    v_max3_f32 v60, v60, v214, v215
    v_max3_f32 v60, v60, v216, v217
    v_max3_f32 v60, v60, v218, v219
    v_max3_f32 v60, v60, v220, v221
    v_max3_f32 v60, v60, v222, v223
    s_nop 1
    s_cmp_ge_i32 s46, -1
    s_cbranch_scc0 L_fs_1002
    v_mfma_f32_32x32x16_bf16 v[192:207], a[84:87], a[120:123], 0
    s_nop 11
    v_max3_f32 v60, v60, v192, v193
    v_max3_f32 v60, v60, v194, v195
    v_max3_f32 v60, v60, v196, v197
    v_max3_f32 v60, v60, v198, v199
    v_max3_f32 v60, v60, v200, v201
    v_max3_f32 v60, v60, v202, v203
    v_max3_f32 v60, v60, v204, v205
    v_max3_f32 v60, v60, v206, v207
    s_nop 1
L_fs_1002:
    s_cmp_ge_i32 s46, -2
    s_cbranch_scc0 L_fs_1003
    v_mfma_f32_32x32x16_bf16 v[192:207], a[88:91], a[120:123], 0
    s_nop 11
    v_max3_f32 v60, v60, v192, v193
    v_max3_f32 v60, v60, v194, v195
    v_max3_f32 v60, v60, v196, v197
    v_max3_f32 v60, v60, v198, v199
    v_max3_f32 v60, v60, v200, v201
    v_max3_f32 v60, v60, v202, v203
    v_max3_f32 v60, v60, v204, v205
    v_max3_f32 v60, v60, v206, v207
    s_nop 1
L_fs_1003:
    s_cmp_ge_i32 s46, -3
    s_cbranch_scc0 L_fs_1004
    v_mfma_f32_32x32x16_bf16 v[192:207], a[92:95], a[120:123], 0
    s_nop 11
    v_max3_f32 v60, v60, v192, v193
    v_max3_f32 v60, v60, v194, v195
    v_max3_f32 v60, v60, v196, v197
    v_max3_f32 v60, v60, v198, v199
    v_max3_f32 v60, v60, v200, v201
    v_max3_f32 v60, v60, v202, v203
    v_max3_f32 v60, v60, v204, v205
    v_max3_f32 v60, v60, v206, v207
    s_nop 1
L_fs_1004:
    s_cmp_ge_i32 s46, -4
    s_cbranch_scc0 L_fs_1005
    v_mfma_f32_32x32x16_bf16 v[192:207], a[96:99], a[120:123], 0
    s_nop 11
    v_max3_f32 v60, v60, v192, v193
    v_max3_f32 v60, v60, v194, v195
    v_max3_f32 v60, v60, v196, v197
    v_max3_f32 v60, v60, v198, v199
    v_max3_f32 v60, v60, v200, v201
    v_max3_f32 v60, v60, v202, v203
    v_max3_f32 v60, v60, v204, v205
    v_max3_f32 v60, v60, v206, v207
    s_nop 1
L_fs_1005:
    s_cmp_ge_i32 s46, -5
    s_cbranch_scc0 L_fs_1006
    v_mfma_f32_32x32x16_bf16 v[192:207], a[100:103], a[120:123], 0
    s_nop 11
    v_max3_f32 v60, v60, v192, v193
    v_max3_f32 v60, v60, v194, v195
    v_max3_f32 v60, v60, v196, v197
    v_max3_f32 v60, v60, v198, v199
    v_max3_f32 v60, v60, v200, v201
    v_max3_f32 v60, v60, v202, v203
    v_max3_f32 v60, v60, v204, v205
    v_max3_f32 v60, v60, v206, v207
    s_nop 1
L_fs_1006:
    s_cmp_ge_i32 s46, -6
    s_cbranch_scc0 L_fs_1007
    v_mfma_f32_32x32x16_bf16 v[192:207], a[104:107], a[120:123], 0
    s_nop 11
    v_max3_f32 v60, v60, v192, v193
    v_max3_f32 v60, v60, v194, v195
    v_max3_f32 v60, v60, v196, v197
    v_max3_f32 v60, v60, v198, v199
    v_max3_f32 v60, v60, v200, v201
    v_max3_f32 v60, v60, v202, v203
    v_max3_f32 v60, v60, v204, v205
    v_max3_f32 v60, v60, v206, v207
    s_nop 1
L_fs_1007:
    s_cmp_ge_i32 s46, -7
    s_cbranch_scc0 L_fs_1008
    v_mfma_f32_32x32x16_bf16 v[192:207], a[108:111], a[120:123], 0
    s_nop 11
    v_max3_f32 v60, v60, v192, v193
    v_max3_f32 v60, v60, v194, v195
    v_max3_f32 v60, v60, v196, v197
    v_max3_f32 v60, v60, v198, v199
    v_max3_f32 v60, v60, v200, v201
    v_max3_f32 v60, v60, v202, v203
    v_max3_f32 v60, v60, v204, v205
    v_max3_f32 v60, v60, v206, v207
    s_nop 1
L_fs_1008:
    v_mov_b32 v61, v60
    s_nop 1
    v_permlane32_swap_b32 v60, v61
    v_max_f32 v60, v60, v61
    v_sub_f32 v208, v208, v60
    v_sub_f32 v209, v209, v60
    v_sub_f32 v210, v210, v60
    v_sub_f32 v211, v211, v60
    v_sub_f32 v212, v212, v60
    v_sub_f32 v213, v213, v60
    v_sub_f32 v214, v214, v60
    v_sub_f32 v215, v215, v60
    v_sub_f32 v216, v216, v60
    v_sub_f32 v217, v217, v60
    v_sub_f32 v218, v218, v60
    v_sub_f32 v219, v219, v60
    v_sub_f32 v220, v220, v60
    v_sub_f32 v221, v221, v60
    v_sub_f32 v222, v222, v60
    v_sub_f32 v223, v223, v60
    v_exp_f32 v208, v208
    v_exp_f32 v209, v209
    v_exp_f32 v210, v210
    v_exp_f32 v211, v211
    v_exp_f32 v212, v212
    v_exp_f32 v213, v213
    v_exp_f32 v214, v214
    v_exp_f32 v215, v215
    v_exp_f32 v216, v216
    v_exp_f32 v217, v217
    v_exp_f32 v218, v218
    v_exp_f32 v219, v219
    v_exp_f32 v220, v220
    v_exp_f32 v221, v221
    v_exp_f32 v222, v222
    v_exp_f32 v223, v223
    v_cvt_pk_bf16_f32 v224, v208, v209
    v_cvt_pk_bf16_f32 v225, v210, v211
    v_cvt_pk_bf16_f32 v226, v212, v213
    v_cvt_pk_bf16_f32 v227, v214, v215
    v_cvt_pk_bf16_f32 v228, v216, v217
    v_cvt_pk_bf16_f32 v229, v218, v219
    v_cvt_pk_bf16_f32 v230, v220, v221
    v_cvt_pk_bf16_f32 v231, v222, v223
    v_bfi_b32 v232, v32, 0, v224
    v_bfi_b32 v233, v33, 0, v225
    v_bfi_b32 v234, v34, 0, v226
    v_bfi_b32 v235, v35, 0, v227
    v_bfi_b32 v236, v36, 0, v228
    v_bfi_b32 v237, v37, 0, v229
    v_bfi_b32 v238, v38, 0, v230
    v_bfi_b32 v239, v39, 0, v231
    v_and_b32 v224, v224, v32
    v_and_b32 v225, v225, v33
    v_and_b32 v226, v226, v34
    v_and_b32 v227, v227, v35
    v_and_b32 v228, v228, v36
    v_and_b32 v229, v229, v37
    v_and_b32 v230, v230, v38
    v_and_b32 v231, v231, v39
    v_mfma_f32_32x32x16_bf16 v[144:159], a[64:67], v[232:235], 0
    v_mfma_f32_32x32x16_bf16 v[144:159], a[68:71], v[236:239], v[144:159]
    v_mfma_f32_32x32x16_bf16 v[144:159], a[0:3], v[224:227], v[144:159]
    v_mfma_f32_32x32x16_bf16 v[144:159], a[4:7], v[228:231], v[144:159]
    s_nop 11
    s_cmp_ge_i32 s46, -1
    s_cbranch_scc0 L_fs_1009
    v_mfma_f32_32x32x16_bf16 v[192:207], a[84:87], a[120:123], 0
    s_nop 11
    v_sub_f32 v192, v192, v60
    v_sub_f32 v193, v193, v60
    v_sub_f32 v194, v194, v60
    v_sub_f32 v195, v195, v60
    v_sub_f32 v196, v196, v60
    v_sub_f32 v197, v197, v60
    v_sub_f32 v198, v198, v60
    v_sub_f32 v199, v199, v60
    v_sub_f32 v200, v200, v60
    v_sub_f32 v201, v201, v60
    v_sub_f32 v202, v202, v60
    v_sub_f32 v203, v203, v60
    v_sub_f32 v204, v204, v60
    v_sub_f32 v205, v205, v60
    v_sub_f32 v206, v206, v60
    v_sub_f32 v207, v207, v60
    v_exp_f32 v192, v192
    v_exp_f32 v193, v193
    v_exp_f32 v194, v194
    v_exp_f32 v195, v195
    v_exp_f32 v196, v196
    v_exp_f32 v197, v197
    v_exp_f32 v198, v198
    v_exp_f32 v199, v199
    v_exp_f32 v200, v200
    v_exp_f32 v201, v201
    v_exp_f32 v202, v202
    v_exp_f32 v203, v203
    v_exp_f32 v204, v204
    v_exp_f32 v205, v205
    v_exp_f32 v206, v206
    v_exp_f32 v207, v207
    v_cvt_pk_bf16_f32 v224, v192, v193
    v_cvt_pk_bf16_f32 v225, v194, v195
    v_cvt_pk_bf16_f32 v226, v196, v197
    v_cvt_pk_bf16_f32 v227, v198, v199
    v_cvt_pk_bf16_f32 v228, v200, v201
    v_cvt_pk_bf16_f32 v229, v202, v203
    v_cvt_pk_bf16_f32 v230, v204, v205
    v_cvt_pk_bf16_f32 v231, v206, v207
    v_mfma_f32_32x32x16_bf16 v[144:159], a[8:11], v[224:227], v[144:159]
    s_nop 0
    v_mfma_f32_32x32x16_bf16 v[144:159], a[12:15], v[228:231], v[144:159]
    s_nop 11
L_fs_1009:
    s_cmp_ge_i32 s46, -2
    s_cbranch_scc0 L_fs_1010
    v_mfma_f32_32x32x16_bf16 v[192:207], a[88:91], a[120:123], 0
    s_nop 11
    v_sub_f32 v192, v192, v60
    v_sub_f32 v193, v193, v60
    v_sub_f32 v194, v194, v60
    v_sub_f32 v195, v195, v60
    v_sub_f32 v196, v196, v60
    v_sub_f32 v197, v197, v60
    v_sub_f32 v198, v198, v60
    v_sub_f32 v199, v199, v60
    v_sub_f32 v200, v200, v60
    v_sub_f32 v201, v201, v60
    v_sub_f32 v202, v202, v60
    v_sub_f32 v203, v203, v60
    v_sub_f32 v204, v204, v60
    v_sub_f32 v205, v205, v60
    v_sub_f32 v206, v206, v60
    v_sub_f32 v207, v207, v60
    v_exp_f32 v192, v192
    v_exp_f32 v193, v193
    v_exp_f32 v194, v194
    v_exp_f32 v195, v195
    v_exp_f32 v196, v196
    v_exp_f32 v197, v197
    v_exp_f32 v198, v198
    v_exp_f32 v199, v199
    v_exp_f32 v200, v200
    v_exp_f32 v201, v201
    v_exp_f32 v202, v202
    v_exp_f32 v203, v203
    v_exp_f32 v204, v204
    v_exp_f32 v205, v205
    v_exp_f32 v206, v206
    v_exp_f32 v207, v207
    v_cvt_pk_bf16_f32 v224, v192, v193
    v_cvt_pk_bf16_f32 v225, v194, v195
    v_cvt_pk_bf16_f32 v226, v196, v197
    v_cvt_pk_bf16_f32 v227, v198, v199
    v_cvt_pk_bf16_f32 v228, v200, v201
    v_cvt_pk_bf16_f32 v229, v202, v203
    v_cvt_pk_bf16_f32 v230, v204, v205
    v_cvt_pk_bf16_f32 v231, v206, v207
    v_mfma_f32_32x32x16_bf16 v[144:159], a[16:19], v[224:227], v[144:159]
    s_nop 0
    v_mfma_f32_32x32x16_bf16 v[144:159], a[20:23], v[228:231], v[144:159]
    s_nop 11
L_fs_1010:
    s_cmp_ge_i32 s46, -3
    s_cbranch_scc0 L_fs_1011
    v_mfma_f32_32x32x16_bf16 v[192:207], a[92:95], a[120:123], 0
    s_nop 11
    v_sub_f32 v192, v192, v60
    v_sub_f32 v193, v193, v60
    v_sub_f32 v194, v194, v60
    v_sub_f32 v195, v195, v60
    v_sub_f32 v196, v196, v60
    v_sub_f32 v197, v197, v60
    v_sub_f32 v198, v198, v60
    v_sub_f32 v199, v199, v60
    v_sub_f32 v200, v200, v60
    v_sub_f32 v201, v201, v60
    v_sub_f32 v202, v202, v60
    v_sub_f32 v203, v203, v60
    v_sub_f32 v204, v204, v60
    v_sub_f32 v205, v205, v60
    v_sub_f32 v206, v206, v60
    v_sub_f32 v207, v207, v60
    v_exp_f32 v192, v192
    v_exp_f32 v193, v193
    v_exp_f32 v194, v194
    v_exp_f32 v195, v195
    v_exp_f32 v196, v196
    v_exp_f32 v197, v197
    v_exp_f32 v198, v198
    v_exp_f32 v199, v199
    v_exp_f32 v200, v200
    v_exp_f32 v201, v201
    v_exp_f32 v202, v202
    v_exp_f32 v203, v203
    v_exp_f32 v204, v204
    v_exp_f32 v205, v205
    v_exp_f32 v206, v206
    v_exp_f32 v207, v207
    v_cvt_pk_bf16_f32 v224, v192, v193
    v_cvt_pk_bf16_f32 v225, v194, v195
    v_cvt_pk_bf16_f32 v226, v196, v197
    v_cvt_pk_bf16_f32 v227, v198, v199
    v_cvt_pk_bf16_f32 v228, v200, v201
    v_cvt_pk_bf16_f32 v229, v202, v203
    v_cvt_pk_bf16_f32 v230, v204, v205
    v_cvt_pk_bf16_f32 v231, v206, v207
    v_mfma_f32_32x32x16_bf16 v[144:159], a[24:27], v[224:227], v[144:159]
    s_nop 0
    v_mfma_f32_32x32x16_bf16 v[144:159], a[28:31], v[228:231], v[144:159]
    s_nop 11
L_fs_1011:
    s_cmp_ge_i32 s46, -4
    s_cbranch_scc0 L_fs_1012
    v_mfma_f32_32x32x16_bf16 v[192:207], a[96:99], a[120:123], 0
    s_nop 11
    v_sub_f32 v192, v192, v60
    v_sub_f32 v193, v193, v60
    v_sub_f32 v194, v194, v60
    v_sub_f32 v195, v195, v60
    v_sub_f32 v196, v196, v60
    v_sub_f32 v197, v197, v60
    v_sub_f32 v198, v198, v60
    v_sub_f32 v199, v199, v60
    v_sub_f32 v200, v200, v60
    v_sub_f32 v201, v201, v60
    v_sub_f32 v202, v202, v60
    v_sub_f32 v203, v203, v60
    v_sub_f32 v204, v204, v60
    v_sub_f32 v205, v205, v60
    v_sub_f32 v206, v206, v60
    v_sub_f32 v207, v207, v60
    v_exp_f32 v192, v192
    v_exp_f32 v193, v193
    v_exp_f32 v194, v194
    v_exp_f32 v195, v195
    v_exp_f32 v196, v196
    v_exp_f32 v197, v197
    v_exp_f32 v198, v198
    v_exp_f32 v199, v199
    v_exp_f32 v200, v200
    v_exp_f32 v201, v201
    v_exp_f32 v202, v202
    v_exp_f32 v203, v203
    v_exp_f32 v204, v204
    v_exp_f32 v205, v205
    v_exp_f32 v206, v206
    v_exp_f32 v207, v207
    v_cvt_pk_bf16_f32 v224, v192, v193
    v_cvt_pk_bf16_f32 v225, v194, v195
    v_cvt_pk_bf16_f32 v226, v196, v197
    v_cvt_pk_bf16_f32 v227, v198, v199
    v_cvt_pk_bf16_f32 v228, v200, v201
    v_cvt_pk_bf16_f32 v229, v202, v203
    v_cvt_pk_bf16_f32 v230, v204, v205
    v_cvt_pk_bf16_f32 v231, v206, v207
    v_mfma_f32_32x32x16_bf16 v[144:159], a[32:35], v[224:227], v[144:159]
    s_nop 0
    v_mfma_f32_32x32x16_bf16 v[144:159], a[36:39], v[228:231], v[144:159]
    s_nop 11
L_fs_1012:
    s_cmp_ge_i32 s46, -5
    s_cbranch_scc0 L_fs_1013
    v_mfma_f32_32x32x16_bf16 v[192:207], a[100:103], a[120:123], 0
    s_nop 11
    v_sub_f32 v192, v192, v60
    v_sub_f32 v193, v193, v60
    v_sub_f32 v194, v194, v60
    v_sub_f32 v195, v195, v60
    v_sub_f32 v196, v196, v60
    v_sub_f32 v197, v197, v60
    v_sub_f32 v198, v198, v60
    v_sub_f32 v199, v199, v60
    v_sub_f32 v200, v200, v60
    v_sub_f32 v201, v201, v60
    v_sub_f32 v202, v202, v60
    v_sub_f32 v203, v203, v60
    v_sub_f32 v204, v204, v60
    v_sub_f32 v205, v205, v60
    v_sub_f32 v206, v206, v60
    v_sub_f32 v207, v207, v60
    v_exp_f32 v192, v192
    v_exp_f32 v193, v193
    v_exp_f32 v194, v194
    v_exp_f32 v195, v195
    v_exp_f32 v196, v196
    v_exp_f32 v197, v197
    v_exp_f32 v198, v198
    v_exp_f32 v199, v199
    v_exp_f32 v200, v200
    v_exp_f32 v201, v201
    v_exp_f32 v202, v202
    v_exp_f32 v203, v203
    v_exp_f32 v204, v204
    v_exp_f32 v205, v205
    v_exp_f32 v206, v206
    v_exp_f32 v207, v207
    v_cvt_pk_bf16_f32 v224, v192, v193
    v_cvt_pk_bf16_f32 v225, v194, v195
    v_cvt_pk_bf16_f32 v226, v196, v197
    v_cvt_pk_bf16_f32 v227, v198, v199
    v_cvt_pk_bf16_f32 v228, v200, v201
    v_cvt_pk_bf16_f32 v229, v202, v203
    v_cvt_pk_bf16_f32 v230, v204, v205
    v_cvt_pk_bf16_f32 v231, v206, v207
    v_mfma_f32_32x32x16_bf16 v[144:159], a[40:43], v[224:227], v[144:159]
    s_nop 0
    v_mfma_f32_32x32x16_bf16 v[144:159], a[44:47], v[228:231], v[144:159]
    s_nop 11
L_fs_1013:
    s_cmp_ge_i32 s46, -6
    s_cbranch_scc0 L_fs_1014
    v_mfma_f32_32x32x16_bf16 v[192:207], a[104:107], a[120:123], 0
    s_nop 11
    v_sub_f32 v192, v192, v60
    v_sub_f32 v193, v193, v60
    v_sub_f32 v194, v194, v60
    v_sub_f32 v195, v195, v60
    v_sub_f32 v196, v196, v60
    v_sub_f32 v197, v197, v60
    v_sub_f32 v198, v198, v60
    v_sub_f32 v199, v199, v60
    v_sub_f32 v200, v200, v60
    v_sub_f32 v201, v201, v60
    v_sub_f32 v202, v202, v60
    v_sub_f32 v203, v203, v60
    v_sub_f32 v204, v204, v60
    v_sub_f32 v205, v205, v60
    v_sub_f32 v206, v206, v60
    v_sub_f32 v207, v207, v60
    v_exp_f32 v192, v192
    v_exp_f32 v193, v193
    v_exp_f32 v194, v194
    v_exp_f32 v195, v195
    v_exp_f32 v196, v196
    v_exp_f32 v197, v197
    v_exp_f32 v198, v198
    v_exp_f32 v199, v199
    v_exp_f32 v200, v200
    v_exp_f32 v201, v201
    v_exp_f32 v202, v202
    v_exp_f32 v203, v203
    v_exp_f32 v204, v204
    v_exp_f32 v205, v205
    v_exp_f32 v206, v206
    v_exp_f32 v207, v207
    v_cvt_pk_bf16_f32 v224, v192, v193
    v_cvt_pk_bf16_f32 v225, v194, v195
    v_cvt_pk_bf16_f32 v226, v196, v197
    v_cvt_pk_bf16_f32 v227, v198, v199
    v_cvt_pk_bf16_f32 v228, v200, v201
    v_cvt_pk_bf16_f32 v229, v202, v203
    v_cvt_pk_bf16_f32 v230, v204, v205
    v_cvt_pk_bf16_f32 v231, v206, v207
    v_mfma_f32_32x32x16_bf16 v[144:159], a[48:51], v[224:227], v[144:159]
    s_nop 0
    v_mfma_f32_32x32x16_bf16 v[144:159], a[52:55], v[228:231], v[144:159]
    s_nop 11
L_fs_1014:
    s_cmp_ge_i32 s46, -7
    s_cbranch_scc0 L_fs_1015
    v_mfma_f32_32x32x16_bf16 v[192:207], a[108:111], a[120:123], 0
    s_nop 11
    v_sub_f32 v192, v192, v60
    v_sub_f32 v193, v193, v60
    v_sub_f32 v194, v194, v60
    v_sub_f32 v195, v195, v60
    v_sub_f32 v196, v196, v60
    v_sub_f32 v197, v197, v60
    v_sub_f32 v198, v198, v60
    v_sub_f32 v199, v199, v60
    v_sub_f32 v200, v200, v60
    v_sub_f32 v201, v201, v60
    v_sub_f32 v202, v202, v60
    v_sub_f32 v203, v203, v60
    v_sub_f32 v204, v204, v60
    v_sub_f32 v205, v205, v60
    v_sub_f32 v206, v206, v60
    v_sub_f32 v207, v207, v60
    v_exp_f32 v192, v192
    v_exp_f32 v193, v193
    v_exp_f32 v194, v194
    v_exp_f32 v195, v195
    v_exp_f32 v196, v196
    v_exp_f32 v197, v197
    v_exp_f32 v198, v198
    v_exp_f32 v199, v199
    v_exp_f32 v200, v200
    v_exp_f32 v201, v201
    v_exp_f32 v202, v202
    v_exp_f32 v203, v203
    v_exp_f32 v204, v204
    v_exp_f32 v205, v205
    v_exp_f32 v206, v206
    v_exp_f32 v207, v207
    v_cvt_pk_bf16_f32 v224, v192, v193
    v_cvt_pk_bf16_f32 v225, v194, v195
    v_cvt_pk_bf16_f32 v226, v196, v197
    v_cvt_pk_bf16_f32 v227, v198, v199
    v_cvt_pk_bf16_f32 v228, v200, v201
    v_cvt_pk_bf16_f32 v229, v202, v203
    v_cvt_pk_bf16_f32 v230, v204, v205
    v_cvt_pk_bf16_f32 v231, v206, v207
    v_mfma_f32_32x32x16_bf16 v[144:159], a[56:59], v[224:227], v[144:159]
    s_nop 0
    v_mfma_f32_32x32x16_bf16 v[144:159], a[60:63], v[228:231], v[144:159]
    s_nop 11
L_fs_1015:
    v_rcp_f32 v56, v152
    s_nop 1
    s_branch L_fbback_202

L_fb_205:
    s_waitcnt vmcnt(0) lgkmcnt(0)
    s_nop 15
    v_mov_b32 v72, 0xf149f2ca
    v_mov_b32 v73, 0xf149f2ca
    v_mov_b32 v74, 0xf149f2ca
    v_mov_b32 v75, 0xf149f2ca
    v_mov_b32 v76, 0xf149f2ca
    v_mov_b32 v77, 0xf149f2ca
    v_mov_b32 v78, 0xf149f2ca
    v_mov_b32 v79, 0xf149f2ca
    v_mov_b32 v80, 0xf149f2ca
    v_mov_b32 v81, 0xf149f2ca
    v_mov_b32 v82, 0xf149f2ca
    v_mov_b32 v83, 0xf149f2ca
    v_mov_b32 v84, 0xf149f2ca
    v_mov_b32 v85, 0xf149f2ca
    v_mov_b32 v86, 0xf149f2ca
    v_mov_b32 v87, 0xf149f2ca
    s_nop 1
    s_cmp_ge_i32 s46, -1
    s_cbranch_scc0 L_fs_2001
    v_mfma_f32_32x32x16_bf16 v[72:87], a[84:87], a[124:127], 0
    s_nop 11
L_fs_2001:
    v_mfma_f32_32x32x16_bf16 v[176:191], a[116:119], a[124:127], 0
    s_nop 11
    v_cndmask_b32 v176, v176, v72, s[64:65]
    v_cndmask_b32 v177, v177, v73, s[66:67]
    v_cndmask_b32 v178, v178, v74, s[68:69]
    v_cndmask_b32 v179, v179, v75, s[70:71]
    v_cndmask_b32 v180, v180, v76, s[72:73]
    v_cndmask_b32 v181, v181, v77, s[74:75]
    v_cndmask_b32 v182, v182, v78, s[76:77]
    v_cndmask_b32 v183, v183, v79, s[78:79]
    v_cndmask_b32 v184, v184, v80, s[80:81]
    v_cndmask_b32 v185, v185, v81, s[82:83]
    v_cndmask_b32 v186, v186, v82, s[84:85]
    v_cndmask_b32 v187, v187, v83, s[86:87]
    v_cndmask_b32 v188, v188, v84, s[88:89]
    v_cndmask_b32 v189, v189, v85, s[90:91]
    v_cndmask_b32 v190, v190, v86, s[92:93]
    v_cndmask_b32 v191, v191, v87, s[94:95]
    v_max_f32 v60, v176, v177
    v_max3_f32 v60, v60, v178, v179
    v_max3_f32 v60, v60, v180, v181
    v_max3_f32 v60, v60, v182, v183
    v_max3_f32 v60, v60, v184, v185
    v_max3_f32 v60, v60, v186, v187
    v_max3_f32 v60, v60, v188, v189
    v_max3_f32 v60, v60, v190, v191
    s_nop 1
    s_cmp_ge_i32 s46, -2
    s_cbranch_scc0 L_fs_2002
    v_mfma_f32_32x32x16_bf16 v[72:87], a[88:91], a[124:127], 0
    s_nop 11
    v_max3_f32 v60, v60, v72, v73
    v_max3_f32 v60, v60, v74, v75
    v_max3_f32 v60, v60, v76, v77
    v_max3_f32 v60, v60, v78, v79
    v_max3_f32 v60, v60, v80, v81
    v_max3_f32 v60, v60, v82, v83
    v_max3_f32 v60, v60, v84, v85
    v_max3_f32 v60, v60, v86, v87
    s_nop 1
L_fs_2002:
    s_cmp_ge_i32 s46, -3
    s_cbranch_scc0 L_fs_2003
    v_mfma_f32_32x32x16_bf16 v[72:87], a[92:95], a[124:127], 0
    s_nop 11
    v_max3_f32 v60, v60, v72, v73
    v_max3_f32 v60, v60, v74, v75
    v_max3_f32 v60, v60, v76, v77
    v_max3_f32 v60, v60, v78, v79
    v_max3_f32 v60, v60, v80, v81
    v_max3_f32 v60, v60, v82, v83
    v_max3_f32 v60, v60, v84, v85
    v_max3_f32 v60, v60, v86, v87
    s_nop 1
L_fs_2003:
    s_cmp_ge_i32 s46, -4
    s_cbranch_scc0 L_fs_2004
    v_mfma_f32_32x32x16_bf16 v[72:87], a[96:99], a[124:127], 0
    s_nop 11
    v_max3_f32 v60, v60, v72, v73
    v_max3_f32 v60, v60, v74, v75
    v_max3_f32 v60, v60, v76, v77
    v_max3_f32 v60, v60, v78, v79
    v_max3_f32 v60, v60, v80, v81
    v_max3_f32 v60, v60, v82, v83
    v_max3_f32 v60, v60, v84, v85
    v_max3_f32 v60, v60, v86, v87
    s_nop 1
L_fs_2004:
    s_cmp_ge_i32 s46, -5
    s_cbranch_scc0 L_fs_2005
    v_mfma_f32_32x32x16_bf16 v[72:87], a[100:103], a[124:127], 0
    s_nop 11
    v_max3_f32 v60, v60, v72, v73
    v_max3_f32 v60, v60, v74, v75
    v_max3_f32 v60, v60, v76, v77
    v_max3_f32 v60, v60, v78, v79
    v_max3_f32 v60, v60, v80, v81
    v_max3_f32 v60, v60, v82, v83
    v_max3_f32 v60, v60, v84, v85
    v_max3_f32 v60, v60, v86, v87
    s_nop 1
L_fs_2005:
    s_cmp_ge_i32 s46, -6
    s_cbranch_scc0 L_fs_2006
    v_mfma_f32_32x32x16_bf16 v[72:87], a[104:107], a[124:127], 0
    s_nop 11
    v_max3_f32 v60, v60, v72, v73
    v_max3_f32 v60, v60, v74, v75
    v_max3_f32 v60, v60, v76, v77
    v_max3_f32 v60, v60, v78, v79
    v_max3_f32 v60, v60, v80, v81
    v_max3_f32 v60, v60, v82, v83
    v_max3_f32 v60, v60, v84, v85
    v_max3_f32 v60, v60, v86, v87
    s_nop 1
L_fs_2006:
    s_cmp_ge_i32 s46, -7
    s_cbranch_scc0 L_fs_2007
    v_mfma_f32_32x32x16_bf16 v[72:87], a[108:111], a[124:127], 0
    s_nop 11
    v_max3_f32 v60, v60, v72, v73
    v_max3_f32 v60, v60, v74, v75
    v_max3_f32 v60, v60, v76, v77
    v_max3_f32 v60, v60, v78, v79
    v_max3_f32 v60, v60, v80, v81
    v_max3_f32 v60, v60, v82, v83
    v_max3_f32 v60, v60, v84, v85
    v_max3_f32 v60, v60, v86, v87
    s_nop 1
L_fs_2007:
    s_cmp_ge_i32 s46, -8
    s_cbranch_scc0 L_fs_2008
    v_mfma_f32_32x32x16_bf16 v[72:87], a[112:115], a[124:127], 0
    s_nop 11
    v_max3_f32 v60, v60, v72, v73
    v_max3_f32 v60, v60, v74, v75
    v_max3_f32 v60, v60, v76, v77
    v_max3_f32 v60, v60, v78, v79
    v_max3_f32 v60, v60, v80, v81
    v_max3_f32 v60, v60, v82, v83
    v_max3_f32 v60, v60, v84, v85
    v_max3_f32 v60, v60, v86, v87
    s_nop 1
L_fs_2008:
    v_mov_b32 v61, v60
    s_nop 1
    v_permlane32_swap_b32 v60, v61
    v_max_f32 v60, v60, v61
    v_sub_f32 v176, v176, v60
    v_sub_f32 v177, v177, v60
    v_sub_f32 v178, v178, v60
    v_sub_f32 v179, v179, v60
    v_sub_f32 v180, v180, v60
    v_sub_f32 v181, v181, v60
    v_sub_f32 v182, v182, v60
    v_sub_f32 v183, v183, v60
    v_sub_f32 v184, v184, v60
    v_sub_f32 v185, v185, v60
    v_sub_f32 v186, v186, v60
    v_sub_f32 v187, v187, v60
    v_sub_f32 v188, v188, v60
    v_sub_f32 v189, v189, v60
    v_sub_f32 v190, v190, v60
    v_sub_f32 v191, v191, v60
    v_exp_f32 v176, v176
    v_exp_f32 v177, v177
    v_exp_f32 v178, v178
    v_exp_f32 v179, v179
    v_exp_f32 v180, v180
    v_exp_f32 v181, v181
    v_exp_f32 v182, v182
    v_exp_f32 v183, v183
    v_exp_f32 v184, v184
    v_exp_f32 v185, v185
    v_exp_f32 v186, v186
    v_exp_f32 v187, v187
    v_exp_f32 v188, v188
    v_exp_f32 v189, v189
    v_exp_f32 v190, v190
    v_exp_f32 v191, v191
    v_cvt_pk_bf16_f32 v40, v176, v177
    v_cvt_pk_bf16_f32 v41, v178, v179
    v_cvt_pk_bf16_f32 v42, v180, v181
    v_cvt_pk_bf16_f32 v43, v182, v183
    v_cvt_pk_bf16_f32 v44, v184, v185
    v_cvt_pk_bf16_f32 v45, v186, v187
    v_cvt_pk_bf16_f32 v46, v188, v189
    v_cvt_pk_bf16_f32 v47, v190, v191
    v_bfi_b32 v48, v32, 0, v40
    v_bfi_b32 v49, v33, 0, v41
    v_bfi_b32 v50, v34, 0, v42
    v_bfi_b32 v51, v35, 0, v43
    v_bfi_b32 v52, v36, 0, v44
    v_bfi_b32 v53, v37, 0, v45
    v_bfi_b32 v54, v38, 0, v46
    v_bfi_b32 v55, v39, 0, v47
    v_and_b32 v40, v40, v32
    v_and_b32 v41, v41, v33
    v_and_b32 v42, v42, v34
    v_and_b32 v43, v43, v35
    v_and_b32 v44, v44, v36
    v_and_b32 v45, v45, v37
    v_and_b32 v46, v46, v38
    v_and_b32 v47, v47, v39
    v_mfma_f32_32x32x16_bf16 v[160:175], a[72:75], v[48:51], 0
    v_mfma_f32_32x32x16_bf16 v[160:175], a[76:79], v[52:55], v[160:175]
    v_mfma_f32_32x32x16_bf16 v[160:175], a[8:11], v[40:43], v[160:175]
    v_mfma_f32_32x32x16_bf16 v[160:175], a[12:15], v[44:47], v[160:175]
    s_nop 11
    s_cmp_ge_i32 s46, -2
    s_cbranch_scc0 L_fs_2009
    v_mfma_f32_32x32x16_bf16 v[72:87], a[88:91], a[124:127], 0
    s_nop 11
    v_sub_f32 v72, v72, v60
    v_sub_f32 v73, v73, v60
    v_sub_f32 v74, v74, v60
    v_sub_f32 v75, v75, v60
    v_sub_f32 v76, v76, v60
    v_sub_f32 v77, v77, v60
    v_sub_f32 v78, v78, v60
    v_sub_f32 v79, v79, v60
    v_sub_f32 v80, v80, v60
    v_sub_f32 v81, v81, v60
    v_sub_f32 v82, v82, v60
    v_sub_f32 v83, v83, v60
    v_sub_f32 v84, v84, v60
    v_sub_f32 v85, v85, v60
    v_sub_f32 v86, v86, v60
    v_sub_f32 v87, v87, v60
    v_exp_f32 v72, v72
    v_exp_f32 v73, v73
    v_exp_f32 v74, v74
    v_exp_f32 v75, v75
    v_exp_f32 v76, v76
    v_exp_f32 v77, v77
    v_exp_f32 v78, v78
    v_exp_f32 v79, v79
    v_exp_f32 v80, v80
    v_exp_f32 v81, v81
    v_exp_f32 v82, v82
    v_exp_f32 v83, v83
    v_exp_f32 v84, v84
    v_exp_f32 v85, v85
    v_exp_f32 v86, v86
    v_exp_f32 v87, v87
    v_cvt_pk_bf16_f32 v40, v72, v73
    v_cvt_pk_bf16_f32 v41, v74, v75
    v_cvt_pk_bf16_f32 v42, v76, v77
    v_cvt_pk_bf16_f32 v43, v78, v79
    v_cvt_pk_bf16_f32 v44, v80, v81
    v_cvt_pk_bf16_f32 v45, v82, v83
    v_cvt_pk_bf16_f32 v46, v84, v85
    v_cvt_pk_bf16_f32 v47, v86, v87
    v_mfma_f32_32x32x16_bf16 v[160:175], a[16:19], v[40:43], v[160:175]
    s_nop 0
    v_mfma_f32_32x32x16_bf16 v[160:175], a[20:23], v[44:47], v[160:175]
    s_nop 11
L_fs_2009:
    s_cmp_ge_i32 s46, -3
    s_cbranch_scc0 L_fs_2010
    v_mfma_f32_32x32x16_bf16 v[72:87], a[92:95], a[124:127], 0
    s_nop 11
    v_sub_f32 v72, v72, v60
    v_sub_f32 v73, v73, v60
    v_sub_f32 v74, v74, v60
    v_sub_f32 v75, v75, v60
    v_sub_f32 v76, v76, v60
    v_sub_f32 v77, v77, v60
    v_sub_f32 v78, v78, v60
    v_sub_f32 v79, v79, v60
    v_sub_f32 v80, v80, v60
    v_sub_f32 v81, v81, v60
    v_sub_f32 v82, v82, v60
    v_sub_f32 v83, v83, v60
    v_sub_f32 v84, v84, v60
    v_sub_f32 v85, v85, v60
    v_sub_f32 v86, v86, v60
    v_sub_f32 v87, v87, v60
    v_exp_f32 v72, v72
    v_exp_f32 v73, v73
    v_exp_f32 v74, v74
    v_exp_f32 v75, v75
    v_exp_f32 v76, v76
    v_exp_f32 v77, v77
    v_exp_f32 v78, v78
    v_exp_f32 v79, v79
    v_exp_f32 v80, v80
    v_exp_f32 v81, v81
    v_exp_f32 v82, v82
    v_exp_f32 v83, v83
    v_exp_f32 v84, v84
    v_exp_f32 v85, v85
    v_exp_f32 v86, v86
    v_exp_f32 v87, v87
    v_cvt_pk_bf16_f32 v40, v72, v73
    v_cvt_pk_bf16_f32 v41, v74, v75
    v_cvt_pk_bf16_f32 v42, v76, v77
    v_cvt_pk_bf16_f32 v43, v78, v79
    v_cvt_pk_bf16_f32 v44, v80, v81
    v_cvt_pk_bf16_f32 v45, v82, v83
    v_cvt_pk_bf16_f32 v46, v84, v85
    v_cvt_pk_bf16_f32 v47, v86, v87
    v_mfma_f32_32x32x16_bf16 v[160:175], a[24:27], v[40:43], v[160:175]
    s_nop 0
    v_mfma_f32_32x32x16_bf16 v[160:175], a[28:31], v[44:47], v[160:175]
    s_nop 11
L_fs_2010:
    s_cmp_ge_i32 s46, -4
    s_cbranch_scc0 L_fs_2011
    v_mfma_f32_32x32x16_bf16 v[72:87], a[96:99], a[124:127], 0
    s_nop 11
    v_sub_f32 v72, v72, v60
    v_sub_f32 v73, v73, v60
    v_sub_f32 v74, v74, v60
    v_sub_f32 v75, v75, v60
    v_sub_f32 v76, v76, v60
    v_sub_f32 v77, v77, v60
    v_sub_f32 v78, v78, v60
    v_sub_f32 v79, v79, v60
    v_sub_f32 v80, v80, v60
    v_sub_f32 v81, v81, v60
    v_sub_f32 v82, v82, v60
    v_sub_f32 v83, v83, v60
    v_sub_f32 v84, v84, v60
    v_sub_f32 v85, v85, v60
    v_sub_f32 v86, v86, v60
    v_sub_f32 v87, v87, v60
    v_exp_f32 v72, v72
    v_exp_f32 v73, v73
    v_exp_f32 v74, v74
    v_exp_f32 v75, v75
    v_exp_f32 v76, v76
    v_exp_f32 v77, v77
    v_exp_f32 v78, v78
    v_exp_f32 v79, v79
    v_exp_f32 v80, v80
    v_exp_f32 v81, v81
    v_exp_f32 v82, v82
    v_exp_f32 v83, v83
    v_exp_f32 v84, v84
    v_exp_f32 v85, v85
    v_exp_f32 v86, v86
    v_exp_f32 v87, v87
    v_cvt_pk_bf16_f32 v40, v72, v73
    v_cvt_pk_bf16_f32 v41, v74, v75
    v_cvt_pk_bf16_f32 v42, v76, v77
    v_cvt_pk_bf16_f32 v43, v78, v79
    v_cvt_pk_bf16_f32 v44, v80, v81
    v_cvt_pk_bf16_f32 v45, v82, v83
    v_cvt_pk_bf16_f32 v46, v84, v85
    v_cvt_pk_bf16_f32 v47, v86, v87
    v_mfma_f32_32x32x16_bf16 v[160:175], a[32:35], v[40:43], v[160:175]
    s_nop 0
    v_mfma_f32_32x32x16_bf16 v[160:175], a[36:39], v[44:47], v[160:175]
    s_nop 11
L_fs_2011:
    s_cmp_ge_i32 s46, -5
    s_cbranch_scc0 L_fs_2012
    v_mfma_f32_32x32x16_bf16 v[72:87], a[100:103], a[124:127], 0
    s_nop 11
    v_sub_f32 v72, v72, v60
    v_sub_f32 v73, v73, v60
    v_sub_f32 v74, v74, v60
    v_sub_f32 v75, v75, v60
    v_sub_f32 v76, v76, v60
    v_sub_f32 v77, v77, v60
    v_sub_f32 v78, v78, v60
    v_sub_f32 v79, v79, v60
    v_sub_f32 v80, v80, v60
    v_sub_f32 v81, v81, v60
    v_sub_f32 v82, v82, v60
    v_sub_f32 v83, v83, v60
    v_sub_f32 v84, v84, v60
    v_sub_f32 v85, v85, v60
    v_sub_f32 v86, v86, v60
    v_sub_f32 v87, v87, v60
    v_exp_f32 v72, v72
    v_exp_f32 v73, v73
    v_exp_f32 v74, v74
    v_exp_f32 v75, v75
    v_exp_f32 v76, v76
    v_exp_f32 v77, v77
    v_exp_f32 v78, v78
    v_exp_f32 v79, v79
    v_exp_f32 v80, v80
    v_exp_f32 v81, v81
    v_exp_f32 v82, v82
    v_exp_f32 v83, v83
    v_exp_f32 v84, v84
    v_exp_f32 v85, v85
    v_exp_f32 v86, v86
    v_exp_f32 v87, v87
    v_cvt_pk_bf16_f32 v40, v72, v73
    v_cvt_pk_bf16_f32 v41, v74, v75
    v_cvt_pk_bf16_f32 v42, v76, v77
    v_cvt_pk_bf16_f32 v43, v78, v79
    v_cvt_pk_bf16_f32 v44, v80, v81
    v_cvt_pk_bf16_f32 v45, v82, v83
    v_cvt_pk_bf16_f32 v46, v84, v85
    v_cvt_pk_bf16_f32 v47, v86, v87
    v_mfma_f32_32x32x16_bf16 v[160:175], a[40:43], v[40:43], v[160:175]
    s_nop 0
    v_mfma_f32_32x32x16_bf16 v[160:175], a[44:47], v[44:47], v[160:175]
    s_nop 11
L_fs_2012:
    s_cmp_ge_i32 s46, -6
    s_cbranch_scc0 L_fs_2013
    v_mfma_f32_32x32x16_bf16 v[72:87], a[104:107], a[124:127], 0
    s_nop 11
    v_sub_f32 v72, v72, v60
    v_sub_f32 v73, v73, v60
    v_sub_f32 v74, v74, v60
    v_sub_f32 v75, v75, v60
    v_sub_f32 v76, v76, v60
    v_sub_f32 v77, v77, v60
    v_sub_f32 v78, v78, v60
    v_sub_f32 v79, v79, v60
    v_sub_f32 v80, v80, v60
    v_sub_f32 v81, v81, v60
    v_sub_f32 v82, v82, v60
    v_sub_f32 v83, v83, v60
    v_sub_f32 v84, v84, v60
    v_sub_f32 v85, v85, v60
    v_sub_f32 v86, v86, v60
    v_sub_f32 v87, v87, v60
    v_exp_f32 v72, v72
    v_exp_f32 v73, v73
    v_exp_f32 v74, v74
    v_exp_f32 v75, v75
    v_exp_f32 v76, v76
    v_exp_f32 v77, v77
    v_exp_f32 v78, v78
    v_exp_f32 v79, v79
    v_exp_f32 v80, v80
    v_exp_f32 v81, v81
    v_exp_f32 v82, v82
    v_exp_f32 v83, v83
    v_exp_f32 v84, v84
    v_exp_f32 v85, v85
    v_exp_f32 v86, v86
    v_exp_f32 v87, v87
    v_cvt_pk_bf16_f32 v40, v72, v73
    v_cvt_pk_bf16_f32 v41, v74, v75
    v_cvt_pk_bf16_f32 v42, v76, v77
    v_cvt_pk_bf16_f32 v43, v78, v79
    v_cvt_pk_bf16_f32 v44, v80, v81
    v_cvt_pk_bf16_f32 v45, v82, v83
    v_cvt_pk_bf16_f32 v46, v84, v85
    v_cvt_pk_bf16_f32 v47, v86, v87
    v_mfma_f32_32x32x16_bf16 v[160:175], a[48:51], v[40:43], v[160:175]
    s_nop 0
    v_mfma_f32_32x32x16_bf16 v[160:175], a[52:55], v[44:47], v[160:175]
    s_nop 11
L_fs_2013:
    s_cmp_ge_i32 s46, -7
    s_cbranch_scc0 L_fs_2014
    v_mfma_f32_32x32x16_bf16 v[72:87], a[108:111], a[124:127], 0
    s_nop 11
    v_sub_f32 v72, v72, v60
    v_sub_f32 v73, v73, v60
    v_sub_f32 v74, v74, v60
    v_sub_f32 v75, v75, v60
    v_sub_f32 v76, v76, v60
    v_sub_f32 v77, v77, v60
    v_sub_f32 v78, v78, v60
    v_sub_f32 v79, v79, v60
    v_sub_f32 v80, v80, v60
    v_sub_f32 v81, v81, v60
    v_sub_f32 v82, v82, v60
    v_sub_f32 v83, v83, v60
    v_sub_f32 v84, v84, v60
    v_sub_f32 v85, v85, v60
    v_sub_f32 v86, v86, v60
    v_sub_f32 v87, v87, v60
    v_exp_f32 v72, v72
    v_exp_f32 v73, v73
    v_exp_f32 v74, v74
    v_exp_f32 v75, v75
    v_exp_f32 v76, v76
    v_exp_f32 v77, v77
    v_exp_f32 v78, v78
    v_exp_f32 v79, v79
    v_exp_f32 v80, v80
    v_exp_f32 v81, v81
    v_exp_f32 v82, v82
    v_exp_f32 v83, v83
    v_exp_f32 v84, v84
    v_exp_f32 v85, v85
    v_exp_f32 v86, v86
    v_exp_f32 v87, v87
    v_cvt_pk_bf16_f32 v40, v72, v73
    v_cvt_pk_bf16_f32 v41, v74, v75
    v_cvt_pk_bf16_f32 v42, v76, v77
    v_cvt_pk_bf16_f32 v43, v78, v79
    v_cvt_pk_bf16_f32 v44, v80, v81
    v_cvt_pk_bf16_f32 v45, v82, v83
    v_cvt_pk_bf16_f32 v46, v84, v85
    v_cvt_pk_bf16_f32 v47, v86, v87
    v_mfma_f32_32x32x16_bf16 v[160:175], a[56:59], v[40:43], v[160:175]
    s_nop 0
    v_mfma_f32_32x32x16_bf16 v[160:175], a[60:63], v[44:47], v[160:175]
    s_nop 11
L_fs_2014:
    s_cmp_ge_i32 s46, -8
    s_cbranch_scc0 L_fs_2015
    v_mfma_f32_32x32x16_bf16 v[72:87], a[112:115], a[124:127], 0
    s_nop 11
    v_sub_f32 v72, v72, v60
    v_sub_f32 v73, v73, v60
    v_sub_f32 v74, v74, v60
    v_sub_f32 v75, v75, v60
    v_sub_f32 v76, v76, v60
    v_sub_f32 v77, v77, v60
    v_sub_f32 v78, v78, v60
    v_sub_f32 v79, v79, v60
    v_sub_f32 v80, v80, v60
    v_sub_f32 v81, v81, v60
    v_sub_f32 v82, v82, v60
    v_sub_f32 v83, v83, v60
    v_sub_f32 v84, v84, v60
    v_sub_f32 v85, v85, v60
    v_sub_f32 v86, v86, v60
    v_sub_f32 v87, v87, v60
    v_exp_f32 v72, v72
    v_exp_f32 v73, v73
    v_exp_f32 v74, v74
    v_exp_f32 v75, v75
    v_exp_f32 v76, v76
    v_exp_f32 v77, v77
    v_exp_f32 v78, v78
    v_exp_f32 v79, v79
    v_exp_f32 v80, v80
    v_exp_f32 v81, v81
    v_exp_f32 v82, v82
    v_exp_f32 v83, v83
    v_exp_f32 v84, v84
    v_exp_f32 v85, v85
    v_exp_f32 v86, v86
    v_exp_f32 v87, v87
    v_cvt_pk_bf16_f32 v40, v72, v73
    v_cvt_pk_bf16_f32 v41, v74, v75
    v_cvt_pk_bf16_f32 v42, v76, v77
    v_cvt_pk_bf16_f32 v43, v78, v79
    v_cvt_pk_bf16_f32 v44, v80, v81
    v_cvt_pk_bf16_f32 v45, v82, v83
    v_cvt_pk_bf16_f32 v46, v84, v85
    v_cvt_pk_bf16_f32 v47, v86, v87
    v_mfma_f32_32x32x16_bf16 v[160:175], a[64:67], v[40:43], v[160:175]
    s_nop 0
    v_mfma_f32_32x32x16_bf16 v[160:175], a[68:71], v[44:47], v[160:175]
    s_nop 11
L_fs_2015:
    v_rcp_f32 v56, v168
    s_nop 1
    s_branch L_fbback_206

.section .rodata,"a"
.p2align 6
.amdhsa_kernel gated_mix__sliding_block__swiglu_ffn__prompt_kernel
  .amdhsa_next_free_vgpr 512
  .amdhsa_next_free_sgpr 102
  .amdhsa_accum_offset 256
  .amdhsa_group_segment_fixed_size 0
  .amdhsa_kernarg_size 88
  .amdhsa_user_sgpr_count 2
  .amdhsa_user_sgpr_kernarg_segment_ptr 1
  .amdhsa_system_sgpr_workgroup_id_x 1
  .amdhsa_float_denorm_mode_32 3
.end_amdhsa_kernel
```
